```python
import torch

def _softmax(x, axis=-1):
    return torch.softmax(x, dim=axis)
def _gelu(x):
    return torch.nn.functional.gelu(x, approximate="tanh")
def _silu(x):
    return torch.nn.functional.silu(x)
def _sigmoid(x):
    return torch.sigmoid(x)
def _layernorm(x, axis=-1, eps=1e-5):
    m = x.mean(dim=axis, keepdim=True)
    v = x.var(dim=axis, keepdim=True, unbiased=False)
    return (x - m) / torch.sqrt(v + eps)
def _scatter_add(tgt, idx, src, axis=0):
    return tgt.clone().index_add_(axis, idx, src)
def _segment_sum(src, seg, n):
    out = torch.zeros((n,) + src.shape[1:], dtype=src.dtype)
    return out.index_add_(0, seg, src)
def _pad(x, pw):
    flat = tuple(v for pair in reversed(pw) for v in pair)
    return torch.nn.functional.pad(x, flat)

kernel_name = 'standalone__mha_softmax__near_ridge'

def setup_inputs():

    _w = (lambda a: (lambda t: t.to(torch.bfloat16) if t.is_floating_point() else t)(torch.as_tensor(a)))
    B, H, Sq, Sk, D = 8, 32, 240, 2048, 128
    return {
        "q": _w((lambda *s: torch.randn(*s, dtype=torch.bfloat16) * 0.8)(B, H, Sq, D)),
        "k": _w((lambda *s: torch.randn(*s, dtype=torch.bfloat16) * 0.8)(B, H, Sk, D)),
        "v": _w((lambda *s: torch.randn(*s, dtype=torch.bfloat16) * 0.05)(B, H, Sk, D)),
    }

def reference(q, k, v):
    scale = q.shape[-1] ** -0.5
    scores = torch.einsum("bhqd,bhkd->bhqk", q, k) * scale
    p = _softmax(scores, axis=-1)
    return torch.einsum("bhqk,bhkd->bhqd", p, v)
```

```asm
; @launch grid=(256,1,1) block=(256,1,1) lds=131072
.amdgcn_target "amdgcn-amd-amdhsa--gfx950"
.text
.globl standalone__mha_softmax__near_ridge_kernel
.p2align 12
.p2align 8
.type standalone__mha_softmax__near_ridge_kernel,@function
standalone__mha_softmax__near_ridge_kernel:
    s_cmp_ge_u32 s2, 256
    s_cbranch_scc1 L_end
    s_load_dwordx4 s[4:7], s[0:1], 0
    s_load_dwordx4 s[8:11], s[0:1], 16
    v_lshrrev_b32 v20, 6, v0
    v_and_b32 v18, 63, v0
    v_readfirstlane_b32 s3, v20
    s_mov_b32 s38, s2
    s_and_b32 s28, s2, 7
    s_lshl_b32 s28, s28, 5
    s_lshr_b32 s2, s2, 3
    s_or_b32 s2, s2, s28
    v_lshrrev_b32 v20, 4, v18
    v_and_b32 v21, 15, v18
    s_lshl_b32 s30, s3, 12
    s_and_b32 s28, s3, 1
    s_lshl_b32 s28, s28, 15
    s_lshr_b32 s37, s3, 1
    s_lshl_b32 s37, s37, 16
    s_or_b32 s37, s37, s28
    v_lshl_add_u32 v24, v20, 8, s37
    v_add_u32 v22, 0, v20
    v_xor_b32 v0, v22, v21
    v_lshl_add_u32 v12, v0, 4, v24
    v_subrev_u32 v72, s37, v12
    v_lshlrev_b32 v22, 1, v22
    v_xor_b32 v22, v22, v21
    v_lshl_add_u32 v16, v22, 4, v24
    v_add_u32 v22, 4, v20
    v_xor_b32 v1, v22, v21
    v_lshl_add_u32 v13, v1, 4, v24
    v_subrev_u32 v73, s37, v13
    v_lshlrev_b32 v22, 1, v22
    v_xor_b32 v22, v22, v21
    v_lshl_add_u32 v17, v22, 4, v24
    v_add_u32 v22, 8, v20
    v_xor_b32 v2, v22, v21
    v_lshl_add_u32 v14, v2, 4, v24
    v_subrev_u32 v74, s37, v14
    v_add_u32 v22, 12, v20
    v_xor_b32 v3, v22, v21
    v_lshl_add_u32 v15, v3, 4, v24
    v_subrev_u32 v75, s37, v15
    s_lshl_b32 s39, s3, 14
    s_mov_b32 s32, 0
    s_lshl_b32 s28, s2, 19
    s_lshr_b32 s29, s2, 13
    s_mov_b32 s14, 0x80000
    s_mov_b32 s15, 0x20000
    s_mov_b32 s18, 0x80000
    s_mov_b32 s19, 0x20000
    s_mov_b32 s22, 61440
    s_mov_b32 s23, 0x20000
    s_mov_b32 s26, 61440
    s_mov_b32 s27, 0x20000
    s_add_u32 m0, s30, 0
    s_waitcnt lgkmcnt(0)
    s_add_u32 s12, s6, s28
    s_addc_u32 s13, s7, s29
    s_add_u32 s16, s8, s28
    s_addc_u32 s17, s9, s29
    s_mul_i32 s28, s2, 61440
    buffer_load_dwordx4 v12, s[12:15], s32 offen offset:0 nt lds
    buffer_load_dwordx4 v13, s[12:15], s32 offen offset:1024 nt lds
    buffer_load_dwordx4 v14, s[12:15], s32 offen offset:2048 nt lds
    buffer_load_dwordx4 v15, s[12:15], s32 offen offset:3072 nt lds
    s_add_u32 s20, s4, s28
    s_addc_u32 s21, s5, 0
    s_add_u32 s24, s10, s28
    s_addc_u32 s25, s11, 0
    s_getreg_b32 s11, hwreg(HW_REG_XCC_ID, 0, 1)
    s_cmp_eq_u32 s11, 0
    s_cselect_b32 s28, 1, 0
    s_add_u32 m0, s30, 49152
    s_add_u32 s29, s39, 0
    buffer_load_dwordx4 v72, s[20:23], s29 offen offset:0 nt lds
    buffer_load_dwordx4 v73, s[20:23], s29 offen offset:1024 nt lds
    buffer_load_dwordx4 v74, s[20:23], s29 offen offset:2048 nt lds
    buffer_load_dwordx4 v75, s[20:23], s29 offen offset:3072 nt lds
    s_cmp_eq_u32 s28, 1
    s_cbranch_scc1 L_h1E
    s_add_u32 m0, s30, 114688
    s_add_u32 s29, s39, 4096
    buffer_load_dwordx4 v72, s[20:23], s29 offen offset:0 nt lds
    buffer_load_dwordx4 v73, s[20:23], s29 offen offset:1024 nt lds
    buffer_load_dwordx4 v74, s[20:23], s29 offen offset:2048 nt lds
    buffer_load_dwordx4 v75, s[20:23], s29 offen offset:3072 nt lds
    s_lshr_b32 s28, s38, 1
    s_andn2_b32 s28, s28, 3
    s_add_u32 s28, s28, s3
    s_and_b32 s28, s28, 15
    s_cmp_eq_u32 s28, 0
    s_cbranch_scc1 T_A4O
    s_cmp_eq_u32 s28, 1
    s_cbranch_scc1 T_B4O
    s_cmp_eq_u32 s28, 2
    s_cbranch_scc1 T_W4
    s_cmp_eq_u32 s28, 3
    s_cbranch_scc1 T_L4O
    s_cmp_eq_u32 s28, 4
    s_cbranch_scc1 T_E4
    s_cmp_eq_u32 s28, 5
    s_cbranch_scc1 T_A3O
    s_cmp_eq_u32 s28, 6
    s_cbranch_scc1 T_B3O
    s_cmp_eq_u32 s28, 7
    s_cbranch_scc1 T_W3
    s_cmp_eq_u32 s28, 8
    s_cbranch_scc1 T_L3
    s_cmp_eq_u32 s28, 9
    s_cbranch_scc1 T_E3
    s_branch L_backE
L_h1E:
    s_lshr_b32 s28, s38, 1
    s_andn2_b32 s28, s28, 3
    s_add_u32 s28, s28, s3
    s_and_b32 s28, s28, 15
    s_cmp_eq_u32 s28, 0
    s_cbranch_scc1 T_A4E
    s_cmp_eq_u32 s28, 1
    s_cbranch_scc1 T_B4E
    s_cmp_eq_u32 s28, 2
    s_cbranch_scc1 T_W4
    s_cmp_eq_u32 s28, 3
    s_cbranch_scc1 T_L4E
    s_cmp_eq_u32 s28, 4
    s_cbranch_scc1 T_E4
    s_cmp_eq_u32 s28, 5
    s_cbranch_scc1 T_A3E
    s_cmp_eq_u32 s28, 6
    s_cbranch_scc1 T_B3E
    s_cmp_eq_u32 s28, 7
    s_cbranch_scc1 T_W3
    s_cmp_eq_u32 s28, 8
    s_cbranch_scc1 T_L3
    s_cmp_eq_u32 s28, 9
    s_cbranch_scc1 T_E3
L_backE:
    v_lshlrev_b32 v22, 4, v0
    v_lshl_add_u32 v0, v21, 8, v22
    v_lshlrev_b32 v22, 4, v1
    v_lshl_add_u32 v1, v21, 8, v22
    v_lshlrev_b32 v22, 4, v2
    v_lshl_add_u32 v2, v21, 8, v22
    v_lshlrev_b32 v22, 4, v3
    v_lshl_add_u32 v3, v21, 8, v22
    v_lshrrev_b32 v22, 2, v18
    v_and_b32 v20, 7, v22
    v_lshlrev_b32 v22, 8, v22
    v_and_b32 v23, 3, v18
    v_lshl_add_u32 v22, v23, 3, v22
    v_add_u32 v22, 65536, v22
    v_xor_b32 v24, 0, v20
    v_lshl_add_u32 v4, v24, 5, v22
    v_xor_b32 v24, 1, v20
    v_lshl_add_u32 v5, v24, 5, v22
    v_xor_b32 v24, 2, v20
    v_lshl_add_u32 v6, v24, 5, v22
    v_xor_b32 v24, 3, v20
    v_lshl_add_u32 v7, v24, 5, v22
    v_xor_b32 v24, 4, v20
    v_lshl_add_u32 v8, v24, 5, v22
    v_xor_b32 v24, 5, v20
    v_lshl_add_u32 v9, v24, 5, v22
    v_xor_b32 v24, 6, v20
    v_lshl_add_u32 v10, v24, 5, v22
    v_xor_b32 v24, 7, v20
    v_lshl_add_u32 v11, v24, 5, v22
    v_and_b32 v24, 1, v18
    v_mul_u32_u24 v24, 0xaaaa, v24
    v_add_u32 v111, 0x4444, v24
    v_cmp_gt_u32 vcc, 2, v23
    v_mov_b32 v22, 0x3f803f80
    v_accvgpr_write_b32 a212, 0
    v_accvgpr_write_b32 a213, 0
    v_accvgpr_write_b32 a214, 0
    v_accvgpr_write_b32 a215, 0
    v_cndmask_b32 v22, 0, v22, vcc
    v_add_u32 v96, s30, v0
    v_add_u32 v100, 65536, v96
    v_add_u32 v97, s30, v1
    v_add_u32 v101, 65536, v97
    v_add_u32 v98, s30, v2
    v_add_u32 v102, 65536, v98
    v_add_u32 v99, s30, v3
    v_add_u32 v103, 65536, v99
    v_accvgpr_write_b32 a208, v22
    v_accvgpr_write_b32 a209, v22
    v_accvgpr_write_b32 a210, v22
    v_accvgpr_write_b32 a211, v22
    v_mfma_f32_32x32x16_bf16 v[128:143], a[212:215], a[212:215], 0
    v_mfma_f32_32x32x16_bf16 v[144:159], a[212:215], a[212:215], 0
    v_mfma_f32_32x32x16_bf16 v[160:175], a[212:215], a[212:215], 0
    v_mfma_f32_32x32x16_bf16 v[176:191], a[212:215], a[212:215], 0
    v_mfma_f32_32x32x16_bf16 v[192:207], a[212:215], a[212:215], 0
    v_mfma_f32_32x32x16_bf16 v[208:223], a[212:215], a[212:215], 0
    v_mfma_f32_32x32x16_bf16 v[224:239], a[212:215], a[212:215], 0
    v_mfma_f32_32x32x16_bf16 v[240:255], a[212:215], a[212:215], 0
    v_mfma_f32_32x32x16_bf16 a[192:207], a[212:215], a[212:215], 0
    v_lshrrev_b32 v20, 5, v18
    v_bfe_u32 v23, v18, 4, 1
    v_lshlrev_b32 v22, 3, v23
    v_lshl_add_u32 v22, v21, 8, v22
    v_add_u32 v22, s30, v22
    s_lshl_b32 s28, s3, 14
    v_xor_b32 v20, v20, v21
    v_xor_b32 v23, 0, v20
    v_lshl_add_u32 v26, v23, 4, v22
    v_xor_b32 v23, 2, v20
    v_lshl_add_u32 v27, v23, 4, v22
    v_xor_b32 v23, 4, v20
    v_lshl_add_u32 v28, v23, 4, v22
    v_xor_b32 v23, 6, v20
    v_lshl_add_u32 v29, v23, 4, v22
    v_xor_b32 v23, 8, v20
    v_lshl_add_u32 v30, v23, 4, v22
    v_xor_b32 v23, 10, v20
    v_lshl_add_u32 v31, v23, 4, v22
    v_xor_b32 v23, 12, v20
    v_lshl_add_u32 v19, v23, 4, v22
    v_xor_b32 v23, 14, v20
    v_lshl_add_u32 v108, v23, 4, v22
    v_lshl_add_u32 v109, v18, 4, s28
    s_movk_i32 s8, 4096
    s_movk_i32 s9, 8192
    s_movk_i32 s10, 12288
    s_mov_b32 s34, 0x3e0293ee
    s_mov_b32 s35, 0x5d800000
    s_mov_b32 s31, 0xffff0000
    s_mov_b32 s33, 1
    s_mov_b32 s5, 0x8000
    s_mov_b32 s4, 0x4000
    s_add_u32 s6, s30, 98304
    s_add_u32 s7, s30, 0
    s_cmp_eq_u32 s11, 0
    s_cbranch_scc1 L_hE
    s_add_u32 m0, s30, 65536
    s_nop 0
    buffer_load_dwordx4 v16, s[16:19], s32 offen offset:0 nt lds
    buffer_load_dwordx4 v17, s[16:19], s32 offen offset:1024 nt lds
    buffer_load_dwordx4 v16, s[16:19], s32 offen offset:2048 nt lds
    buffer_load_dwordx4 v17, s[16:19], s32 offen offset:3072 nt lds
    s_or_b32 s32, s32, 98304
    s_add_u32 s32, s32, 4096
    s_andn2_b32 s32, s32, 98304
    s_cmp_eq_u32 s3, 3
    s_cbranch_scc1 S_A3O
    s_branch S_A4O
L_hE:
    s_cmp_eq_u32 s3, 3
    s_cbranch_scc1 S_A3E
    s_branch S_A4E
Z_head:
.p2align 6
T_B4E:
    s_branch L_backE
    s_nop 0
S_B4E:
    s_waitcnt vmcnt(4)
    ds_read_b128 v[112:115], v100 offset:32768
    ds_read_b128 v[116:119], v101 offset:32768
    ds_read_b128 v[120:123], v102 offset:32768
    ds_read_b128 v[124:127], v103 offset:32768
    v_max3_f32 v24, v32, v33, v34
    v_max3_f32 v25, v35, v36, v37
    v_max3_f32 v24, v24, v38, v39
    v_max3_f32 v25, v25, v40, v41
    v_max3_f32 v24, v24, v42, v43
    v_max3_f32 v25, v25, v44, v45
    v_max3_f32 v24, v24, v46, v47
    v_max_f32 v24, v24, v25
    v_mov_b32 v25, v24
    s_nop 1
    v_permlane32_swap_b32 v24, v25
    v_max_f32 v24, v24, v25
    v_mov_b32 v25, v24
    s_nop 1
    v_permlane16_swap_b32 v24, v25
    v_max_f32 v24, v24, v25
    v_sub_f32 v32, v32, v24
    v_sub_f32 v33, v33, v24
    v_sub_f32 v34, v34, v24
    v_sub_f32 v35, v35, v24
    v_sub_f32 v36, v36, v24
    v_sub_f32 v37, v37, v24
    v_sub_f32 v38, v38, v24
    v_sub_f32 v39, v39, v24
    v_sub_f32 v40, v40, v24
    v_sub_f32 v41, v41, v24
    v_sub_f32 v42, v42, v24
    v_sub_f32 v43, v43, v24
    v_sub_f32 v44, v44, v24
    v_sub_f32 v45, v45, v24
    v_sub_f32 v46, v46, v24
    v_sub_f32 v47, v47, v24
    v_sub_f32 v88, 0, v24
    v_sub_f32 v89, 0, v24
    v_sub_f32 v90, 0, v24
    v_sub_f32 v91, 0, v24
    s_waitcnt lgkmcnt(3)
    v_mfma_f32_16x16x32_bf16 v[160:163], a[128:131], v[72:75], v[160:163]
    v_lshlrev_b32 v20, 16, v112
    v_and_b32 v21, s31, v112
    v_lshlrev_b32 v22, 16, v113
    v_and_b32 v23, s31, v113
    v_mul_f32 v20, s34, v20
    v_mul_f32 v21, s34, v21
    v_mfma_f32_16x16x32_bf16 v[160:163], a[160:163], v[76:79], v[160:163]
    v_mul_f32 v22, s34, v22
    v_mul_f32 v23, s34, v23
    v_cvt_pk_bf16_f32 v20, v20, v21
    v_cvt_pk_bf16_f32 v22, v22, v23
    v_accvgpr_write_b32 a48, v20
    v_accvgpr_write_b32 a49, v22
    v_mfma_f32_16x16x32_bf16 v[164:167], a[164:167], v[76:79], v[164:167]
    v_lshlrev_b32 v20, 16, v114
    v_and_b32 v21, s31, v114
    v_lshlrev_b32 v22, 16, v115
    v_and_b32 v23, s31, v115
    v_mul_f32 v20, s34, v20
    v_mul_f32 v21, s34, v21
    v_mfma_f32_16x16x32_bf16 v[164:167], a[132:135], v[72:75], v[164:167]
    v_mul_f32 v22, s34, v22
    v_mul_f32 v23, s34, v23
    v_cvt_pk_bf16_f32 v20, v20, v21
    v_cvt_pk_bf16_f32 v22, v22, v23
    v_accvgpr_write_b32 a50, v20
    v_accvgpr_write_b32 a51, v22
    s_waitcnt lgkmcnt(2)
    v_mfma_f32_16x16x32_bf16 v[168:171], a[136:139], v[72:75], v[168:171]
    v_lshlrev_b32 v20, 16, v116
    v_and_b32 v21, s31, v116
    v_lshlrev_b32 v22, 16, v117
    v_and_b32 v23, s31, v117
    v_mul_f32 v20, s34, v20
    v_mul_f32 v21, s34, v21
    v_mfma_f32_16x16x32_bf16 v[168:171], a[168:171], v[76:79], v[168:171]
    v_mul_f32 v22, s34, v22
    v_mul_f32 v23, s34, v23
    v_cvt_pk_bf16_f32 v20, v20, v21
    v_cvt_pk_bf16_f32 v22, v22, v23
    v_accvgpr_write_b32 a52, v20
    v_accvgpr_write_b32 a53, v22
    v_mfma_f32_16x16x32_bf16 v[172:175], a[172:175], v[76:79], v[172:175]
    v_lshlrev_b32 v20, 16, v118
    v_and_b32 v21, s31, v118
    v_lshlrev_b32 v22, 16, v119
    v_and_b32 v23, s31, v119
    v_mul_f32 v20, s34, v20
    v_mul_f32 v21, s34, v21
    v_mfma_f32_16x16x32_bf16 v[172:175], a[140:143], v[72:75], v[172:175]
    v_mul_f32 v22, s34, v22
    v_mul_f32 v23, s34, v23
    v_cvt_pk_bf16_f32 v20, v20, v21
    v_cvt_pk_bf16_f32 v22, v22, v23
    v_mfma_f32_16x16x32_bf16 v[176:179], a[144:147], v[72:75], v[176:179]
    v_accvgpr_write_b32 a54, v20
    v_accvgpr_write_b32 a55, v22
    s_waitcnt lgkmcnt(1)
    v_mfma_f32_16x16x32_bf16 v[176:179], a[176:179], v[76:79], v[176:179]
    v_lshlrev_b32 v20, 16, v120
    v_and_b32 v21, s31, v120
    v_lshlrev_b32 v22, 16, v121
    v_and_b32 v23, s31, v121
    v_mul_f32 v20, s34, v20
    v_mul_f32 v21, s34, v21
    v_mfma_f32_16x16x32_bf16 v[180:183], a[180:183], v[76:79], v[180:183]
    v_mul_f32 v22, s34, v22
    v_mul_f32 v23, s34, v23
    v_cvt_pk_bf16_f32 v20, v20, v21
    v_cvt_pk_bf16_f32 v22, v22, v23
    v_accvgpr_write_b32 a56, v20
    v_accvgpr_write_b32 a57, v22
    v_mfma_f32_16x16x32_bf16 v[180:183], a[148:151], v[72:75], v[180:183]
    v_lshlrev_b32 v20, 16, v122
    v_and_b32 v21, s31, v122
    v_lshlrev_b32 v22, 16, v123
    v_and_b32 v23, s31, v123
    v_mul_f32 v20, s34, v20
    v_mul_f32 v21, s34, v21
    v_mfma_f32_16x16x32_bf16 v[184:187], a[152:155], v[72:75], v[184:187]
    v_mul_f32 v22, s34, v22
    v_mul_f32 v23, s34, v23
    v_cvt_pk_bf16_f32 v20, v20, v21
    v_cvt_pk_bf16_f32 v22, v22, v23
    v_accvgpr_write_b32 a58, v20
    v_accvgpr_write_b32 a59, v22
    s_waitcnt lgkmcnt(0)
    s_add_u32 m0, s30, 81920
    s_nop 0
    buffer_load_dwordx4 v16, s[16:19], s32 offen offset:0 nt lds
    buffer_load_dwordx4 v17, s[16:19], s32 offen offset:1024 nt lds
    buffer_load_dwordx4 v16, s[16:19], s32 offen offset:2048 nt lds
    buffer_load_dwordx4 v17, s[16:19], s32 offen offset:3072 nt lds
    s_or_b32 s32, s32, 98304
    s_add_u32 s32, s32, 4096
    s_andn2_b32 s32, s32, 98304
    v_mfma_f32_16x16x32_bf16 v[184:187], a[184:187], v[76:79], v[184:187]
    v_lshlrev_b32 v20, 16, v124
    v_and_b32 v21, s31, v124
    v_lshlrev_b32 v22, 16, v125
    v_and_b32 v23, s31, v125
    v_mul_f32 v20, s34, v20
    v_mul_f32 v21, s34, v21
    v_mfma_f32_16x16x32_bf16 v[188:191], a[188:191], v[76:79], v[188:191]
    v_mul_f32 v22, s34, v22
    v_mul_f32 v23, s34, v23
    v_cvt_pk_bf16_f32 v20, v20, v21
    v_cvt_pk_bf16_f32 v22, v22, v23
    v_accvgpr_write_b32 a60, v20
    v_accvgpr_write_b32 a61, v22
    v_mfma_f32_16x16x32_bf16 v[188:191], a[156:159], v[72:75], v[188:191]
    v_lshlrev_b32 v20, 16, v126
    v_and_b32 v21, s31, v126
    v_lshlrev_b32 v22, 16, v127
    v_and_b32 v23, s31, v127
    v_mul_f32 v20, s34, v20
    v_mul_f32 v21, s34, v21
    v_smfmac_f32_16x16x64_bf16 a[196:199], a[208:211], v[72:79], v111
    v_mul_f32 v22, s34, v22
    v_mul_f32 v23, s34, v23
    v_cvt_pk_bf16_f32 v20, v20, v21
    v_cvt_pk_bf16_f32 v22, v22, v23
    v_accvgpr_write_b32 a62, v20
    v_accvgpr_write_b32 a63, v22
    s_nop 1
    v_mfma_f32_16x16x32_bf16 v[48:51], a[64:67], a[48:51], 0
    v_exp_f32 v32, v32
    v_mfma_f32_16x16x32_bf16 v[48:51], a[68:71], a[52:55], v[48:51]
    v_exp_f32 v33, v33
    v_mfma_f32_16x16x32_bf16 v[48:51], a[72:75], a[56:59], v[48:51]
    v_exp_f32 v34, v34
    v_cvt_pk_bf16_f32 v64, v32, v33
    v_mfma_f32_16x16x32_bf16 v[48:51], a[76:79], a[60:63], v[48:51]
    v_exp_f32 v35, v35
    v_mfma_f32_16x16x32_bf16 v[52:55], a[92:95], a[60:63], 0
    v_exp_f32 v36, v36
    v_cvt_pk_bf16_f32 v65, v34, v35
    v_mfma_f32_16x16x32_bf16 v[52:55], a[88:91], a[56:59], v[52:55]
    v_exp_f32 v37, v37
    v_mfma_f32_16x16x32_bf16 v[52:55], a[84:87], a[52:55], v[52:55]
    v_exp_f32 v38, v38
    v_cvt_pk_bf16_f32 v66, v36, v37
    v_mfma_f32_16x16x32_bf16 v[52:55], a[80:83], a[48:51], v[52:55]
    v_exp_f32 v39, v39
    v_mfma_f32_16x16x32_bf16 v[56:59], a[96:99], a[48:51], 0
    v_exp_f32 v40, v40
    v_cvt_pk_bf16_f32 v67, v38, v39
    v_mfma_f32_16x16x32_bf16 v[56:59], a[100:103], a[52:55], v[56:59]
    v_exp_f32 v41, v41
    v_mfma_f32_16x16x32_bf16 v[56:59], a[104:107], a[56:59], v[56:59]
    v_exp_f32 v42, v42
    v_cvt_pk_bf16_f32 v68, v40, v41
    v_mfma_f32_16x16x32_bf16 v[56:59], a[108:111], a[60:63], v[56:59]
    v_exp_f32 v43, v43
    v_mfma_f32_16x16x32_bf16 v[60:63], a[124:127], a[60:63], 0
    v_exp_f32 v44, v44
    v_cvt_pk_bf16_f32 v69, v42, v43
    v_mfma_f32_16x16x32_bf16 v[60:63], a[120:123], a[56:59], v[60:63]
    v_exp_f32 v45, v45
    v_mfma_f32_16x16x32_bf16 v[60:63], a[116:119], a[52:55], v[60:63]
    v_exp_f32 v46, v46
    v_cvt_pk_bf16_f32 v70, v44, v45
    v_mfma_f32_16x16x32_bf16 v[60:63], a[112:115], a[48:51], v[60:63]
    v_exp_f32 v47, v47
    s_nop 0
    v_cvt_pk_bf16_f32 v71, v46, v47
    s_waitcnt vmcnt(4)
    s_barrier
    ds_read_b128 a[64:67], v0 offset:16384
    ds_read_b128 a[68:71], v1 offset:16384
    ds_read_b128 a[72:75], v2 offset:16384
    ds_read_b128 a[76:79], v3 offset:16384
    ds_read_b128 a[80:83], v0 offset:20480
    ds_read_b128 a[84:87], v1 offset:20480
    ds_read_b128 a[88:91], v2 offset:20480
    ds_read_b128 a[92:95], v3 offset:20480
    ds_read_b128 a[96:99], v0 offset:24576
    ds_read_b128 a[100:103], v1 offset:24576
    ds_read_b128 a[104:107], v2 offset:24576
    ds_read_b128 a[108:111], v3 offset:24576
    ds_read_b128 a[112:115], v0 offset:28672
    ds_read_b128 a[116:119], v1 offset:28672
    ds_read_b128 a[120:123], v2 offset:28672
    ds_read_b128 a[124:127], v3 offset:28672
    s_add_u32 m0, s30, 49152
    s_nop 0
    buffer_load_dwordx4 v12, s[12:15], s32 offen offset:0 nt lds
    buffer_load_dwordx4 v13, s[12:15], s32 offen offset:1024 nt lds
    buffer_load_dwordx4 v14, s[12:15], s32 offen offset:2048 nt lds
    buffer_load_dwordx4 v15, s[12:15], s32 offen offset:3072 nt lds
    v_max3_f32 v24, v48, v49, v50
    v_max3_f32 v25, v51, v52, v53
    v_max3_f32 v24, v24, v54, v55
    v_max3_f32 v25, v25, v56, v57
    v_max3_f32 v24, v24, v58, v59
    v_max3_f32 v25, v25, v60, v61
    v_max3_f32 v24, v24, v62, v63
    v_max_f32 v24, v24, v25
    v_mov_b32 v25, v24
    s_nop 1
    v_permlane32_swap_b32 v24, v25
    v_max_f32 v24, v24, v25
    v_mov_b32 v25, v24
    s_nop 1
    v_permlane16_swap_b32 v24, v25
    v_max_f32 v24, v24, v25
    v_sub_f32 v48, v48, v24
    v_sub_f32 v49, v49, v24
    v_sub_f32 v50, v50, v24
    v_sub_f32 v51, v51, v24
    v_sub_f32 v52, v52, v24
    v_sub_f32 v53, v53, v24
    v_sub_f32 v54, v54, v24
    v_sub_f32 v55, v55, v24
    v_sub_f32 v56, v56, v24
    v_sub_f32 v57, v57, v24
    v_sub_f32 v58, v58, v24
    v_sub_f32 v59, v59, v24
    v_sub_f32 v60, v60, v24
    v_sub_f32 v61, v61, v24
    v_sub_f32 v62, v62, v24
    v_sub_f32 v63, v63, v24
    v_sub_f32 v92, 0, v24
    v_sub_f32 v93, 0, v24
    v_sub_f32 v94, 0, v24
    v_sub_f32 v95, 0, v24
    s_add_u32 m0, s30, 114688
    s_nop 0
    buffer_load_dwordx4 v16, s[16:19], s32 offen offset:0 nt lds
    buffer_load_dwordx4 v17, s[16:19], s32 offen offset:1024 nt lds
    buffer_load_dwordx4 v16, s[16:19], s32 offen offset:2048 nt lds
    buffer_load_dwordx4 v17, s[16:19], s32 offen offset:3072 nt lds
    s_or_b32 s32, s32, 98304
    s_add_u32 s32, s32, 4096
    s_andn2_b32 s32, s32, 98304
    s_add_u32 m0, s30, 32768
    s_nop 0
    buffer_load_dwordx4 v12, s[12:15], s32 offen offset:0 nt lds
    buffer_load_dwordx4 v13, s[12:15], s32 offen offset:1024 nt lds
    buffer_load_dwordx4 v14, s[12:15], s32 offen offset:2048 nt lds
    buffer_load_dwordx4 v15, s[12:15], s32 offen offset:3072 nt lds
    s_add_u32 m0, s30, 98304
    s_nop 0
    buffer_load_dwordx4 v16, s[16:19], s32 offen offset:0 nt lds
    buffer_load_dwordx4 v17, s[16:19], s32 offen offset:1024 nt lds
    buffer_load_dwordx4 v16, s[16:19], s32 offen offset:2048 nt lds
    buffer_load_dwordx4 v17, s[16:19], s32 offen offset:3072 nt lds
    s_or_b32 s32, s32, 98304
    s_add_u32 s32, s32, 4096
    s_andn2_b32 s32, s32, 98304
    s_add_u32 m0, s30, 0
    s_nop 0
    buffer_load_dwordx4 v12, s[12:15], s32 offen offset:0 nt lds
    buffer_load_dwordx4 v13, s[12:15], s32 offen offset:1024 nt lds
    buffer_load_dwordx4 v14, s[12:15], s32 offen offset:2048 nt lds
    buffer_load_dwordx4 v15, s[12:15], s32 offen offset:3072 nt lds
    s_sub_u32 s28, s30, s37
    v_add_u32 v100, s28, v12
    v_add_u32 v101, s28, v13
    v_add_u32 v102, s28, v14
    v_add_u32 v103, s28, v15
    v_xor_b32 v0, 16384, v0
    v_xor_b32 v1, 16384, v1
    v_xor_b32 v2, 16384, v2
    v_xor_b32 v3, 16384, v3
    s_waitcnt lgkmcnt(0)
    s_branch S_W4
Z_B4E:
.p2align 12
T_A4E:
    s_branch L_backE
    s_nop 0
S_A4E:
    s_waitcnt vmcnt(4)
    s_barrier
    ds_read_b128 a[64:67], v0 offset:0
    ds_read_b128 a[68:71], v1 offset:0
    ds_read_b128 a[72:75], v2 offset:0
    ds_read_b128 a[76:79], v3 offset:0
    ds_read_b128 a[80:83], v0 offset:4096
    ds_read_b128 a[84:87], v1 offset:4096
    ds_read_b128 a[88:91], v2 offset:4096
    ds_read_b128 a[92:95], v3 offset:4096
    ds_read_b128 a[96:99], v0 offset:8192
    ds_read_b128 a[100:103], v1 offset:8192
    ds_read_b128 a[104:107], v2 offset:8192
    ds_read_b128 a[108:111], v3 offset:8192
    ds_read_b128 a[112:115], v0 offset:12288
    ds_read_b128 a[116:119], v1 offset:12288
    ds_read_b128 a[120:123], v2 offset:12288
    ds_read_b128 a[124:127], v3 offset:12288
    s_add_u32 m0, s30, 114688
    s_add_u32 s29, s39, 4096
    buffer_load_dwordx4 v72, s[20:23], s29 offen offset:0 nt lds
    buffer_load_dwordx4 v73, s[20:23], s29 offen offset:1024 nt lds
    buffer_load_dwordx4 v74, s[20:23], s29 offen offset:2048 nt lds
    buffer_load_dwordx4 v75, s[20:23], s29 offen offset:3072 nt lds
    s_waitcnt vmcnt(4)
    ds_read_b128 v[112:115], v96 offset:49152
    ds_read_b128 v[116:119], v97 offset:49152
    ds_read_b128 v[120:123], v98 offset:49152
    ds_read_b128 v[124:127], v99 offset:49152
    s_waitcnt lgkmcnt(3)
    v_lshlrev_b32 v20, 16, v112
    v_and_b32 v21, s31, v112
    v_lshlrev_b32 v22, 16, v113
    v_and_b32 v23, s31, v113
    v_pk_mul_f32 v[20:21], v[20:21], s[34:35] op_sel_hi:[1,0]
    v_pk_mul_f32 v[22:23], v[22:23], s[34:35] op_sel_hi:[1,0]
    v_cvt_pk_bf16_f32 v20, v20, v21
    v_cvt_pk_bf16_f32 v22, v22, v23
    v_accvgpr_write_b32 a0, v20
    v_accvgpr_write_b32 a1, v22
    v_lshlrev_b32 v20, 16, v114
    v_and_b32 v21, s31, v114
    v_lshlrev_b32 v22, 16, v115
    v_and_b32 v23, s31, v115
    v_pk_mul_f32 v[20:21], v[20:21], s[34:35] op_sel_hi:[1,0]
    v_pk_mul_f32 v[22:23], v[22:23], s[34:35] op_sel_hi:[1,0]
    v_cvt_pk_bf16_f32 v20, v20, v21
    v_cvt_pk_bf16_f32 v22, v22, v23
    v_accvgpr_write_b32 a2, v20
    v_accvgpr_write_b32 a3, v22
    s_waitcnt lgkmcnt(2)
    v_lshlrev_b32 v20, 16, v116
    v_and_b32 v21, s31, v116
    v_lshlrev_b32 v22, 16, v117
    v_and_b32 v23, s31, v117
    v_pk_mul_f32 v[20:21], v[20:21], s[34:35] op_sel_hi:[1,0]
    v_pk_mul_f32 v[22:23], v[22:23], s[34:35] op_sel_hi:[1,0]
    v_cvt_pk_bf16_f32 v20, v20, v21
    v_cvt_pk_bf16_f32 v22, v22, v23
    v_accvgpr_write_b32 a4, v20
    v_accvgpr_write_b32 a5, v22
    v_lshlrev_b32 v20, 16, v118
    v_and_b32 v21, s31, v118
    v_lshlrev_b32 v22, 16, v119
    v_and_b32 v23, s31, v119
    v_pk_mul_f32 v[20:21], v[20:21], s[34:35] op_sel_hi:[1,0]
    v_pk_mul_f32 v[22:23], v[22:23], s[34:35] op_sel_hi:[1,0]
    v_cvt_pk_bf16_f32 v20, v20, v21
    v_cvt_pk_bf16_f32 v22, v22, v23
    v_accvgpr_write_b32 a6, v20
    v_accvgpr_write_b32 a7, v22
    s_waitcnt lgkmcnt(1)
    v_lshlrev_b32 v20, 16, v120
    v_and_b32 v21, s31, v120
    v_lshlrev_b32 v22, 16, v121
    v_and_b32 v23, s31, v121
    v_pk_mul_f32 v[20:21], v[20:21], s[34:35] op_sel_hi:[1,0]
    v_pk_mul_f32 v[22:23], v[22:23], s[34:35] op_sel_hi:[1,0]
    v_cvt_pk_bf16_f32 v20, v20, v21
    v_cvt_pk_bf16_f32 v22, v22, v23
    v_accvgpr_write_b32 a8, v20
    v_accvgpr_write_b32 a9, v22
    v_lshlrev_b32 v20, 16, v122
    v_and_b32 v21, s31, v122
    v_lshlrev_b32 v22, 16, v123
    v_and_b32 v23, s31, v123
    v_pk_mul_f32 v[20:21], v[20:21], s[34:35] op_sel_hi:[1,0]
    v_pk_mul_f32 v[22:23], v[22:23], s[34:35] op_sel_hi:[1,0]
    v_cvt_pk_bf16_f32 v20, v20, v21
    v_cvt_pk_bf16_f32 v22, v22, v23
    v_accvgpr_write_b32 a10, v20
    v_accvgpr_write_b32 a11, v22
    s_waitcnt lgkmcnt(0)
    s_add_u32 m0, s30, 65536
    s_nop 0
    buffer_load_dwordx4 v16, s[16:19], s32 offen offset:0 nt lds
    buffer_load_dwordx4 v17, s[16:19], s32 offen offset:1024 nt lds
    buffer_load_dwordx4 v16, s[16:19], s32 offen offset:2048 nt lds
    buffer_load_dwordx4 v17, s[16:19], s32 offen offset:3072 nt lds
    s_or_b32 s32, s32, 98304
    s_add_u32 s32, s32, 4096
    s_andn2_b32 s32, s32, 98304
    v_lshlrev_b32 v20, 16, v124
    v_and_b32 v21, s31, v124
    v_lshlrev_b32 v22, 16, v125
    v_and_b32 v23, s31, v125
    v_pk_mul_f32 v[20:21], v[20:21], s[34:35] op_sel_hi:[1,0]
    v_pk_mul_f32 v[22:23], v[22:23], s[34:35] op_sel_hi:[1,0]
    v_cvt_pk_bf16_f32 v20, v20, v21
    v_cvt_pk_bf16_f32 v22, v22, v23
    v_accvgpr_write_b32 a12, v20
    v_accvgpr_write_b32 a13, v22
    v_lshlrev_b32 v20, 16, v126
    v_and_b32 v21, s31, v126
    v_lshlrev_b32 v22, 16, v127
    v_and_b32 v23, s31, v127
    v_pk_mul_f32 v[20:21], v[20:21], s[34:35] op_sel_hi:[1,0]
    v_pk_mul_f32 v[22:23], v[22:23], s[34:35] op_sel_hi:[1,0]
    v_cvt_pk_bf16_f32 v20, v20, v21
    v_cvt_pk_bf16_f32 v22, v22, v23
    v_accvgpr_write_b32 a14, v20
    v_accvgpr_write_b32 a15, v22
    s_nop 1
    v_mfma_f32_16x16x32_bf16 v[32:35], a[64:67], a[0:3], 0
    v_mfma_f32_16x16x32_bf16 v[32:35], a[68:71], a[4:7], v[32:35]
    v_mfma_f32_16x16x32_bf16 v[32:35], a[72:75], a[8:11], v[32:35]
    v_mfma_f32_16x16x32_bf16 v[32:35], a[76:79], a[12:15], v[32:35]
    v_mfma_f32_16x16x32_bf16 v[36:39], a[92:95], a[12:15], 0
    v_mfma_f32_16x16x32_bf16 v[36:39], a[88:91], a[8:11], v[36:39]
    v_mfma_f32_16x16x32_bf16 v[36:39], a[84:87], a[4:7], v[36:39]
    v_mfma_f32_16x16x32_bf16 v[36:39], a[80:83], a[0:3], v[36:39]
    v_mfma_f32_16x16x32_bf16 v[40:43], a[96:99], a[0:3], 0
    v_mfma_f32_16x16x32_bf16 v[40:43], a[100:103], a[4:7], v[40:43]
    v_mfma_f32_16x16x32_bf16 v[40:43], a[104:107], a[8:11], v[40:43]
    v_mfma_f32_16x16x32_bf16 v[40:43], a[108:111], a[12:15], v[40:43]
    v_mfma_f32_16x16x32_bf16 v[44:47], a[124:127], a[12:15], 0
    v_mfma_f32_16x16x32_bf16 v[44:47], a[120:123], a[8:11], v[44:47]
    v_mfma_f32_16x16x32_bf16 v[44:47], a[116:119], a[4:7], v[44:47]
    v_mfma_f32_16x16x32_bf16 v[44:47], a[112:115], a[0:3], v[44:47]
    s_waitcnt vmcnt(4)
    ds_read_b128 v[112:115], v100 offset:49152
    ds_read_b128 v[116:119], v101 offset:49152
    ds_read_b128 v[120:123], v102 offset:49152
    ds_read_b128 v[124:127], v103 offset:49152
    v_max3_f32 v24, v32, v33, v34
    v_max3_f32 v25, v35, v36, v37
    v_max3_f32 v24, v24, v38, v39
    v_max3_f32 v25, v25, v40, v41
    v_max3_f32 v24, v24, v42, v43
    v_max3_f32 v25, v25, v44, v45
    v_max3_f32 v24, v24, v46, v47
    v_max_f32 v24, v24, v25
    v_mov_b32 v25, v24
    s_nop 1
    v_permlane32_swap_b32 v24, v25
    v_max_f32 v24, v24, v25
    v_mov_b32 v25, v24
    s_nop 1
    v_permlane16_swap_b32 v24, v25
    v_max_f32 v24, v24, v25
    v_sub_f32 v32, v32, v24
    v_sub_f32 v33, v33, v24
    v_sub_f32 v34, v34, v24
    v_sub_f32 v35, v35, v24
    v_sub_f32 v36, v36, v24
    v_sub_f32 v37, v37, v24
    v_sub_f32 v38, v38, v24
    v_sub_f32 v39, v39, v24
    v_sub_f32 v40, v40, v24
    v_sub_f32 v41, v41, v24
    v_sub_f32 v42, v42, v24
    v_sub_f32 v43, v43, v24
    v_sub_f32 v44, v44, v24
    v_sub_f32 v45, v45, v24
    v_sub_f32 v46, v46, v24
    v_sub_f32 v47, v47, v24
    v_sub_f32 v80, 0, v24
    v_sub_f32 v81, 0, v24
    v_sub_f32 v82, 0, v24
    v_sub_f32 v83, 0, v24
    s_waitcnt lgkmcnt(3)
    v_lshlrev_b32 v20, 16, v112
    v_and_b32 v21, s31, v112
    v_lshlrev_b32 v22, 16, v113
    v_and_b32 v23, s31, v113
    v_pk_mul_f32 v[20:21], v[20:21], s[34:35] op_sel_hi:[1,0]
    v_pk_mul_f32 v[22:23], v[22:23], s[34:35] op_sel_hi:[1,0]
    v_cvt_pk_bf16_f32 v20, v20, v21
    v_cvt_pk_bf16_f32 v22, v22, v23
    v_accvgpr_write_b32 a16, v20
    v_accvgpr_write_b32 a17, v22
    v_lshlrev_b32 v20, 16, v114
    v_and_b32 v21, s31, v114
    v_lshlrev_b32 v22, 16, v115
    v_and_b32 v23, s31, v115
    v_pk_mul_f32 v[20:21], v[20:21], s[34:35] op_sel_hi:[1,0]
    v_pk_mul_f32 v[22:23], v[22:23], s[34:35] op_sel_hi:[1,0]
    v_cvt_pk_bf16_f32 v20, v20, v21
    v_cvt_pk_bf16_f32 v22, v22, v23
    v_accvgpr_write_b32 a18, v20
    v_accvgpr_write_b32 a19, v22
    s_waitcnt lgkmcnt(2)
    v_lshlrev_b32 v20, 16, v116
    v_and_b32 v21, s31, v116
    v_lshlrev_b32 v22, 16, v117
    v_and_b32 v23, s31, v117
    v_pk_mul_f32 v[20:21], v[20:21], s[34:35] op_sel_hi:[1,0]
    v_pk_mul_f32 v[22:23], v[22:23], s[34:35] op_sel_hi:[1,0]
    v_cvt_pk_bf16_f32 v20, v20, v21
    v_cvt_pk_bf16_f32 v22, v22, v23
    v_accvgpr_write_b32 a20, v20
    v_accvgpr_write_b32 a21, v22
    v_lshlrev_b32 v20, 16, v118
    v_and_b32 v21, s31, v118
    v_lshlrev_b32 v22, 16, v119
    v_and_b32 v23, s31, v119
    v_pk_mul_f32 v[20:21], v[20:21], s[34:35] op_sel_hi:[1,0]
    v_pk_mul_f32 v[22:23], v[22:23], s[34:35] op_sel_hi:[1,0]
    v_cvt_pk_bf16_f32 v20, v20, v21
    v_cvt_pk_bf16_f32 v22, v22, v23
    v_accvgpr_write_b32 a22, v20
    v_accvgpr_write_b32 a23, v22
    s_waitcnt lgkmcnt(1)
    v_lshlrev_b32 v20, 16, v120
    v_and_b32 v21, s31, v120
    v_lshlrev_b32 v22, 16, v121
    v_and_b32 v23, s31, v121
    v_pk_mul_f32 v[20:21], v[20:21], s[34:35] op_sel_hi:[1,0]
    v_pk_mul_f32 v[22:23], v[22:23], s[34:35] op_sel_hi:[1,0]
    v_cvt_pk_bf16_f32 v20, v20, v21
    v_cvt_pk_bf16_f32 v22, v22, v23
    v_accvgpr_write_b32 a24, v20
    v_accvgpr_write_b32 a25, v22
    v_lshlrev_b32 v20, 16, v122
    v_and_b32 v21, s31, v122
    v_lshlrev_b32 v22, 16, v123
    v_and_b32 v23, s31, v123
    v_pk_mul_f32 v[20:21], v[20:21], s[34:35] op_sel_hi:[1,0]
    v_pk_mul_f32 v[22:23], v[22:23], s[34:35] op_sel_hi:[1,0]
    v_cvt_pk_bf16_f32 v20, v20, v21
    v_cvt_pk_bf16_f32 v22, v22, v23
    v_accvgpr_write_b32 a26, v20
    v_accvgpr_write_b32 a27, v22
    s_waitcnt lgkmcnt(0)
    s_add_u32 m0, s30, 32768
    s_add_u32 s29, s39, 8192
    buffer_load_dwordx4 v72, s[20:23], s29 offen offset:0 nt lds
    buffer_load_dwordx4 v73, s[20:23], s29 offen offset:1024 nt lds
    buffer_load_dwordx4 v74, s[20:23], s29 offen offset:2048 nt lds
    buffer_load_dwordx4 v75, s[20:23], s29 offen offset:3072 nt lds
    v_lshlrev_b32 v20, 16, v124
    v_and_b32 v21, s31, v124
    v_lshlrev_b32 v22, 16, v125
    v_and_b32 v23, s31, v125
    v_pk_mul_f32 v[20:21], v[20:21], s[34:35] op_sel_hi:[1,0]
    v_pk_mul_f32 v[22:23], v[22:23], s[34:35] op_sel_hi:[1,0]
    v_cvt_pk_bf16_f32 v20, v20, v21
    v_cvt_pk_bf16_f32 v22, v22, v23
    v_accvgpr_write_b32 a28, v20
    v_accvgpr_write_b32 a29, v22
    v_lshlrev_b32 v20, 16, v126
    v_and_b32 v21, s31, v126
    v_lshlrev_b32 v22, 16, v127
    v_and_b32 v23, s31, v127
    v_pk_mul_f32 v[20:21], v[20:21], s[34:35] op_sel_hi:[1,0]
    v_pk_mul_f32 v[22:23], v[22:23], s[34:35] op_sel_hi:[1,0]
    v_cvt_pk_bf16_f32 v20, v20, v21
    v_cvt_pk_bf16_f32 v22, v22, v23
    v_accvgpr_write_b32 a30, v20
    v_accvgpr_write_b32 a31, v22
    s_nop 1
    v_mfma_f32_16x16x32_bf16 v[48:51], a[64:67], a[16:19], 0
    v_exp_f32 v32, v32
    v_mfma_f32_16x16x32_bf16 v[48:51], a[68:71], a[20:23], v[48:51]
    v_exp_f32 v33, v33
    v_mfma_f32_16x16x32_bf16 v[48:51], a[72:75], a[24:27], v[48:51]
    v_exp_f32 v34, v34
    v_cvt_pk_bf16_f32 v64, v32, v33
    v_mfma_f32_16x16x32_bf16 v[48:51], a[76:79], a[28:31], v[48:51]
    v_exp_f32 v35, v35
    v_mfma_f32_16x16x32_bf16 v[52:55], a[92:95], a[28:31], 0
    v_exp_f32 v36, v36
    v_cvt_pk_bf16_f32 v65, v34, v35
    v_mfma_f32_16x16x32_bf16 v[52:55], a[88:91], a[24:27], v[52:55]
    v_exp_f32 v37, v37
    v_mfma_f32_16x16x32_bf16 v[52:55], a[84:87], a[20:23], v[52:55]
    v_exp_f32 v38, v38
    v_cvt_pk_bf16_f32 v66, v36, v37
    v_mfma_f32_16x16x32_bf16 v[52:55], a[80:83], a[16:19], v[52:55]
    v_exp_f32 v39, v39
    v_mfma_f32_16x16x32_bf16 v[56:59], a[96:99], a[16:19], 0
    v_exp_f32 v40, v40
    v_cvt_pk_bf16_f32 v67, v38, v39
    v_mfma_f32_16x16x32_bf16 v[56:59], a[100:103], a[20:23], v[56:59]
    v_exp_f32 v41, v41
    v_mfma_f32_16x16x32_bf16 v[56:59], a[104:107], a[24:27], v[56:59]
    v_exp_f32 v42, v42
    v_cvt_pk_bf16_f32 v68, v40, v41
    v_mfma_f32_16x16x32_bf16 v[56:59], a[108:111], a[28:31], v[56:59]
    v_exp_f32 v43, v43
    v_mfma_f32_16x16x32_bf16 v[60:63], a[124:127], a[28:31], 0
    v_exp_f32 v44, v44
    v_cvt_pk_bf16_f32 v69, v42, v43
    v_mfma_f32_16x16x32_bf16 v[60:63], a[120:123], a[24:27], v[60:63]
    v_exp_f32 v45, v45
    v_mfma_f32_16x16x32_bf16 v[60:63], a[116:119], a[20:23], v[60:63]
    v_exp_f32 v46, v46
    v_cvt_pk_bf16_f32 v70, v44, v45
    v_mfma_f32_16x16x32_bf16 v[60:63], a[112:115], a[16:19], v[60:63]
    v_exp_f32 v47, v47
    s_nop 0
    v_cvt_pk_bf16_f32 v71, v46, v47
    s_waitcnt vmcnt(4)
    s_barrier
    ds_read_b64_tr_b16 a[128:129], v4 offset:0
    ds_read_b64_tr_b16 a[130:131], v4 offset:4096
    ds_read_b64_tr_b16 a[160:161], v4 offset:8192
    ds_read_b64_tr_b16 a[162:163], v4 offset:12288
    ds_read_b64_tr_b16 a[132:133], v5 offset:0
    ds_read_b64_tr_b16 a[134:135], v5 offset:4096
    ds_read_b64_tr_b16 a[164:165], v5 offset:8192
    ds_read_b64_tr_b16 a[166:167], v5 offset:12288
    ds_read_b64_tr_b16 a[136:137], v6 offset:0
    ds_read_b64_tr_b16 a[138:139], v6 offset:4096
    ds_read_b64_tr_b16 a[168:169], v6 offset:8192
    ds_read_b64_tr_b16 a[170:171], v6 offset:12288
    ds_read_b64_tr_b16 a[140:141], v7 offset:0
    ds_read_b64_tr_b16 a[142:143], v7 offset:4096
    ds_read_b64_tr_b16 a[172:173], v7 offset:8192
    ds_read_b64_tr_b16 a[174:175], v7 offset:12288
    ds_read_b64_tr_b16 a[144:145], v8 offset:0
    ds_read_b64_tr_b16 a[146:147], v8 offset:4096
    ds_read_b64_tr_b16 a[176:177], v8 offset:8192
    ds_read_b64_tr_b16 a[178:179], v8 offset:12288
    ds_read_b64_tr_b16 a[148:149], v9 offset:0
    ds_read_b64_tr_b16 a[150:151], v9 offset:4096
    ds_read_b64_tr_b16 a[180:181], v9 offset:8192
    ds_read_b64_tr_b16 a[182:183], v9 offset:12288
    ds_read_b64_tr_b16 a[152:153], v10 offset:0
    ds_read_b64_tr_b16 a[154:155], v10 offset:4096
    ds_read_b64_tr_b16 a[184:185], v10 offset:8192
    ds_read_b64_tr_b16 a[186:187], v10 offset:12288
    ds_read_b64_tr_b16 a[156:157], v11 offset:0
    ds_read_b64_tr_b16 a[158:159], v11 offset:4096
    ds_read_b64_tr_b16 a[188:189], v11 offset:8192
    ds_read_b64_tr_b16 a[190:191], v11 offset:12288
    s_add_u32 m0, s30, 98304
    s_add_u32 s29, s39, 12288
    buffer_load_dwordx4 v72, s[20:23], s29 offen offset:0 nt lds
    buffer_load_dwordx4 v73, s[20:23], s29 offen offset:1024 nt lds
    buffer_load_dwordx4 v74, s[20:23], s29 offen offset:2048 nt lds
    buffer_load_dwordx4 v75, s[20:23], s29 offen offset:3072 nt lds
    s_waitcnt vmcnt(4)
    ds_read_b128 v[112:115], v96 offset:32768
    ds_read_b128 v[116:119], v97 offset:32768
    ds_read_b128 v[120:123], v98 offset:32768
    ds_read_b128 v[124:127], v99 offset:32768
    v_max3_f32 v24, v48, v49, v50
    v_max3_f32 v25, v51, v52, v53
    v_max3_f32 v24, v24, v54, v55
    v_max3_f32 v25, v25, v56, v57
    v_max3_f32 v24, v24, v58, v59
    v_max3_f32 v25, v25, v60, v61
    v_max3_f32 v24, v24, v62, v63
    v_max_f32 v24, v24, v25
    v_mov_b32 v25, v24
    s_nop 1
    v_permlane32_swap_b32 v24, v25
    v_max_f32 v24, v24, v25
    v_mov_b32 v25, v24
    s_nop 1
    v_permlane16_swap_b32 v24, v25
    v_max_f32 v24, v24, v25
    v_sub_f32 v48, v48, v24
    v_sub_f32 v49, v49, v24
    v_sub_f32 v50, v50, v24
    v_sub_f32 v51, v51, v24
    v_sub_f32 v52, v52, v24
    v_sub_f32 v53, v53, v24
    v_sub_f32 v54, v54, v24
    v_sub_f32 v55, v55, v24
    v_sub_f32 v56, v56, v24
    v_sub_f32 v57, v57, v24
    v_sub_f32 v58, v58, v24
    v_sub_f32 v59, v59, v24
    v_sub_f32 v60, v60, v24
    v_sub_f32 v61, v61, v24
    v_sub_f32 v62, v62, v24
    v_sub_f32 v63, v63, v24
    v_sub_f32 v84, 0, v24
    v_sub_f32 v85, 0, v24
    v_sub_f32 v86, 0, v24
    v_sub_f32 v87, 0, v24
    s_waitcnt lgkmcnt(3)
    v_mfma_f32_16x16x32_bf16 v[128:131], a[128:131], v[64:67], v[128:131]
    v_lshlrev_b32 v20, 16, v112
    v_and_b32 v21, s31, v112
    v_lshlrev_b32 v22, 16, v113
    v_and_b32 v23, s31, v113
    v_mul_f32 v20, s34, v20
    v_mul_f32 v21, s34, v21
    v_mfma_f32_16x16x32_bf16 v[128:131], a[160:163], v[68:71], v[128:131]
    v_mul_f32 v22, s34, v22
    v_mul_f32 v23, s34, v23
    v_cvt_pk_bf16_f32 v20, v20, v21
    v_cvt_pk_bf16_f32 v22, v22, v23
    v_accvgpr_write_b32 a32, v20
    v_accvgpr_write_b32 a33, v22
    v_mfma_f32_16x16x32_bf16 v[132:135], a[164:167], v[68:71], v[132:135]
    v_lshlrev_b32 v20, 16, v114
    v_and_b32 v21, s31, v114
    v_lshlrev_b32 v22, 16, v115
    v_and_b32 v23, s31, v115
    v_mul_f32 v20, s34, v20
    v_mul_f32 v21, s34, v21
    v_mfma_f32_16x16x32_bf16 v[132:135], a[132:135], v[64:67], v[132:135]
    v_mul_f32 v22, s34, v22
    v_mul_f32 v23, s34, v23
    v_cvt_pk_bf16_f32 v20, v20, v21
    v_cvt_pk_bf16_f32 v22, v22, v23
    v_accvgpr_write_b32 a34, v20
    v_accvgpr_write_b32 a35, v22
    s_waitcnt lgkmcnt(2)
    v_mfma_f32_16x16x32_bf16 v[136:139], a[136:139], v[64:67], v[136:139]
    v_lshlrev_b32 v20, 16, v116
    v_and_b32 v21, s31, v116
    v_lshlrev_b32 v22, 16, v117
    v_and_b32 v23, s31, v117
    v_mul_f32 v20, s34, v20
    v_mul_f32 v21, s34, v21
    v_mfma_f32_16x16x32_bf16 v[136:139], a[168:171], v[68:71], v[136:139]
    v_mul_f32 v22, s34, v22
    v_mul_f32 v23, s34, v23
    v_cvt_pk_bf16_f32 v20, v20, v21
    v_cvt_pk_bf16_f32 v22, v22, v23
    v_accvgpr_write_b32 a36, v20
    v_accvgpr_write_b32 a37, v22
    v_mfma_f32_16x16x32_bf16 v[140:143], a[172:175], v[68:71], v[140:143]
    v_lshlrev_b32 v20, 16, v118
    v_and_b32 v21, s31, v118
    v_lshlrev_b32 v22, 16, v119
    v_and_b32 v23, s31, v119
    v_mul_f32 v20, s34, v20
    v_mul_f32 v21, s34, v21
    v_mfma_f32_16x16x32_bf16 v[140:143], a[140:143], v[64:67], v[140:143]
    v_mul_f32 v22, s34, v22
    v_mul_f32 v23, s34, v23
    v_cvt_pk_bf16_f32 v20, v20, v21
    v_cvt_pk_bf16_f32 v22, v22, v23
    v_mfma_f32_16x16x32_bf16 v[144:147], a[144:147], v[64:67], v[144:147]
    v_accvgpr_write_b32 a38, v20
    v_accvgpr_write_b32 a39, v22
    s_waitcnt lgkmcnt(1)
    v_mfma_f32_16x16x32_bf16 v[144:147], a[176:179], v[68:71], v[144:147]
    v_lshlrev_b32 v20, 16, v120
    v_and_b32 v21, s31, v120
    v_lshlrev_b32 v22, 16, v121
    v_and_b32 v23, s31, v121
    v_mul_f32 v20, s34, v20
    v_mul_f32 v21, s34, v21
    v_mfma_f32_16x16x32_bf16 v[148:151], a[180:183], v[68:71], v[148:151]
    v_mul_f32 v22, s34, v22
    v_mul_f32 v23, s34, v23
    v_cvt_pk_bf16_f32 v20, v20, v21
    v_cvt_pk_bf16_f32 v22, v22, v23
    v_accvgpr_write_b32 a40, v20
    v_accvgpr_write_b32 a41, v22
    v_mfma_f32_16x16x32_bf16 v[148:151], a[148:151], v[64:67], v[148:151]
    v_lshlrev_b32 v20, 16, v122
    v_and_b32 v21, s31, v122
    v_lshlrev_b32 v22, 16, v123
    v_and_b32 v23, s31, v123
    v_mul_f32 v20, s34, v20
    v_mul_f32 v21, s34, v21
    v_mfma_f32_16x16x32_bf16 v[152:155], a[152:155], v[64:67], v[152:155]
    v_mul_f32 v22, s34, v22
    v_mul_f32 v23, s34, v23
    v_cvt_pk_bf16_f32 v20, v20, v21
    v_cvt_pk_bf16_f32 v22, v22, v23
    v_accvgpr_write_b32 a42, v20
    v_accvgpr_write_b32 a43, v22
    s_waitcnt lgkmcnt(0)
    s_add_u32 m0, s30, 16384
    s_nop 0
    buffer_load_dwordx4 v12, s[12:15], s32 offen offset:0 nt lds
    buffer_load_dwordx4 v13, s[12:15], s32 offen offset:1024 nt lds
    buffer_load_dwordx4 v14, s[12:15], s32 offen offset:2048 nt lds
    buffer_load_dwordx4 v15, s[12:15], s32 offen offset:3072 nt lds
    v_mfma_f32_16x16x32_bf16 v[152:155], a[184:187], v[68:71], v[152:155]
    v_lshlrev_b32 v20, 16, v124
    v_and_b32 v21, s31, v124
    v_lshlrev_b32 v22, 16, v125
    v_and_b32 v23, s31, v125
    v_mul_f32 v20, s34, v20
    v_mul_f32 v21, s34, v21
    v_mfma_f32_16x16x32_bf16 v[156:159], a[188:191], v[68:71], v[156:159]
    v_mul_f32 v22, s34, v22
    v_mul_f32 v23, s34, v23
    v_cvt_pk_bf16_f32 v20, v20, v21
    v_cvt_pk_bf16_f32 v22, v22, v23
    v_accvgpr_write_b32 a44, v20
    v_accvgpr_write_b32 a45, v22
    v_mfma_f32_16x16x32_bf16 v[156:159], a[156:159], v[64:67], v[156:159]
    v_lshlrev_b32 v20, 16, v126
    v_and_b32 v21, s31, v126
    v_lshlrev_b32 v22, 16, v127
    v_and_b32 v23, s31, v127
    v_mul_f32 v20, s34, v20
    v_mul_f32 v21, s34, v21
    v_smfmac_f32_16x16x64_bf16 a[192:195], a[208:211], v[64:71], v111
    v_mul_f32 v22, s34, v22
    v_mul_f32 v23, s34, v23
    v_cvt_pk_bf16_f32 v20, v20, v21
    v_cvt_pk_bf16_f32 v22, v22, v23
    v_accvgpr_write_b32 a46, v20
    v_accvgpr_write_b32 a47, v22
    s_nop 1
    v_mfma_f32_16x16x32_bf16 v[32:35], a[64:67], a[32:35], 0
    v_exp_f32 v48, v48
    v_mfma_f32_16x16x32_bf16 v[32:35], a[68:71], a[36:39], v[32:35]
    v_exp_f32 v49, v49
    v_mfma_f32_16x16x32_bf16 v[32:35], a[72:75], a[40:43], v[32:35]
    v_exp_f32 v50, v50
    v_cvt_pk_bf16_f32 v72, v48, v49
    v_mfma_f32_16x16x32_bf16 v[32:35], a[76:79], a[44:47], v[32:35]
    v_exp_f32 v51, v51
    v_mfma_f32_16x16x32_bf16 v[36:39], a[92:95], a[44:47], 0
    v_exp_f32 v52, v52
    v_cvt_pk_bf16_f32 v73, v50, v51
    v_mfma_f32_16x16x32_bf16 v[36:39], a[88:91], a[40:43], v[36:39]
    v_exp_f32 v53, v53
    v_mfma_f32_16x16x32_bf16 v[36:39], a[84:87], a[36:39], v[36:39]
    v_exp_f32 v54, v54
    v_cvt_pk_bf16_f32 v74, v52, v53
    v_mfma_f32_16x16x32_bf16 v[36:39], a[80:83], a[32:35], v[36:39]
    v_exp_f32 v55, v55
    v_mfma_f32_16x16x32_bf16 v[40:43], a[96:99], a[32:35], 0
    v_exp_f32 v56, v56
    v_cvt_pk_bf16_f32 v75, v54, v55
    v_mfma_f32_16x16x32_bf16 v[40:43], a[100:103], a[36:39], v[40:43]
    v_exp_f32 v57, v57
    v_mfma_f32_16x16x32_bf16 v[40:43], a[104:107], a[40:43], v[40:43]
    v_exp_f32 v58, v58
    v_cvt_pk_bf16_f32 v76, v56, v57
    v_mfma_f32_16x16x32_bf16 v[40:43], a[108:111], a[44:47], v[40:43]
    v_exp_f32 v59, v59
    v_mfma_f32_16x16x32_bf16 v[44:47], a[124:127], a[44:47], 0
    v_exp_f32 v60, v60
    v_cvt_pk_bf16_f32 v77, v58, v59
    v_mfma_f32_16x16x32_bf16 v[44:47], a[120:123], a[40:43], v[44:47]
    v_exp_f32 v61, v61
    v_mfma_f32_16x16x32_bf16 v[44:47], a[116:119], a[36:39], v[44:47]
    v_exp_f32 v62, v62
    v_cvt_pk_bf16_f32 v78, v60, v61
    v_mfma_f32_16x16x32_bf16 v[44:47], a[112:115], a[32:35], v[44:47]
    v_exp_f32 v63, v63
    s_nop 0
    v_cvt_pk_bf16_f32 v79, v62, v63
    s_branch S_B4E
Z_A4E:
.p2align 12
T_A4O:
    s_branch L_backE
    s_nop 0
S_A4O:
    s_waitcnt vmcnt(12)
    s_barrier
    ds_read_b128 a[64:67], v0 offset:0
    ds_read_b128 a[68:71], v1 offset:0
    ds_read_b128 a[72:75], v2 offset:0
    ds_read_b128 a[76:79], v3 offset:0
    ds_read_b128 a[80:83], v0 offset:4096
    ds_read_b128 a[84:87], v1 offset:4096
    ds_read_b128 a[88:91], v2 offset:4096
    ds_read_b128 a[92:95], v3 offset:4096
    ds_read_b128 a[96:99], v0 offset:8192
    ds_read_b128 a[100:103], v1 offset:8192
    ds_read_b128 a[104:107], v2 offset:8192
    ds_read_b128 a[108:111], v3 offset:8192
    ds_read_b128 a[112:115], v0 offset:12288
    ds_read_b128 a[116:119], v1 offset:12288
    ds_read_b128 a[120:123], v2 offset:12288
    ds_read_b128 a[124:127], v3 offset:12288
    s_add_u32 m0, s30, 32768
    s_add_u32 s29, s39, 8192
    buffer_load_dwordx4 v72, s[20:23], s29 offen offset:0 nt lds
    buffer_load_dwordx4 v73, s[20:23], s29 offen offset:1024 nt lds
    buffer_load_dwordx4 v74, s[20:23], s29 offen offset:2048 nt lds
    buffer_load_dwordx4 v75, s[20:23], s29 offen offset:3072 nt lds
    s_waitcnt vmcnt(12)
    ds_read_b128 v[112:115], v96 offset:49152
    ds_read_b128 v[116:119], v97 offset:49152
    ds_read_b128 v[120:123], v98 offset:49152
    ds_read_b128 v[124:127], v99 offset:49152
    s_waitcnt lgkmcnt(3)
    v_lshlrev_b32 v20, 16, v112
    v_and_b32 v21, s31, v112
    v_lshlrev_b32 v22, 16, v113
    v_and_b32 v23, s31, v113
    v_pk_mul_f32 v[20:21], v[20:21], s[34:35] op_sel_hi:[1,0]
    v_pk_mul_f32 v[22:23], v[22:23], s[34:35] op_sel_hi:[1,0]
    v_cvt_pk_bf16_f32 v20, v20, v21
    v_cvt_pk_bf16_f32 v22, v22, v23
    v_accvgpr_write_b32 a0, v20
    v_accvgpr_write_b32 a1, v22
    v_lshlrev_b32 v20, 16, v114
    v_and_b32 v21, s31, v114
    v_lshlrev_b32 v22, 16, v115
    v_and_b32 v23, s31, v115
    v_pk_mul_f32 v[20:21], v[20:21], s[34:35] op_sel_hi:[1,0]
    v_pk_mul_f32 v[22:23], v[22:23], s[34:35] op_sel_hi:[1,0]
    v_cvt_pk_bf16_f32 v20, v20, v21
    v_cvt_pk_bf16_f32 v22, v22, v23
    v_accvgpr_write_b32 a2, v20
    v_accvgpr_write_b32 a3, v22
    s_waitcnt lgkmcnt(2)
    v_lshlrev_b32 v20, 16, v116
    v_and_b32 v21, s31, v116
    v_lshlrev_b32 v22, 16, v117
    v_and_b32 v23, s31, v117
    v_pk_mul_f32 v[20:21], v[20:21], s[34:35] op_sel_hi:[1,0]
    v_pk_mul_f32 v[22:23], v[22:23], s[34:35] op_sel_hi:[1,0]
    v_cvt_pk_bf16_f32 v20, v20, v21
    v_cvt_pk_bf16_f32 v22, v22, v23
    v_accvgpr_write_b32 a4, v20
    v_accvgpr_write_b32 a5, v22
    v_lshlrev_b32 v20, 16, v118
    v_and_b32 v21, s31, v118
    v_lshlrev_b32 v22, 16, v119
    v_and_b32 v23, s31, v119
    v_pk_mul_f32 v[20:21], v[20:21], s[34:35] op_sel_hi:[1,0]
    v_pk_mul_f32 v[22:23], v[22:23], s[34:35] op_sel_hi:[1,0]
    v_cvt_pk_bf16_f32 v20, v20, v21
    v_cvt_pk_bf16_f32 v22, v22, v23
    v_accvgpr_write_b32 a6, v20
    v_accvgpr_write_b32 a7, v22
    s_waitcnt lgkmcnt(1)
    v_lshlrev_b32 v20, 16, v120
    v_and_b32 v21, s31, v120
    v_lshlrev_b32 v22, 16, v121
    v_and_b32 v23, s31, v121
    v_pk_mul_f32 v[20:21], v[20:21], s[34:35] op_sel_hi:[1,0]
    v_pk_mul_f32 v[22:23], v[22:23], s[34:35] op_sel_hi:[1,0]
    v_cvt_pk_bf16_f32 v20, v20, v21
    v_cvt_pk_bf16_f32 v22, v22, v23
    v_accvgpr_write_b32 a8, v20
    v_accvgpr_write_b32 a9, v22
    v_lshlrev_b32 v20, 16, v122
    v_and_b32 v21, s31, v122
    v_lshlrev_b32 v22, 16, v123
    v_and_b32 v23, s31, v123
    v_pk_mul_f32 v[20:21], v[20:21], s[34:35] op_sel_hi:[1,0]
    v_pk_mul_f32 v[22:23], v[22:23], s[34:35] op_sel_hi:[1,0]
    v_cvt_pk_bf16_f32 v20, v20, v21
    v_cvt_pk_bf16_f32 v22, v22, v23
    v_accvgpr_write_b32 a10, v20
    v_accvgpr_write_b32 a11, v22
    s_waitcnt lgkmcnt(0)
    s_add_u32 m0, s30, 98304
    s_add_u32 s29, s39, 12288
    buffer_load_dwordx4 v72, s[20:23], s29 offen offset:0 nt lds
    buffer_load_dwordx4 v73, s[20:23], s29 offen offset:1024 nt lds
    buffer_load_dwordx4 v74, s[20:23], s29 offen offset:2048 nt lds
    buffer_load_dwordx4 v75, s[20:23], s29 offen offset:3072 nt lds
    v_lshlrev_b32 v20, 16, v124
    v_and_b32 v21, s31, v124
    v_lshlrev_b32 v22, 16, v125
    v_and_b32 v23, s31, v125
    v_pk_mul_f32 v[20:21], v[20:21], s[34:35] op_sel_hi:[1,0]
    v_pk_mul_f32 v[22:23], v[22:23], s[34:35] op_sel_hi:[1,0]
    v_cvt_pk_bf16_f32 v20, v20, v21
    v_cvt_pk_bf16_f32 v22, v22, v23
    v_accvgpr_write_b32 a12, v20
    v_accvgpr_write_b32 a13, v22
    v_lshlrev_b32 v20, 16, v126
    v_and_b32 v21, s31, v126
    v_lshlrev_b32 v22, 16, v127
    v_and_b32 v23, s31, v127
    v_pk_mul_f32 v[20:21], v[20:21], s[34:35] op_sel_hi:[1,0]
    v_pk_mul_f32 v[22:23], v[22:23], s[34:35] op_sel_hi:[1,0]
    v_cvt_pk_bf16_f32 v20, v20, v21
    v_cvt_pk_bf16_f32 v22, v22, v23
    v_accvgpr_write_b32 a14, v20
    v_accvgpr_write_b32 a15, v22
    s_nop 1
    v_mfma_f32_16x16x32_bf16 v[32:35], a[64:67], a[0:3], 0
    v_mfma_f32_16x16x32_bf16 v[32:35], a[68:71], a[4:7], v[32:35]
    v_mfma_f32_16x16x32_bf16 v[32:35], a[72:75], a[8:11], v[32:35]
    v_mfma_f32_16x16x32_bf16 v[32:35], a[76:79], a[12:15], v[32:35]
    v_mfma_f32_16x16x32_bf16 v[36:39], a[92:95], a[12:15], 0
    v_mfma_f32_16x16x32_bf16 v[36:39], a[88:91], a[8:11], v[36:39]
    v_mfma_f32_16x16x32_bf16 v[36:39], a[84:87], a[4:7], v[36:39]
    v_mfma_f32_16x16x32_bf16 v[36:39], a[80:83], a[0:3], v[36:39]
    v_mfma_f32_16x16x32_bf16 v[40:43], a[96:99], a[0:3], 0
    v_mfma_f32_16x16x32_bf16 v[40:43], a[100:103], a[4:7], v[40:43]
    v_mfma_f32_16x16x32_bf16 v[40:43], a[104:107], a[8:11], v[40:43]
    v_mfma_f32_16x16x32_bf16 v[40:43], a[108:111], a[12:15], v[40:43]
    v_mfma_f32_16x16x32_bf16 v[44:47], a[124:127], a[12:15], 0
    v_mfma_f32_16x16x32_bf16 v[44:47], a[120:123], a[8:11], v[44:47]
    v_mfma_f32_16x16x32_bf16 v[44:47], a[116:119], a[4:7], v[44:47]
    v_mfma_f32_16x16x32_bf16 v[44:47], a[112:115], a[0:3], v[44:47]
    s_waitcnt vmcnt(12)
    ds_read_b128 v[112:115], v100 offset:49152
    ds_read_b128 v[116:119], v101 offset:49152
    ds_read_b128 v[120:123], v102 offset:49152
    ds_read_b128 v[124:127], v103 offset:49152
    v_max3_f32 v24, v32, v33, v34
    v_max3_f32 v25, v35, v36, v37
    v_max3_f32 v24, v24, v38, v39
    v_max3_f32 v25, v25, v40, v41
    v_max3_f32 v24, v24, v42, v43
    v_max3_f32 v25, v25, v44, v45
    v_max3_f32 v24, v24, v46, v47
    v_max_f32 v24, v24, v25
    v_mov_b32 v25, v24
    s_nop 1
    v_permlane32_swap_b32 v24, v25
    v_max_f32 v24, v24, v25
    v_mov_b32 v25, v24
    s_nop 1
    v_permlane16_swap_b32 v24, v25
    v_max_f32 v24, v24, v25
    v_sub_f32 v32, v32, v24
    v_sub_f32 v33, v33, v24
    v_sub_f32 v34, v34, v24
    v_sub_f32 v35, v35, v24
    v_sub_f32 v36, v36, v24
    v_sub_f32 v37, v37, v24
    v_sub_f32 v38, v38, v24
    v_sub_f32 v39, v39, v24
    v_sub_f32 v40, v40, v24
    v_sub_f32 v41, v41, v24
    v_sub_f32 v42, v42, v24
    v_sub_f32 v43, v43, v24
    v_sub_f32 v44, v44, v24
    v_sub_f32 v45, v45, v24
    v_sub_f32 v46, v46, v24
    v_sub_f32 v47, v47, v24
    v_sub_f32 v80, 0, v24
    v_sub_f32 v81, 0, v24
    v_sub_f32 v82, 0, v24
    v_sub_f32 v83, 0, v24
    s_waitcnt lgkmcnt(3)
    v_lshlrev_b32 v20, 16, v112
    v_and_b32 v21, s31, v112
    v_lshlrev_b32 v22, 16, v113
    v_and_b32 v23, s31, v113
    v_pk_mul_f32 v[20:21], v[20:21], s[34:35] op_sel_hi:[1,0]
    v_pk_mul_f32 v[22:23], v[22:23], s[34:35] op_sel_hi:[1,0]
    v_cvt_pk_bf16_f32 v20, v20, v21
    v_cvt_pk_bf16_f32 v22, v22, v23
    v_accvgpr_write_b32 a16, v20
    v_accvgpr_write_b32 a17, v22
    v_lshlrev_b32 v20, 16, v114
    v_and_b32 v21, s31, v114
    v_lshlrev_b32 v22, 16, v115
    v_and_b32 v23, s31, v115
    v_pk_mul_f32 v[20:21], v[20:21], s[34:35] op_sel_hi:[1,0]
    v_pk_mul_f32 v[22:23], v[22:23], s[34:35] op_sel_hi:[1,0]
    v_cvt_pk_bf16_f32 v20, v20, v21
    v_cvt_pk_bf16_f32 v22, v22, v23
    v_accvgpr_write_b32 a18, v20
    v_accvgpr_write_b32 a19, v22
    s_waitcnt lgkmcnt(2)
    v_lshlrev_b32 v20, 16, v116
    v_and_b32 v21, s31, v116
    v_lshlrev_b32 v22, 16, v117
    v_and_b32 v23, s31, v117
    v_pk_mul_f32 v[20:21], v[20:21], s[34:35] op_sel_hi:[1,0]
    v_pk_mul_f32 v[22:23], v[22:23], s[34:35] op_sel_hi:[1,0]
    v_cvt_pk_bf16_f32 v20, v20, v21
    v_cvt_pk_bf16_f32 v22, v22, v23
    v_accvgpr_write_b32 a20, v20
    v_accvgpr_write_b32 a21, v22
    v_lshlrev_b32 v20, 16, v118
    v_and_b32 v21, s31, v118
    v_lshlrev_b32 v22, 16, v119
    v_and_b32 v23, s31, v119
    v_pk_mul_f32 v[20:21], v[20:21], s[34:35] op_sel_hi:[1,0]
    v_pk_mul_f32 v[22:23], v[22:23], s[34:35] op_sel_hi:[1,0]
    v_cvt_pk_bf16_f32 v20, v20, v21
    v_cvt_pk_bf16_f32 v22, v22, v23
    v_accvgpr_write_b32 a22, v20
    v_accvgpr_write_b32 a23, v22
    s_waitcnt lgkmcnt(1)
    v_lshlrev_b32 v20, 16, v120
    v_and_b32 v21, s31, v120
    v_lshlrev_b32 v22, 16, v121
    v_and_b32 v23, s31, v121
    v_pk_mul_f32 v[20:21], v[20:21], s[34:35] op_sel_hi:[1,0]
    v_pk_mul_f32 v[22:23], v[22:23], s[34:35] op_sel_hi:[1,0]
    v_cvt_pk_bf16_f32 v20, v20, v21
    v_cvt_pk_bf16_f32 v22, v22, v23
    v_accvgpr_write_b32 a24, v20
    v_accvgpr_write_b32 a25, v22
    v_lshlrev_b32 v20, 16, v122
    v_and_b32 v21, s31, v122
    v_lshlrev_b32 v22, 16, v123
    v_and_b32 v23, s31, v123
    v_pk_mul_f32 v[20:21], v[20:21], s[34:35] op_sel_hi:[1,0]
    v_pk_mul_f32 v[22:23], v[22:23], s[34:35] op_sel_hi:[1,0]
    v_cvt_pk_bf16_f32 v20, v20, v21
    v_cvt_pk_bf16_f32 v22, v22, v23
    v_accvgpr_write_b32 a26, v20
    v_accvgpr_write_b32 a27, v22
    s_waitcnt lgkmcnt(0)
    s_add_u32 m0, s30, 16384
    s_nop 0
    buffer_load_dwordx4 v12, s[12:15], s32 offen offset:0 nt lds
    buffer_load_dwordx4 v13, s[12:15], s32 offen offset:1024 nt lds
    buffer_load_dwordx4 v14, s[12:15], s32 offen offset:2048 nt lds
    buffer_load_dwordx4 v15, s[12:15], s32 offen offset:3072 nt lds
    v_lshlrev_b32 v20, 16, v124
    v_and_b32 v21, s31, v124
    v_lshlrev_b32 v22, 16, v125
    v_and_b32 v23, s31, v125
    v_pk_mul_f32 v[20:21], v[20:21], s[34:35] op_sel_hi:[1,0]
    v_pk_mul_f32 v[22:23], v[22:23], s[34:35] op_sel_hi:[1,0]
    v_cvt_pk_bf16_f32 v20, v20, v21
    v_cvt_pk_bf16_f32 v22, v22, v23
    v_accvgpr_write_b32 a28, v20
    v_accvgpr_write_b32 a29, v22
    v_lshlrev_b32 v20, 16, v126
    v_and_b32 v21, s31, v126
    v_lshlrev_b32 v22, 16, v127
    v_and_b32 v23, s31, v127
    v_pk_mul_f32 v[20:21], v[20:21], s[34:35] op_sel_hi:[1,0]
    v_pk_mul_f32 v[22:23], v[22:23], s[34:35] op_sel_hi:[1,0]
    v_cvt_pk_bf16_f32 v20, v20, v21
    v_cvt_pk_bf16_f32 v22, v22, v23
    v_accvgpr_write_b32 a30, v20
    v_accvgpr_write_b32 a31, v22
    s_nop 1
    v_mfma_f32_16x16x32_bf16 v[48:51], a[64:67], a[16:19], 0
    v_exp_f32 v32, v32
    v_mfma_f32_16x16x32_bf16 v[48:51], a[68:71], a[20:23], v[48:51]
    v_exp_f32 v33, v33
    v_mfma_f32_16x16x32_bf16 v[48:51], a[72:75], a[24:27], v[48:51]
    v_exp_f32 v34, v34
    v_cvt_pk_bf16_f32 v64, v32, v33
    v_mfma_f32_16x16x32_bf16 v[48:51], a[76:79], a[28:31], v[48:51]
    v_exp_f32 v35, v35
    v_mfma_f32_16x16x32_bf16 v[52:55], a[92:95], a[28:31], 0
    v_exp_f32 v36, v36
    v_cvt_pk_bf16_f32 v65, v34, v35
    v_mfma_f32_16x16x32_bf16 v[52:55], a[88:91], a[24:27], v[52:55]
    v_exp_f32 v37, v37
    v_mfma_f32_16x16x32_bf16 v[52:55], a[84:87], a[20:23], v[52:55]
    v_exp_f32 v38, v38
    v_cvt_pk_bf16_f32 v66, v36, v37
    v_mfma_f32_16x16x32_bf16 v[52:55], a[80:83], a[16:19], v[52:55]
    v_exp_f32 v39, v39
    v_mfma_f32_16x16x32_bf16 v[56:59], a[96:99], a[16:19], 0
    v_exp_f32 v40, v40
    v_cvt_pk_bf16_f32 v67, v38, v39
    v_mfma_f32_16x16x32_bf16 v[56:59], a[100:103], a[20:23], v[56:59]
    v_exp_f32 v41, v41
    v_mfma_f32_16x16x32_bf16 v[56:59], a[104:107], a[24:27], v[56:59]
    v_exp_f32 v42, v42
    v_cvt_pk_bf16_f32 v68, v40, v41
    v_mfma_f32_16x16x32_bf16 v[56:59], a[108:111], a[28:31], v[56:59]
    v_exp_f32 v43, v43
    v_mfma_f32_16x16x32_bf16 v[60:63], a[124:127], a[28:31], 0
    v_exp_f32 v44, v44
    v_cvt_pk_bf16_f32 v69, v42, v43
    v_mfma_f32_16x16x32_bf16 v[60:63], a[120:123], a[24:27], v[60:63]
    v_exp_f32 v45, v45
    v_mfma_f32_16x16x32_bf16 v[60:63], a[116:119], a[20:23], v[60:63]
    v_exp_f32 v46, v46
    v_cvt_pk_bf16_f32 v70, v44, v45
    v_mfma_f32_16x16x32_bf16 v[60:63], a[112:115], a[16:19], v[60:63]
    v_exp_f32 v47, v47
    s_nop 0
    v_cvt_pk_bf16_f32 v71, v46, v47
    s_waitcnt vmcnt(12)
    s_barrier
    ds_read_b64_tr_b16 a[128:129], v4 offset:0
    ds_read_b64_tr_b16 a[130:131], v4 offset:4096
    ds_read_b64_tr_b16 a[160:161], v4 offset:8192
    ds_read_b64_tr_b16 a[162:163], v4 offset:12288
    ds_read_b64_tr_b16 a[132:133], v5 offset:0
    ds_read_b64_tr_b16 a[134:135], v5 offset:4096
    ds_read_b64_tr_b16 a[164:165], v5 offset:8192
    ds_read_b64_tr_b16 a[166:167], v5 offset:12288
    ds_read_b64_tr_b16 a[136:137], v6 offset:0
    ds_read_b64_tr_b16 a[138:139], v6 offset:4096
    ds_read_b64_tr_b16 a[168:169], v6 offset:8192
    ds_read_b64_tr_b16 a[170:171], v6 offset:12288
    ds_read_b64_tr_b16 a[140:141], v7 offset:0
    ds_read_b64_tr_b16 a[142:143], v7 offset:4096
    ds_read_b64_tr_b16 a[172:173], v7 offset:8192
    ds_read_b64_tr_b16 a[174:175], v7 offset:12288
    ds_read_b64_tr_b16 a[144:145], v8 offset:0
    ds_read_b64_tr_b16 a[146:147], v8 offset:4096
    ds_read_b64_tr_b16 a[176:177], v8 offset:8192
    ds_read_b64_tr_b16 a[178:179], v8 offset:12288
    ds_read_b64_tr_b16 a[148:149], v9 offset:0
    ds_read_b64_tr_b16 a[150:151], v9 offset:4096
    ds_read_b64_tr_b16 a[180:181], v9 offset:8192
    ds_read_b64_tr_b16 a[182:183], v9 offset:12288
    ds_read_b64_tr_b16 a[152:153], v10 offset:0
    ds_read_b64_tr_b16 a[154:155], v10 offset:4096
    ds_read_b64_tr_b16 a[184:185], v10 offset:8192
    ds_read_b64_tr_b16 a[186:187], v10 offset:12288
    ds_read_b64_tr_b16 a[156:157], v11 offset:0
    ds_read_b64_tr_b16 a[158:159], v11 offset:4096
    ds_read_b64_tr_b16 a[188:189], v11 offset:8192
    ds_read_b64_tr_b16 a[190:191], v11 offset:12288
    s_add_u32 m0, s30, 81920
    s_nop 0
    buffer_load_dwordx4 v16, s[16:19], s32 offen offset:0 nt lds
    buffer_load_dwordx4 v17, s[16:19], s32 offen offset:1024 nt lds
    buffer_load_dwordx4 v16, s[16:19], s32 offen offset:2048 nt lds
    buffer_load_dwordx4 v17, s[16:19], s32 offen offset:3072 nt lds
    s_or_b32 s32, s32, 98304
    s_add_u32 s32, s32, 4096
    s_andn2_b32 s32, s32, 98304
    s_waitcnt vmcnt(12)
    ds_read_b128 v[112:115], v96 offset:32768
    ds_read_b128 v[116:119], v97 offset:32768
    ds_read_b128 v[120:123], v98 offset:32768
    ds_read_b128 v[124:127], v99 offset:32768
    v_max3_f32 v24, v48, v49, v50
    v_max3_f32 v25, v51, v52, v53
    v_max3_f32 v24, v24, v54, v55
    v_max3_f32 v25, v25, v56, v57
    v_max3_f32 v24, v24, v58, v59
    v_max3_f32 v25, v25, v60, v61
    v_max3_f32 v24, v24, v62, v63
    v_max_f32 v24, v24, v25
    v_mov_b32 v25, v24
    s_nop 1
    v_permlane32_swap_b32 v24, v25
    v_max_f32 v24, v24, v25
    v_mov_b32 v25, v24
    s_nop 1
    v_permlane16_swap_b32 v24, v25
    v_max_f32 v24, v24, v25
    v_sub_f32 v48, v48, v24
    v_sub_f32 v49, v49, v24
    v_sub_f32 v50, v50, v24
    v_sub_f32 v51, v51, v24
    v_sub_f32 v52, v52, v24
    v_sub_f32 v53, v53, v24
    v_sub_f32 v54, v54, v24
    v_sub_f32 v55, v55, v24
    v_sub_f32 v56, v56, v24
    v_sub_f32 v57, v57, v24
    v_sub_f32 v58, v58, v24
    v_sub_f32 v59, v59, v24
    v_sub_f32 v60, v60, v24
    v_sub_f32 v61, v61, v24
    v_sub_f32 v62, v62, v24
    v_sub_f32 v63, v63, v24
    v_sub_f32 v84, 0, v24
    v_sub_f32 v85, 0, v24
    v_sub_f32 v86, 0, v24
    v_sub_f32 v87, 0, v24
    s_waitcnt lgkmcnt(3)
    v_mfma_f32_16x16x32_bf16 v[128:131], a[128:131], v[64:67], v[128:131]
    v_lshlrev_b32 v20, 16, v112
    v_and_b32 v21, s31, v112
    v_lshlrev_b32 v22, 16, v113
    v_and_b32 v23, s31, v113
    v_mul_f32 v20, s34, v20
    v_mul_f32 v21, s34, v21
    v_mfma_f32_16x16x32_bf16 v[128:131], a[160:163], v[68:71], v[128:131]
    v_mul_f32 v22, s34, v22
    v_mul_f32 v23, s34, v23
    v_cvt_pk_bf16_f32 v20, v20, v21
    v_cvt_pk_bf16_f32 v22, v22, v23
    v_accvgpr_write_b32 a32, v20
    v_accvgpr_write_b32 a33, v22
    v_mfma_f32_16x16x32_bf16 v[132:135], a[164:167], v[68:71], v[132:135]
    v_lshlrev_b32 v20, 16, v114
    v_and_b32 v21, s31, v114
    v_lshlrev_b32 v22, 16, v115
    v_and_b32 v23, s31, v115
    v_mul_f32 v20, s34, v20
    v_mul_f32 v21, s34, v21
    v_mfma_f32_16x16x32_bf16 v[132:135], a[132:135], v[64:67], v[132:135]
    v_mul_f32 v22, s34, v22
    v_mul_f32 v23, s34, v23
    v_cvt_pk_bf16_f32 v20, v20, v21
    v_cvt_pk_bf16_f32 v22, v22, v23
    v_accvgpr_write_b32 a34, v20
    v_accvgpr_write_b32 a35, v22
    s_waitcnt lgkmcnt(2)
    v_mfma_f32_16x16x32_bf16 v[136:139], a[136:139], v[64:67], v[136:139]
    v_lshlrev_b32 v20, 16, v116
    v_and_b32 v21, s31, v116
    v_lshlrev_b32 v22, 16, v117
    v_and_b32 v23, s31, v117
    v_mul_f32 v20, s34, v20
    v_mul_f32 v21, s34, v21
    v_mfma_f32_16x16x32_bf16 v[136:139], a[168:171], v[68:71], v[136:139]
    v_mul_f32 v22, s34, v22
    v_mul_f32 v23, s34, v23
    v_cvt_pk_bf16_f32 v20, v20, v21
    v_cvt_pk_bf16_f32 v22, v22, v23
    v_accvgpr_write_b32 a36, v20
    v_accvgpr_write_b32 a37, v22
    v_mfma_f32_16x16x32_bf16 v[140:143], a[172:175], v[68:71], v[140:143]
    v_lshlrev_b32 v20, 16, v118
    v_and_b32 v21, s31, v118
    v_lshlrev_b32 v22, 16, v119
    v_and_b32 v23, s31, v119
    v_mul_f32 v20, s34, v20
    v_mul_f32 v21, s34, v21
    v_mfma_f32_16x16x32_bf16 v[140:143], a[140:143], v[64:67], v[140:143]
    v_mul_f32 v22, s34, v22
    v_mul_f32 v23, s34, v23
    v_cvt_pk_bf16_f32 v20, v20, v21
    v_cvt_pk_bf16_f32 v22, v22, v23
    v_mfma_f32_16x16x32_bf16 v[144:147], a[144:147], v[64:67], v[144:147]
    v_accvgpr_write_b32 a38, v20
    v_accvgpr_write_b32 a39, v22
    s_waitcnt lgkmcnt(1)
    v_mfma_f32_16x16x32_bf16 v[144:147], a[176:179], v[68:71], v[144:147]
    v_lshlrev_b32 v20, 16, v120
    v_and_b32 v21, s31, v120
    v_lshlrev_b32 v22, 16, v121
    v_and_b32 v23, s31, v121
    v_mul_f32 v20, s34, v20
    v_mul_f32 v21, s34, v21
    v_mfma_f32_16x16x32_bf16 v[148:151], a[180:183], v[68:71], v[148:151]
    v_mul_f32 v22, s34, v22
    v_mul_f32 v23, s34, v23
    v_cvt_pk_bf16_f32 v20, v20, v21
    v_cvt_pk_bf16_f32 v22, v22, v23
    v_accvgpr_write_b32 a40, v20
    v_accvgpr_write_b32 a41, v22
    v_mfma_f32_16x16x32_bf16 v[148:151], a[148:151], v[64:67], v[148:151]
    v_lshlrev_b32 v20, 16, v122
    v_and_b32 v21, s31, v122
    v_lshlrev_b32 v22, 16, v123
    v_and_b32 v23, s31, v123
    v_mul_f32 v20, s34, v20
    v_mul_f32 v21, s34, v21
    v_mfma_f32_16x16x32_bf16 v[152:155], a[152:155], v[64:67], v[152:155]
    v_mul_f32 v22, s34, v22
    v_mul_f32 v23, s34, v23
    v_cvt_pk_bf16_f32 v20, v20, v21
    v_cvt_pk_bf16_f32 v22, v22, v23
    v_accvgpr_write_b32 a42, v20
    v_accvgpr_write_b32 a43, v22
    s_waitcnt lgkmcnt(0)
    s_add_u32 m0, s30, 49152
    s_nop 0
    buffer_load_dwordx4 v12, s[12:15], s32 offen offset:0 nt lds
    buffer_load_dwordx4 v13, s[12:15], s32 offen offset:1024 nt lds
    buffer_load_dwordx4 v14, s[12:15], s32 offen offset:2048 nt lds
    buffer_load_dwordx4 v15, s[12:15], s32 offen offset:3072 nt lds
    v_mfma_f32_16x16x32_bf16 v[152:155], a[184:187], v[68:71], v[152:155]
    v_lshlrev_b32 v20, 16, v124
    v_and_b32 v21, s31, v124
    v_lshlrev_b32 v22, 16, v125
    v_and_b32 v23, s31, v125
    v_mul_f32 v20, s34, v20
    v_mul_f32 v21, s34, v21
    v_mfma_f32_16x16x32_bf16 v[156:159], a[188:191], v[68:71], v[156:159]
    v_mul_f32 v22, s34, v22
    v_mul_f32 v23, s34, v23
    v_cvt_pk_bf16_f32 v20, v20, v21
    v_cvt_pk_bf16_f32 v22, v22, v23
    v_accvgpr_write_b32 a44, v20
    v_accvgpr_write_b32 a45, v22
    v_mfma_f32_16x16x32_bf16 v[156:159], a[156:159], v[64:67], v[156:159]
    v_lshlrev_b32 v20, 16, v126
    v_and_b32 v21, s31, v126
    v_lshlrev_b32 v22, 16, v127
    v_and_b32 v23, s31, v127
    v_mul_f32 v20, s34, v20
    v_mul_f32 v21, s34, v21
    v_smfmac_f32_16x16x64_bf16 a[192:195], a[208:211], v[64:71], v111
    v_mul_f32 v22, s34, v22
    v_mul_f32 v23, s34, v23
    v_cvt_pk_bf16_f32 v20, v20, v21
    v_cvt_pk_bf16_f32 v22, v22, v23
    v_accvgpr_write_b32 a46, v20
    v_accvgpr_write_b32 a47, v22
    s_nop 1
    v_mfma_f32_16x16x32_bf16 v[32:35], a[64:67], a[32:35], 0
    v_exp_f32 v48, v48
    v_mfma_f32_16x16x32_bf16 v[32:35], a[68:71], a[36:39], v[32:35]
    v_exp_f32 v49, v49
    v_mfma_f32_16x16x32_bf16 v[32:35], a[72:75], a[40:43], v[32:35]
    v_exp_f32 v50, v50
    v_cvt_pk_bf16_f32 v72, v48, v49
    v_mfma_f32_16x16x32_bf16 v[32:35], a[76:79], a[44:47], v[32:35]
    v_exp_f32 v51, v51
    v_mfma_f32_16x16x32_bf16 v[36:39], a[92:95], a[44:47], 0
    v_exp_f32 v52, v52
    v_cvt_pk_bf16_f32 v73, v50, v51
    v_mfma_f32_16x16x32_bf16 v[36:39], a[88:91], a[40:43], v[36:39]
    v_exp_f32 v53, v53
    v_mfma_f32_16x16x32_bf16 v[36:39], a[84:87], a[36:39], v[36:39]
    v_exp_f32 v54, v54
    v_cvt_pk_bf16_f32 v74, v52, v53
    v_mfma_f32_16x16x32_bf16 v[36:39], a[80:83], a[32:35], v[36:39]
    v_exp_f32 v55, v55
    v_mfma_f32_16x16x32_bf16 v[40:43], a[96:99], a[32:35], 0
    v_exp_f32 v56, v56
    v_cvt_pk_bf16_f32 v75, v54, v55
    v_mfma_f32_16x16x32_bf16 v[40:43], a[100:103], a[36:39], v[40:43]
    v_exp_f32 v57, v57
    v_mfma_f32_16x16x32_bf16 v[40:43], a[104:107], a[40:43], v[40:43]
    v_exp_f32 v58, v58
    v_cvt_pk_bf16_f32 v76, v56, v57
    v_mfma_f32_16x16x32_bf16 v[40:43], a[108:111], a[44:47], v[40:43]
    v_exp_f32 v59, v59
    v_mfma_f32_16x16x32_bf16 v[44:47], a[124:127], a[44:47], 0
    v_exp_f32 v60, v60
    v_cvt_pk_bf16_f32 v77, v58, v59
    v_mfma_f32_16x16x32_bf16 v[44:47], a[120:123], a[40:43], v[44:47]
    v_exp_f32 v61, v61
    v_mfma_f32_16x16x32_bf16 v[44:47], a[116:119], a[36:39], v[44:47]
    v_exp_f32 v62, v62
    v_cvt_pk_bf16_f32 v78, v60, v61
    v_mfma_f32_16x16x32_bf16 v[44:47], a[112:115], a[32:35], v[44:47]
    v_exp_f32 v63, v63
    s_nop 0
    v_cvt_pk_bf16_f32 v79, v62, v63
    s_branch S_B4O
Z_A4O:
.p2align 12
T_A3E:
    s_branch L_backE
    s_nop 0
S_A3E:
    s_waitcnt vmcnt(4)
    s_barrier
    ds_read_b128 a[64:67], v0 offset:0
    ds_read_b128 a[68:71], v1 offset:0
    ds_read_b128 a[72:75], v2 offset:0
    ds_read_b128 a[76:79], v3 offset:0
    ds_read_b128 a[80:83], v0 offset:4096
    ds_read_b128 a[84:87], v1 offset:4096
    ds_read_b128 a[88:91], v2 offset:4096
    ds_read_b128 a[92:95], v3 offset:4096
    ds_read_b128 a[96:99], v0 offset:8192
    ds_read_b128 a[100:103], v1 offset:8192
    ds_read_b128 a[104:107], v2 offset:8192
    ds_read_b128 a[108:111], v3 offset:8192
    ds_read_b128 a[112:115], v0 offset:12288
    ds_read_b128 a[116:119], v1 offset:12288
    ds_read_b128 a[120:123], v2 offset:12288
    ds_read_b128 a[124:127], v3 offset:12288
    s_add_u32 m0, s30, 114688
    s_add_u32 s29, s39, 4096
    buffer_load_dwordx4 v72, s[20:23], s29 offen offset:0 nt lds
    buffer_load_dwordx4 v73, s[20:23], s29 offen offset:1024 nt lds
    buffer_load_dwordx4 v74, s[20:23], s29 offen offset:2048 nt lds
    buffer_load_dwordx4 v75, s[20:23], s29 offen offset:3072 nt lds
    s_waitcnt vmcnt(4)
    ds_read_b128 v[112:115], v96 offset:49152
    ds_read_b128 v[116:119], v97 offset:49152
    ds_read_b128 v[120:123], v98 offset:49152
    ds_read_b128 v[124:127], v99 offset:49152
    s_waitcnt lgkmcnt(3)
    v_lshlrev_b32 v20, 16, v112
    v_and_b32 v21, s31, v112
    v_lshlrev_b32 v22, 16, v113
    v_and_b32 v23, s31, v113
    v_pk_mul_f32 v[20:21], v[20:21], s[34:35] op_sel_hi:[1,0]
    v_pk_mul_f32 v[22:23], v[22:23], s[34:35] op_sel_hi:[1,0]
    v_cvt_pk_bf16_f32 v20, v20, v21
    v_cvt_pk_bf16_f32 v22, v22, v23
    v_accvgpr_write_b32 a0, v20
    v_accvgpr_write_b32 a1, v22
    v_lshlrev_b32 v20, 16, v114
    v_and_b32 v21, s31, v114
    v_lshlrev_b32 v22, 16, v115
    v_and_b32 v23, s31, v115
    v_pk_mul_f32 v[20:21], v[20:21], s[34:35] op_sel_hi:[1,0]
    v_pk_mul_f32 v[22:23], v[22:23], s[34:35] op_sel_hi:[1,0]
    v_cvt_pk_bf16_f32 v20, v20, v21
    v_cvt_pk_bf16_f32 v22, v22, v23
    v_accvgpr_write_b32 a2, v20
    v_accvgpr_write_b32 a3, v22
    s_waitcnt lgkmcnt(2)
    v_lshlrev_b32 v20, 16, v116
    v_and_b32 v21, s31, v116
    v_lshlrev_b32 v22, 16, v117
    v_and_b32 v23, s31, v117
    v_pk_mul_f32 v[20:21], v[20:21], s[34:35] op_sel_hi:[1,0]
    v_pk_mul_f32 v[22:23], v[22:23], s[34:35] op_sel_hi:[1,0]
    v_cvt_pk_bf16_f32 v20, v20, v21
    v_cvt_pk_bf16_f32 v22, v22, v23
    v_accvgpr_write_b32 a4, v20
    v_accvgpr_write_b32 a5, v22
    v_lshlrev_b32 v20, 16, v118
    v_and_b32 v21, s31, v118
    v_lshlrev_b32 v22, 16, v119
    v_and_b32 v23, s31, v119
    v_pk_mul_f32 v[20:21], v[20:21], s[34:35] op_sel_hi:[1,0]
    v_pk_mul_f32 v[22:23], v[22:23], s[34:35] op_sel_hi:[1,0]
    v_cvt_pk_bf16_f32 v20, v20, v21
    v_cvt_pk_bf16_f32 v22, v22, v23
    v_accvgpr_write_b32 a6, v20
    v_accvgpr_write_b32 a7, v22
    s_waitcnt lgkmcnt(1)
    v_lshlrev_b32 v20, 16, v120
    v_and_b32 v21, s31, v120
    v_lshlrev_b32 v22, 16, v121
    v_and_b32 v23, s31, v121
    v_pk_mul_f32 v[20:21], v[20:21], s[34:35] op_sel_hi:[1,0]
    v_pk_mul_f32 v[22:23], v[22:23], s[34:35] op_sel_hi:[1,0]
    v_cvt_pk_bf16_f32 v20, v20, v21
    v_cvt_pk_bf16_f32 v22, v22, v23
    v_accvgpr_write_b32 a8, v20
    v_accvgpr_write_b32 a9, v22
    v_lshlrev_b32 v20, 16, v122
    v_and_b32 v21, s31, v122
    v_lshlrev_b32 v22, 16, v123
    v_and_b32 v23, s31, v123
    v_pk_mul_f32 v[20:21], v[20:21], s[34:35] op_sel_hi:[1,0]
    v_pk_mul_f32 v[22:23], v[22:23], s[34:35] op_sel_hi:[1,0]
    v_cvt_pk_bf16_f32 v20, v20, v21
    v_cvt_pk_bf16_f32 v22, v22, v23
    v_accvgpr_write_b32 a10, v20
    v_accvgpr_write_b32 a11, v22
    s_waitcnt lgkmcnt(0)
    s_add_u32 m0, s30, 65536
    s_nop 0
    buffer_load_dwordx4 v16, s[16:19], s32 offen offset:0 nt lds
    buffer_load_dwordx4 v17, s[16:19], s32 offen offset:1024 nt lds
    buffer_load_dwordx4 v16, s[16:19], s32 offen offset:2048 nt lds
    buffer_load_dwordx4 v17, s[16:19], s32 offen offset:3072 nt lds
    s_or_b32 s32, s32, 98304
    s_add_u32 s32, s32, 4096
    s_andn2_b32 s32, s32, 98304
    v_lshlrev_b32 v20, 16, v124
    v_and_b32 v21, s31, v124
    v_lshlrev_b32 v22, 16, v125
    v_and_b32 v23, s31, v125
    v_pk_mul_f32 v[20:21], v[20:21], s[34:35] op_sel_hi:[1,0]
    v_pk_mul_f32 v[22:23], v[22:23], s[34:35] op_sel_hi:[1,0]
    v_cvt_pk_bf16_f32 v20, v20, v21
    v_cvt_pk_bf16_f32 v22, v22, v23
    v_accvgpr_write_b32 a12, v20
    v_accvgpr_write_b32 a13, v22
    v_lshlrev_b32 v20, 16, v126
    v_and_b32 v21, s31, v126
    v_lshlrev_b32 v22, 16, v127
    v_and_b32 v23, s31, v127
    v_pk_mul_f32 v[20:21], v[20:21], s[34:35] op_sel_hi:[1,0]
    v_pk_mul_f32 v[22:23], v[22:23], s[34:35] op_sel_hi:[1,0]
    v_cvt_pk_bf16_f32 v20, v20, v21
    v_cvt_pk_bf16_f32 v22, v22, v23
    v_accvgpr_write_b32 a14, v20
    v_accvgpr_write_b32 a15, v22
    s_nop 1
    v_mfma_f32_16x16x32_bf16 v[32:35], a[64:67], a[0:3], 0
    v_mfma_f32_16x16x32_bf16 v[32:35], a[68:71], a[4:7], v[32:35]
    v_mfma_f32_16x16x32_bf16 v[32:35], a[72:75], a[8:11], v[32:35]
    v_mfma_f32_16x16x32_bf16 v[32:35], a[76:79], a[12:15], v[32:35]
    v_mfma_f32_16x16x32_bf16 v[36:39], a[92:95], a[12:15], 0
    v_mfma_f32_16x16x32_bf16 v[36:39], a[88:91], a[8:11], v[36:39]
    v_mfma_f32_16x16x32_bf16 v[36:39], a[84:87], a[4:7], v[36:39]
    v_mfma_f32_16x16x32_bf16 v[36:39], a[80:83], a[0:3], v[36:39]
    v_mfma_f32_16x16x32_bf16 v[40:43], a[96:99], a[0:3], 0
    v_mfma_f32_16x16x32_bf16 v[40:43], a[100:103], a[4:7], v[40:43]
    v_mfma_f32_16x16x32_bf16 v[40:43], a[104:107], a[8:11], v[40:43]
    v_mfma_f32_16x16x32_bf16 v[40:43], a[108:111], a[12:15], v[40:43]
    v_mfma_f32_16x16x32_bf16 v[44:47], a[124:127], a[12:15], 0
    v_mfma_f32_16x16x32_bf16 v[44:47], a[120:123], a[8:11], v[44:47]
    v_mfma_f32_16x16x32_bf16 v[44:47], a[116:119], a[4:7], v[44:47]
    v_mfma_f32_16x16x32_bf16 v[44:47], a[112:115], a[0:3], v[44:47]
    s_waitcnt vmcnt(4)
    ds_read_b128 v[112:115], v100 offset:49152
    ds_read_b128 v[116:119], v101 offset:49152
    ds_read_b128 v[120:123], v102 offset:49152
    ds_read_b128 v[124:127], v103 offset:49152
    v_max3_f32 v24, v32, v33, v34
    v_max3_f32 v25, v35, v36, v37
    v_max3_f32 v24, v24, v38, v39
    v_max3_f32 v25, v25, v40, v41
    v_max3_f32 v24, v24, v42, v43
    v_max3_f32 v25, v25, v44, v45
    v_max3_f32 v24, v24, v46, v47
    v_max_f32 v24, v24, v25
    v_mov_b32 v25, v24
    s_nop 1
    v_permlane32_swap_b32 v24, v25
    v_max_f32 v24, v24, v25
    v_mov_b32 v25, v24
    s_nop 1
    v_permlane16_swap_b32 v24, v25
    v_max_f32 v24, v24, v25
    v_sub_f32 v32, v32, v24
    v_sub_f32 v33, v33, v24
    v_sub_f32 v34, v34, v24
    v_sub_f32 v35, v35, v24
    v_sub_f32 v36, v36, v24
    v_sub_f32 v37, v37, v24
    v_sub_f32 v38, v38, v24
    v_sub_f32 v39, v39, v24
    v_sub_f32 v40, v40, v24
    v_sub_f32 v41, v41, v24
    v_sub_f32 v42, v42, v24
    v_sub_f32 v43, v43, v24
    v_sub_f32 v44, v44, v24
    v_sub_f32 v45, v45, v24
    v_sub_f32 v46, v46, v24
    v_sub_f32 v47, v47, v24
    v_sub_f32 v80, 0, v24
    v_sub_f32 v81, 0, v24
    v_sub_f32 v82, 0, v24
    v_sub_f32 v83, 0, v24
    s_waitcnt lgkmcnt(3)
    v_lshlrev_b32 v20, 16, v112
    v_and_b32 v21, s31, v112
    v_lshlrev_b32 v22, 16, v113
    v_and_b32 v23, s31, v113
    v_pk_mul_f32 v[20:21], v[20:21], s[34:35] op_sel_hi:[1,0]
    v_pk_mul_f32 v[22:23], v[22:23], s[34:35] op_sel_hi:[1,0]
    v_cvt_pk_bf16_f32 v20, v20, v21
    v_cvt_pk_bf16_f32 v22, v22, v23
    v_accvgpr_write_b32 a16, v20
    v_accvgpr_write_b32 a17, v22
    v_lshlrev_b32 v20, 16, v114
    v_and_b32 v21, s31, v114
    v_lshlrev_b32 v22, 16, v115
    v_and_b32 v23, s31, v115
    v_pk_mul_f32 v[20:21], v[20:21], s[34:35] op_sel_hi:[1,0]
    v_pk_mul_f32 v[22:23], v[22:23], s[34:35] op_sel_hi:[1,0]
    v_cvt_pk_bf16_f32 v20, v20, v21
    v_cvt_pk_bf16_f32 v22, v22, v23
    v_accvgpr_write_b32 a18, v20
    v_accvgpr_write_b32 a19, v22
    s_waitcnt lgkmcnt(2)
    v_lshlrev_b32 v20, 16, v116
    v_and_b32 v21, s31, v116
    v_lshlrev_b32 v22, 16, v117
    v_and_b32 v23, s31, v117
    v_pk_mul_f32 v[20:21], v[20:21], s[34:35] op_sel_hi:[1,0]
    v_pk_mul_f32 v[22:23], v[22:23], s[34:35] op_sel_hi:[1,0]
    v_cvt_pk_bf16_f32 v20, v20, v21
    v_cvt_pk_bf16_f32 v22, v22, v23
    v_accvgpr_write_b32 a20, v20
    v_accvgpr_write_b32 a21, v22
    v_lshlrev_b32 v20, 16, v118
    v_and_b32 v21, s31, v118
    v_lshlrev_b32 v22, 16, v119
    v_and_b32 v23, s31, v119
    v_pk_mul_f32 v[20:21], v[20:21], s[34:35] op_sel_hi:[1,0]
    v_pk_mul_f32 v[22:23], v[22:23], s[34:35] op_sel_hi:[1,0]
    v_cvt_pk_bf16_f32 v20, v20, v21
    v_cvt_pk_bf16_f32 v22, v22, v23
    v_accvgpr_write_b32 a22, v20
    v_accvgpr_write_b32 a23, v22
    s_waitcnt lgkmcnt(1)
    v_lshlrev_b32 v20, 16, v120
    v_and_b32 v21, s31, v120
    v_lshlrev_b32 v22, 16, v121
    v_and_b32 v23, s31, v121
    v_pk_mul_f32 v[20:21], v[20:21], s[34:35] op_sel_hi:[1,0]
    v_pk_mul_f32 v[22:23], v[22:23], s[34:35] op_sel_hi:[1,0]
    v_cvt_pk_bf16_f32 v20, v20, v21
    v_cvt_pk_bf16_f32 v22, v22, v23
    v_accvgpr_write_b32 a24, v20
    v_accvgpr_write_b32 a25, v22
    v_lshlrev_b32 v20, 16, v122
    v_and_b32 v21, s31, v122
    v_lshlrev_b32 v22, 16, v123
    v_and_b32 v23, s31, v123
    v_pk_mul_f32 v[20:21], v[20:21], s[34:35] op_sel_hi:[1,0]
    v_pk_mul_f32 v[22:23], v[22:23], s[34:35] op_sel_hi:[1,0]
    v_cvt_pk_bf16_f32 v20, v20, v21
    v_cvt_pk_bf16_f32 v22, v22, v23
    v_accvgpr_write_b32 a26, v20
    v_accvgpr_write_b32 a27, v22
    s_waitcnt lgkmcnt(0)
    s_add_u32 m0, s30, 32768
    s_add_u32 s29, s39, 8192
    buffer_load_dwordx4 v72, s[20:23], s29 offen offset:0 nt lds
    buffer_load_dwordx4 v73, s[20:23], s29 offen offset:1024 nt lds
    buffer_load_dwordx4 v74, s[20:23], s29 offen offset:2048 nt lds
    buffer_load_dwordx4 v75, s[20:23], s29 offen offset:3072 nt lds
    v_lshlrev_b32 v20, 16, v124
    v_and_b32 v21, s31, v124
    v_lshlrev_b32 v22, 16, v125
    v_and_b32 v23, s31, v125
    v_pk_mul_f32 v[20:21], v[20:21], s[34:35] op_sel_hi:[1,0]
    v_pk_mul_f32 v[22:23], v[22:23], s[34:35] op_sel_hi:[1,0]
    v_cvt_pk_bf16_f32 v20, v20, v21
    v_cvt_pk_bf16_f32 v22, v22, v23
    v_accvgpr_write_b32 a28, v20
    v_accvgpr_write_b32 a29, v22
    v_lshlrev_b32 v20, 16, v126
    v_and_b32 v21, s31, v126
    v_lshlrev_b32 v22, 16, v127
    v_and_b32 v23, s31, v127
    v_pk_mul_f32 v[20:21], v[20:21], s[34:35] op_sel_hi:[1,0]
    v_pk_mul_f32 v[22:23], v[22:23], s[34:35] op_sel_hi:[1,0]
    v_cvt_pk_bf16_f32 v20, v20, v21
    v_cvt_pk_bf16_f32 v22, v22, v23
    v_accvgpr_write_b32 a30, v20
    v_accvgpr_write_b32 a31, v22
    s_nop 1
    v_mfma_f32_16x16x32_bf16 v[48:51], a[64:67], a[16:19], 0
    v_exp_f32 v32, v32
    v_mfma_f32_16x16x32_bf16 v[48:51], a[68:71], a[20:23], v[48:51]
    v_exp_f32 v33, v33
    v_mfma_f32_16x16x32_bf16 v[48:51], a[72:75], a[24:27], v[48:51]
    v_exp_f32 v34, v34
    v_cvt_pk_bf16_f32 v64, v32, v33
    v_mfma_f32_16x16x32_bf16 v[48:51], a[76:79], a[28:31], v[48:51]
    v_exp_f32 v35, v35
    v_mfma_f32_16x16x32_bf16 v[52:55], a[92:95], a[28:31], 0
    v_exp_f32 v36, v36
    v_cvt_pk_bf16_f32 v65, v34, v35
    v_mfma_f32_16x16x32_bf16 v[52:55], a[88:91], a[24:27], v[52:55]
    v_exp_f32 v37, v37
    v_mfma_f32_16x16x32_bf16 v[52:55], a[84:87], a[20:23], v[52:55]
    v_exp_f32 v38, v38
    v_cvt_pk_bf16_f32 v66, v36, v37
    v_mfma_f32_16x16x32_bf16 v[52:55], a[80:83], a[16:19], v[52:55]
    v_exp_f32 v39, v39
    v_mfma_f32_16x16x32_bf16 v[56:59], a[96:99], a[16:19], 0
    v_exp_f32 v40, v40
    v_cvt_pk_bf16_f32 v67, v38, v39
    v_mfma_f32_16x16x32_bf16 v[56:59], a[100:103], a[20:23], v[56:59]
    v_exp_f32 v41, v41
    v_mfma_f32_16x16x32_bf16 v[56:59], a[104:107], a[24:27], v[56:59]
    v_exp_f32 v42, v42
    v_cvt_pk_bf16_f32 v68, v40, v41
    v_mfma_f32_16x16x32_bf16 v[56:59], a[108:111], a[28:31], v[56:59]
    v_exp_f32 v43, v43
    v_mfma_f32_16x16x32_bf16 v[60:63], a[124:127], a[28:31], 0
    v_exp_f32 v44, v44
    v_cvt_pk_bf16_f32 v69, v42, v43
    v_mfma_f32_16x16x32_bf16 v[60:63], a[120:123], a[24:27], v[60:63]
    v_exp_f32 v45, v45
    v_mfma_f32_16x16x32_bf16 v[60:63], a[116:119], a[20:23], v[60:63]
    v_exp_f32 v46, v46
    v_cvt_pk_bf16_f32 v70, v44, v45
    v_mfma_f32_16x16x32_bf16 v[60:63], a[112:115], a[16:19], v[60:63]
    v_exp_f32 v47, v47
    s_nop 0
    v_cvt_pk_bf16_f32 v71, v46, v47
    s_waitcnt vmcnt(4)
    s_barrier
    ds_read_b64_tr_b16 a[128:129], v4 offset:0
    ds_read_b64_tr_b16 a[130:131], v4 offset:4096
    ds_read_b64_tr_b16 a[160:161], v4 offset:8192
    ds_read_b64_tr_b16 a[162:163], v4 offset:12288
    ds_read_b64_tr_b16 a[132:133], v5 offset:0
    ds_read_b64_tr_b16 a[134:135], v5 offset:4096
    ds_read_b64_tr_b16 a[164:165], v5 offset:8192
    ds_read_b64_tr_b16 a[166:167], v5 offset:12288
    ds_read_b64_tr_b16 a[136:137], v6 offset:0
    ds_read_b64_tr_b16 a[138:139], v6 offset:4096
    ds_read_b64_tr_b16 a[168:169], v6 offset:8192
    ds_read_b64_tr_b16 a[170:171], v6 offset:12288
    ds_read_b64_tr_b16 a[140:141], v7 offset:0
    ds_read_b64_tr_b16 a[142:143], v7 offset:4096
    ds_read_b64_tr_b16 a[172:173], v7 offset:8192
    ds_read_b64_tr_b16 a[174:175], v7 offset:12288
    ds_read_b64_tr_b16 a[144:145], v8 offset:0
    ds_read_b64_tr_b16 a[146:147], v8 offset:4096
    ds_read_b64_tr_b16 a[176:177], v8 offset:8192
    ds_read_b64_tr_b16 a[178:179], v8 offset:12288
    ds_read_b64_tr_b16 a[148:149], v9 offset:0
    ds_read_b64_tr_b16 a[150:151], v9 offset:4096
    ds_read_b64_tr_b16 a[180:181], v9 offset:8192
    ds_read_b64_tr_b16 a[182:183], v9 offset:12288
    ds_read_b64_tr_b16 a[152:153], v10 offset:0
    ds_read_b64_tr_b16 a[154:155], v10 offset:4096
    ds_read_b64_tr_b16 a[184:185], v10 offset:8192
    ds_read_b64_tr_b16 a[186:187], v10 offset:12288
    ds_read_b64_tr_b16 a[156:157], v11 offset:0
    ds_read_b64_tr_b16 a[158:159], v11 offset:4096
    ds_read_b64_tr_b16 a[188:189], v11 offset:8192
    ds_read_b64_tr_b16 a[190:191], v11 offset:12288
    s_add_u32 m0, s30, 16384
    s_nop 0
    buffer_load_dwordx4 v12, s[12:15], s32 offen offset:0 nt lds
    buffer_load_dwordx4 v13, s[12:15], s32 offen offset:1024 nt lds
    buffer_load_dwordx4 v14, s[12:15], s32 offen offset:2048 nt lds
    buffer_load_dwordx4 v15, s[12:15], s32 offen offset:3072 nt lds
    s_branch S_B3E
Z_A3E:
.p2align 6
T_E3:
    s_branch L_backE
    s_nop 0
S_E3:
    s_waitcnt vmcnt(0)
    s_nop 7
    v_accvgpr_read_b32 v104, a192
    v_accvgpr_read_b32 v20, a193
    v_add_f32 v104, v104, v20
    v_rcp_f32 v20, v104
    s_nop 0
    v_pk_mul_f32 v[128:129], v[128:129], v[20:21] op_sel_hi:[1,0]
    v_pk_mul_f32 v[130:131], v[130:131], v[20:21] op_sel_hi:[1,0]
    v_pk_mul_f32 v[132:133], v[132:133], v[20:21] op_sel_hi:[1,0]
    v_pk_mul_f32 v[134:135], v[134:135], v[20:21] op_sel_hi:[1,0]
    v_pk_mul_f32 v[136:137], v[136:137], v[20:21] op_sel_hi:[1,0]
    v_pk_mul_f32 v[138:139], v[138:139], v[20:21] op_sel_hi:[1,0]
    v_pk_mul_f32 v[140:141], v[140:141], v[20:21] op_sel_hi:[1,0]
    v_pk_mul_f32 v[142:143], v[142:143], v[20:21] op_sel_hi:[1,0]
    v_pk_mul_f32 v[144:145], v[144:145], v[20:21] op_sel_hi:[1,0]
    v_pk_mul_f32 v[146:147], v[146:147], v[20:21] op_sel_hi:[1,0]
    v_pk_mul_f32 v[148:149], v[148:149], v[20:21] op_sel_hi:[1,0]
    v_pk_mul_f32 v[150:151], v[150:151], v[20:21] op_sel_hi:[1,0]
    v_pk_mul_f32 v[152:153], v[152:153], v[20:21] op_sel_hi:[1,0]
    v_pk_mul_f32 v[154:155], v[154:155], v[20:21] op_sel_hi:[1,0]
    v_pk_mul_f32 v[156:157], v[156:157], v[20:21] op_sel_hi:[1,0]
    v_pk_mul_f32 v[158:159], v[158:159], v[20:21] op_sel_hi:[1,0]
    v_cvt_pk_bf16_f32 v112, v128, v129
    v_cvt_pk_bf16_f32 v113, v130, v131
    ds_write_b64 v26, v[112:113] offset:0
    v_cvt_pk_bf16_f32 v114, v132, v133
    v_cvt_pk_bf16_f32 v115, v134, v135
    ds_write_b64 v27, v[114:115] offset:0
    v_cvt_pk_bf16_f32 v116, v136, v137
    v_cvt_pk_bf16_f32 v117, v138, v139
    ds_write_b64 v28, v[116:117] offset:0
    v_cvt_pk_bf16_f32 v118, v140, v141
    v_cvt_pk_bf16_f32 v119, v142, v143
    ds_write_b64 v29, v[118:119] offset:0
    v_cvt_pk_bf16_f32 v120, v144, v145
    v_cvt_pk_bf16_f32 v121, v146, v147
    ds_write_b64 v30, v[120:121] offset:0
    v_cvt_pk_bf16_f32 v122, v148, v149
    v_cvt_pk_bf16_f32 v123, v150, v151
    ds_write_b64 v31, v[122:123] offset:0
    v_cvt_pk_bf16_f32 v124, v152, v153
    v_cvt_pk_bf16_f32 v125, v154, v155
    ds_write_b64 v19, v[124:125] offset:0
    v_cvt_pk_bf16_f32 v126, v156, v157
    v_cvt_pk_bf16_f32 v127, v158, v159
    ds_write_b64 v108, v[126:127] offset:0
    v_mfma_f32_16x16x32_bf16 v[160:163], a[128:131], v[72:75], v[160:163]
    v_exp_f32 v224, v224
    v_mfma_f32_16x16x32_bf16 v[160:163], a[160:163], v[76:79], v[160:163]
    s_waitcnt lgkmcnt(0)
    v_exp_f32 v225, v225
    v_mfma_f32_16x16x32_bf16 v[164:167], a[164:167], v[76:79], v[164:167]
    ds_read_b128 v[128:131], v100 offset:0
    v_exp_f32 v226, v226
    v_cvt_pk_bf16_f32 v240, v224, v225
    v_mfma_f32_16x16x32_bf16 v[164:167], a[132:135], v[72:75], v[164:167]
    ds_read_b128 v[132:135], v101 offset:1024
    v_exp_f32 v227, v227
    v_mfma_f32_16x16x32_bf16 v[168:171], a[136:139], v[72:75], v[168:171]
    ds_read_b128 v[136:139], v102 offset:2048
    v_exp_f32 v228, v228
    v_cvt_pk_bf16_f32 v241, v226, v227
    v_mfma_f32_16x16x32_bf16 v[168:171], a[168:171], v[76:79], v[168:171]
    ds_read_b128 v[140:143], v103 offset:3072
    v_exp_f32 v229, v229
    v_mfma_f32_16x16x32_bf16 v[172:175], a[172:175], v[76:79], v[172:175]
    v_exp_f32 v230, v230
    v_cvt_pk_bf16_f32 v242, v228, v229
    v_mfma_f32_16x16x32_bf16 v[172:175], a[140:143], v[72:75], v[172:175]
    v_exp_f32 v231, v231
    v_mfma_f32_16x16x32_bf16 v[176:179], a[144:147], v[72:75], v[176:179]
    v_exp_f32 v232, v232
    v_cvt_pk_bf16_f32 v243, v230, v231
    v_mfma_f32_16x16x32_bf16 v[176:179], a[176:179], v[76:79], v[176:179]
    s_waitcnt lgkmcnt(0)
    v_exp_f32 v233, v233
    v_mfma_f32_16x16x32_bf16 v[180:183], a[180:183], v[76:79], v[180:183]
    buffer_store_dwordx4 v[128:131], v109, s[24:27], 0 offen offset:0 sc1
    v_exp_f32 v234, v234
    v_cvt_pk_bf16_f32 v244, v232, v233
    v_mfma_f32_16x16x32_bf16 v[180:183], a[148:151], v[72:75], v[180:183]
    v_exp_f32 v235, v235
    v_mfma_f32_16x16x32_bf16 v[184:187], a[152:155], v[72:75], v[184:187]
    buffer_store_dwordx4 v[132:135], v109, s[24:27], 0 offen offset:1024 sc1
    v_exp_f32 v236, v236
    v_cvt_pk_bf16_f32 v245, v234, v235
    v_mfma_f32_16x16x32_bf16 v[184:187], a[184:187], v[76:79], v[184:187]
    v_exp_f32 v237, v237
    v_mfma_f32_16x16x32_bf16 v[188:191], a[188:191], v[76:79], v[188:191]
    buffer_store_dwordx4 v[136:139], v109, s[24:27], 0 offen offset:2048 sc1
    v_exp_f32 v238, v238
    v_cvt_pk_bf16_f32 v246, v236, v237
    v_mfma_f32_16x16x32_bf16 v[188:191], a[156:159], v[72:75], v[188:191]
    v_exp_f32 v239, v239
    v_smfmac_f32_16x16x64_bf16 a[196:199], a[208:211], v[72:79], v111
    buffer_store_dwordx4 v[140:143], v109, s[24:27], 0 offen offset:3072 sc1
    v_cvt_pk_bf16_f32 v247, v238, v239
    s_nop 1
    v_mfma_f32_16x16x32_bf16 v[192:195], a[128:131], v[240:243], v[192:195]
    v_mfma_f32_16x16x32_bf16 v[192:195], a[160:163], v[244:247], v[192:195]
    v_mfma_f32_16x16x32_bf16 v[196:199], a[164:167], v[244:247], v[196:199]
    v_mfma_f32_16x16x32_bf16 v[196:199], a[132:135], v[240:243], v[196:199]
    v_mfma_f32_16x16x32_bf16 v[200:203], a[136:139], v[240:243], v[200:203]
    v_mfma_f32_16x16x32_bf16 v[200:203], a[168:171], v[244:247], v[200:203]
    v_mfma_f32_16x16x32_bf16 v[204:207], a[172:175], v[244:247], v[204:207]
    v_mfma_f32_16x16x32_bf16 v[204:207], a[140:143], v[240:243], v[204:207]
    v_mfma_f32_16x16x32_bf16 v[208:211], a[144:147], v[240:243], v[208:211]
    v_mfma_f32_16x16x32_bf16 v[208:211], a[176:179], v[244:247], v[208:211]
    v_mfma_f32_16x16x32_bf16 v[212:215], a[180:183], v[244:247], v[212:215]
    v_mfma_f32_16x16x32_bf16 v[212:215], a[148:151], v[240:243], v[212:215]
    v_mfma_f32_16x16x32_bf16 v[216:219], a[152:155], v[240:243], v[216:219]
    v_mfma_f32_16x16x32_bf16 v[216:219], a[184:187], v[244:247], v[216:219]
    v_mfma_f32_16x16x32_bf16 v[220:223], a[188:191], v[244:247], v[220:223]
    v_mfma_f32_16x16x32_bf16 v[220:223], a[156:159], v[240:243], v[220:223]
    v_smfmac_f32_16x16x64_bf16 a[200:203], a[208:211], v[240:247], v111
    v_accvgpr_read_b32 v105, a196
    v_accvgpr_read_b32 v22, a197
    v_add_f32 v105, v105, v22
    v_rcp_f32 v22, v105
    s_nop 0
    v_pk_mul_f32 v[160:161], v[160:161], v[22:23] op_sel_hi:[1,0]
    v_pk_mul_f32 v[162:163], v[162:163], v[22:23] op_sel_hi:[1,0]
    v_pk_mul_f32 v[164:165], v[164:165], v[22:23] op_sel_hi:[1,0]
    v_pk_mul_f32 v[166:167], v[166:167], v[22:23] op_sel_hi:[1,0]
    v_pk_mul_f32 v[168:169], v[168:169], v[22:23] op_sel_hi:[1,0]
    v_pk_mul_f32 v[170:171], v[170:171], v[22:23] op_sel_hi:[1,0]
    v_pk_mul_f32 v[172:173], v[172:173], v[22:23] op_sel_hi:[1,0]
    v_pk_mul_f32 v[174:175], v[174:175], v[22:23] op_sel_hi:[1,0]
    v_pk_mul_f32 v[176:177], v[176:177], v[22:23] op_sel_hi:[1,0]
    v_pk_mul_f32 v[178:179], v[178:179], v[22:23] op_sel_hi:[1,0]
    v_pk_mul_f32 v[180:181], v[180:181], v[22:23] op_sel_hi:[1,0]
    v_pk_mul_f32 v[182:183], v[182:183], v[22:23] op_sel_hi:[1,0]
    v_pk_mul_f32 v[184:185], v[184:185], v[22:23] op_sel_hi:[1,0]
    v_pk_mul_f32 v[186:187], v[186:187], v[22:23] op_sel_hi:[1,0]
    v_pk_mul_f32 v[188:189], v[188:189], v[22:23] op_sel_hi:[1,0]
    v_pk_mul_f32 v[190:191], v[190:191], v[22:23] op_sel_hi:[1,0]
    v_cvt_pk_bf16_f32 v112, v160, v161
    v_cvt_pk_bf16_f32 v113, v162, v163
    ds_write_b64 v26, v[112:113] offset:16384
    v_cvt_pk_bf16_f32 v114, v164, v165
    v_cvt_pk_bf16_f32 v115, v166, v167
    ds_write_b64 v27, v[114:115] offset:16384
    v_cvt_pk_bf16_f32 v116, v168, v169
    v_cvt_pk_bf16_f32 v117, v170, v171
    ds_write_b64 v28, v[116:117] offset:16384
    v_cvt_pk_bf16_f32 v118, v172, v173
    v_cvt_pk_bf16_f32 v119, v174, v175
    ds_write_b64 v29, v[118:119] offset:16384
    v_cvt_pk_bf16_f32 v120, v176, v177
    v_cvt_pk_bf16_f32 v121, v178, v179
    ds_write_b64 v30, v[120:121] offset:16384
    v_cvt_pk_bf16_f32 v122, v180, v181
    v_cvt_pk_bf16_f32 v123, v182, v183
    ds_write_b64 v31, v[122:123] offset:16384
    v_cvt_pk_bf16_f32 v124, v184, v185
    v_cvt_pk_bf16_f32 v125, v186, v187
    ds_write_b64 v19, v[124:125] offset:16384
    v_cvt_pk_bf16_f32 v126, v188, v189
    v_cvt_pk_bf16_f32 v127, v190, v191
    ds_write_b64 v108, v[126:127] offset:16384
    s_waitcnt lgkmcnt(0)
    ds_read_b128 v[160:163], v100 offset:16384
    ds_read_b128 v[164:167], v101 offset:17408
    ds_read_b128 v[168:171], v102 offset:18432
    ds_read_b128 v[172:175], v103 offset:19456
    v_accvgpr_read_b32 v106, a200
    v_accvgpr_read_b32 v20, a201
    v_add_f32 v106, v106, v20
    v_rcp_f32 v20, v106
    s_nop 0
    v_pk_mul_f32 v[192:193], v[192:193], v[20:21] op_sel_hi:[1,0]
    v_pk_mul_f32 v[194:195], v[194:195], v[20:21] op_sel_hi:[1,0]
    v_pk_mul_f32 v[196:197], v[196:197], v[20:21] op_sel_hi:[1,0]
    v_pk_mul_f32 v[198:199], v[198:199], v[20:21] op_sel_hi:[1,0]
    v_pk_mul_f32 v[200:201], v[200:201], v[20:21] op_sel_hi:[1,0]
    v_pk_mul_f32 v[202:203], v[202:203], v[20:21] op_sel_hi:[1,0]
    v_pk_mul_f32 v[204:205], v[204:205], v[20:21] op_sel_hi:[1,0]
    v_pk_mul_f32 v[206:207], v[206:207], v[20:21] op_sel_hi:[1,0]
    s_waitcnt lgkmcnt(0)
    v_pk_mul_f32 v[208:209], v[208:209], v[20:21] op_sel_hi:[1,0]
    v_pk_mul_f32 v[210:211], v[210:211], v[20:21] op_sel_hi:[1,0]
    buffer_store_dwordx4 v[160:163], v109, s[24:27], s8 offen offset:0 sc1
    v_pk_mul_f32 v[212:213], v[212:213], v[20:21] op_sel_hi:[1,0]
    v_pk_mul_f32 v[214:215], v[214:215], v[20:21] op_sel_hi:[1,0]
    buffer_store_dwordx4 v[164:167], v109, s[24:27], s8 offen offset:1024 sc1
    v_pk_mul_f32 v[216:217], v[216:217], v[20:21] op_sel_hi:[1,0]
    v_pk_mul_f32 v[218:219], v[218:219], v[20:21] op_sel_hi:[1,0]
    buffer_store_dwordx4 v[168:171], v109, s[24:27], s8 offen offset:2048 sc1
    v_pk_mul_f32 v[220:221], v[220:221], v[20:21] op_sel_hi:[1,0]
    v_pk_mul_f32 v[222:223], v[222:223], v[20:21] op_sel_hi:[1,0]
    buffer_store_dwordx4 v[172:175], v109, s[24:27], s8 offen offset:3072 sc1
    v_cvt_pk_bf16_f32 v112, v192, v193
    v_cvt_pk_bf16_f32 v113, v194, v195
    ds_write_b64 v26, v[112:113] offset:32768
    v_cvt_pk_bf16_f32 v114, v196, v197
    v_cvt_pk_bf16_f32 v115, v198, v199
    ds_write_b64 v27, v[114:115] offset:32768
    v_cvt_pk_bf16_f32 v116, v200, v201
    v_cvt_pk_bf16_f32 v117, v202, v203
    ds_write_b64 v28, v[116:117] offset:32768
    v_cvt_pk_bf16_f32 v118, v204, v205
    v_cvt_pk_bf16_f32 v119, v206, v207
    ds_write_b64 v29, v[118:119] offset:32768
    v_cvt_pk_bf16_f32 v120, v208, v209
    v_cvt_pk_bf16_f32 v121, v210, v211
    ds_write_b64 v30, v[120:121] offset:32768
    v_cvt_pk_bf16_f32 v122, v212, v213
    v_cvt_pk_bf16_f32 v123, v214, v215
    ds_write_b64 v31, v[122:123] offset:32768
    v_cvt_pk_bf16_f32 v124, v216, v217
    v_cvt_pk_bf16_f32 v125, v218, v219
    ds_write_b64 v19, v[124:125] offset:32768
    v_cvt_pk_bf16_f32 v126, v220, v221
    v_cvt_pk_bf16_f32 v127, v222, v223
    ds_write_b64 v108, v[126:127] offset:32768
    v_add_f32 v21, v104, v105
    v_add_f32 v21, v21, v106
    s_waitcnt lgkmcnt(0)
    ds_read_b128 v[192:195], v100 offset:32768
    ds_read_b128 v[196:199], v101 offset:33792
    ds_read_b128 v[200:203], v102 offset:34816
    ds_read_b128 v[204:207], v103 offset:35840
    v_cmp_nlt_f32 vcc, v21, s35
    s_waitcnt lgkmcnt(0)
    buffer_store_dwordx4 v[192:195], v109, s[24:27], s9 offen offset:0 sc1
    buffer_store_dwordx4 v[196:199], v109, s[24:27], s9 offen offset:1024 sc1
    buffer_store_dwordx4 v[200:203], v109, s[24:27], s9 offen offset:2048 sc1
    buffer_store_dwordx4 v[204:207], v109, s[24:27], s9 offen offset:3072 sc1
    s_cbranch_vccnz S_slow3
L_fin3:
    s_endpgm
Z_E3:
.p2align 12
T_A3O:
    s_branch L_backE
    s_nop 0
S_A3O:
    s_waitcnt vmcnt(12)
    s_barrier
    ds_read_b128 a[64:67], v0 offset:0
    ds_read_b128 a[68:71], v1 offset:0
    ds_read_b128 a[72:75], v2 offset:0
    ds_read_b128 a[76:79], v3 offset:0
    ds_read_b128 a[80:83], v0 offset:4096
    ds_read_b128 a[84:87], v1 offset:4096
    ds_read_b128 a[88:91], v2 offset:4096
    ds_read_b128 a[92:95], v3 offset:4096
    ds_read_b128 a[96:99], v0 offset:8192
    ds_read_b128 a[100:103], v1 offset:8192
    ds_read_b128 a[104:107], v2 offset:8192
    ds_read_b128 a[108:111], v3 offset:8192
    ds_read_b128 a[112:115], v0 offset:12288
    ds_read_b128 a[116:119], v1 offset:12288
    ds_read_b128 a[120:123], v2 offset:12288
    ds_read_b128 a[124:127], v3 offset:12288
    s_add_u32 m0, s30, 32768
    s_add_u32 s29, s39, 8192
    buffer_load_dwordx4 v72, s[20:23], s29 offen offset:0 nt lds
    buffer_load_dwordx4 v73, s[20:23], s29 offen offset:1024 nt lds
    buffer_load_dwordx4 v74, s[20:23], s29 offen offset:2048 nt lds
    buffer_load_dwordx4 v75, s[20:23], s29 offen offset:3072 nt lds
    s_waitcnt vmcnt(12)
    ds_read_b128 v[112:115], v96 offset:49152
    ds_read_b128 v[116:119], v97 offset:49152
    ds_read_b128 v[120:123], v98 offset:49152
    ds_read_b128 v[124:127], v99 offset:49152
    s_waitcnt lgkmcnt(3)
    v_lshlrev_b32 v20, 16, v112
    v_and_b32 v21, s31, v112
    v_lshlrev_b32 v22, 16, v113
    v_and_b32 v23, s31, v113
    v_pk_mul_f32 v[20:21], v[20:21], s[34:35] op_sel_hi:[1,0]
    v_pk_mul_f32 v[22:23], v[22:23], s[34:35] op_sel_hi:[1,0]
    v_cvt_pk_bf16_f32 v20, v20, v21
    v_cvt_pk_bf16_f32 v22, v22, v23
    v_accvgpr_write_b32 a0, v20
    v_accvgpr_write_b32 a1, v22
    v_lshlrev_b32 v20, 16, v114
    v_and_b32 v21, s31, v114
    v_lshlrev_b32 v22, 16, v115
    v_and_b32 v23, s31, v115
    v_pk_mul_f32 v[20:21], v[20:21], s[34:35] op_sel_hi:[1,0]
    v_pk_mul_f32 v[22:23], v[22:23], s[34:35] op_sel_hi:[1,0]
    v_cvt_pk_bf16_f32 v20, v20, v21
    v_cvt_pk_bf16_f32 v22, v22, v23
    v_accvgpr_write_b32 a2, v20
    v_accvgpr_write_b32 a3, v22
    s_waitcnt lgkmcnt(2)
    v_lshlrev_b32 v20, 16, v116
    v_and_b32 v21, s31, v116
    v_lshlrev_b32 v22, 16, v117
    v_and_b32 v23, s31, v117
    v_pk_mul_f32 v[20:21], v[20:21], s[34:35] op_sel_hi:[1,0]
    v_pk_mul_f32 v[22:23], v[22:23], s[34:35] op_sel_hi:[1,0]
    v_cvt_pk_bf16_f32 v20, v20, v21
    v_cvt_pk_bf16_f32 v22, v22, v23
    v_accvgpr_write_b32 a4, v20
    v_accvgpr_write_b32 a5, v22
    v_lshlrev_b32 v20, 16, v118
    v_and_b32 v21, s31, v118
    v_lshlrev_b32 v22, 16, v119
    v_and_b32 v23, s31, v119
    v_pk_mul_f32 v[20:21], v[20:21], s[34:35] op_sel_hi:[1,0]
    v_pk_mul_f32 v[22:23], v[22:23], s[34:35] op_sel_hi:[1,0]
    v_cvt_pk_bf16_f32 v20, v20, v21
    v_cvt_pk_bf16_f32 v22, v22, v23
    v_accvgpr_write_b32 a6, v20
    v_accvgpr_write_b32 a7, v22
    s_waitcnt lgkmcnt(1)
    v_lshlrev_b32 v20, 16, v120
    v_and_b32 v21, s31, v120
    v_lshlrev_b32 v22, 16, v121
    v_and_b32 v23, s31, v121
    v_pk_mul_f32 v[20:21], v[20:21], s[34:35] op_sel_hi:[1,0]
    v_pk_mul_f32 v[22:23], v[22:23], s[34:35] op_sel_hi:[1,0]
    v_cvt_pk_bf16_f32 v20, v20, v21
    v_cvt_pk_bf16_f32 v22, v22, v23
    v_accvgpr_write_b32 a8, v20
    v_accvgpr_write_b32 a9, v22
    v_lshlrev_b32 v20, 16, v122
    v_and_b32 v21, s31, v122
    v_lshlrev_b32 v22, 16, v123
    v_and_b32 v23, s31, v123
    v_pk_mul_f32 v[20:21], v[20:21], s[34:35] op_sel_hi:[1,0]
    v_pk_mul_f32 v[22:23], v[22:23], s[34:35] op_sel_hi:[1,0]
    v_cvt_pk_bf16_f32 v20, v20, v21
    v_cvt_pk_bf16_f32 v22, v22, v23
    v_accvgpr_write_b32 a10, v20
    v_accvgpr_write_b32 a11, v22
    s_waitcnt lgkmcnt(0)
    s_add_u32 m0, s30, 16384
    s_nop 0
    buffer_load_dwordx4 v12, s[12:15], s32 offen offset:0 nt lds
    buffer_load_dwordx4 v13, s[12:15], s32 offen offset:1024 nt lds
    buffer_load_dwordx4 v14, s[12:15], s32 offen offset:2048 nt lds
    buffer_load_dwordx4 v15, s[12:15], s32 offen offset:3072 nt lds
    v_lshlrev_b32 v20, 16, v124
    v_and_b32 v21, s31, v124
    v_lshlrev_b32 v22, 16, v125
    v_and_b32 v23, s31, v125
    v_pk_mul_f32 v[20:21], v[20:21], s[34:35] op_sel_hi:[1,0]
    v_pk_mul_f32 v[22:23], v[22:23], s[34:35] op_sel_hi:[1,0]
    v_cvt_pk_bf16_f32 v20, v20, v21
    v_cvt_pk_bf16_f32 v22, v22, v23
    v_accvgpr_write_b32 a12, v20
    v_accvgpr_write_b32 a13, v22
    v_lshlrev_b32 v20, 16, v126
    v_and_b32 v21, s31, v126
    v_lshlrev_b32 v22, 16, v127
    v_and_b32 v23, s31, v127
    v_pk_mul_f32 v[20:21], v[20:21], s[34:35] op_sel_hi:[1,0]
    v_pk_mul_f32 v[22:23], v[22:23], s[34:35] op_sel_hi:[1,0]
    v_cvt_pk_bf16_f32 v20, v20, v21
    v_cvt_pk_bf16_f32 v22, v22, v23
    v_accvgpr_write_b32 a14, v20
    v_accvgpr_write_b32 a15, v22
    s_nop 1
    v_mfma_f32_16x16x32_bf16 v[32:35], a[64:67], a[0:3], 0
    v_mfma_f32_16x16x32_bf16 v[32:35], a[68:71], a[4:7], v[32:35]
    v_mfma_f32_16x16x32_bf16 v[32:35], a[72:75], a[8:11], v[32:35]
    v_mfma_f32_16x16x32_bf16 v[32:35], a[76:79], a[12:15], v[32:35]
    v_mfma_f32_16x16x32_bf16 v[36:39], a[92:95], a[12:15], 0
    v_mfma_f32_16x16x32_bf16 v[36:39], a[88:91], a[8:11], v[36:39]
    v_mfma_f32_16x16x32_bf16 v[36:39], a[84:87], a[4:7], v[36:39]
    v_mfma_f32_16x16x32_bf16 v[36:39], a[80:83], a[0:3], v[36:39]
    v_mfma_f32_16x16x32_bf16 v[40:43], a[96:99], a[0:3], 0
    v_mfma_f32_16x16x32_bf16 v[40:43], a[100:103], a[4:7], v[40:43]
    v_mfma_f32_16x16x32_bf16 v[40:43], a[104:107], a[8:11], v[40:43]
    v_mfma_f32_16x16x32_bf16 v[40:43], a[108:111], a[12:15], v[40:43]
    v_mfma_f32_16x16x32_bf16 v[44:47], a[124:127], a[12:15], 0
    v_mfma_f32_16x16x32_bf16 v[44:47], a[120:123], a[8:11], v[44:47]
    v_mfma_f32_16x16x32_bf16 v[44:47], a[116:119], a[4:7], v[44:47]
    v_mfma_f32_16x16x32_bf16 v[44:47], a[112:115], a[0:3], v[44:47]
    s_waitcnt vmcnt(12)
    ds_read_b128 v[112:115], v100 offset:49152
    ds_read_b128 v[116:119], v101 offset:49152
    ds_read_b128 v[120:123], v102 offset:49152
    ds_read_b128 v[124:127], v103 offset:49152
    v_max3_f32 v24, v32, v33, v34
    v_max3_f32 v25, v35, v36, v37
    v_max3_f32 v24, v24, v38, v39
    v_max3_f32 v25, v25, v40, v41
    v_max3_f32 v24, v24, v42, v43
    v_max3_f32 v25, v25, v44, v45
    v_max3_f32 v24, v24, v46, v47
    v_max_f32 v24, v24, v25
    v_mov_b32 v25, v24
    s_nop 1
    v_permlane32_swap_b32 v24, v25
    v_max_f32 v24, v24, v25
    v_mov_b32 v25, v24
    s_nop 1
    v_permlane16_swap_b32 v24, v25
    v_max_f32 v24, v24, v25
    v_sub_f32 v32, v32, v24
    v_sub_f32 v33, v33, v24
    v_sub_f32 v34, v34, v24
    v_sub_f32 v35, v35, v24
    v_sub_f32 v36, v36, v24
    v_sub_f32 v37, v37, v24
    v_sub_f32 v38, v38, v24
    v_sub_f32 v39, v39, v24
    v_sub_f32 v40, v40, v24
    v_sub_f32 v41, v41, v24
    v_sub_f32 v42, v42, v24
    v_sub_f32 v43, v43, v24
    v_sub_f32 v44, v44, v24
    v_sub_f32 v45, v45, v24
    v_sub_f32 v46, v46, v24
    v_sub_f32 v47, v47, v24
    v_sub_f32 v80, 0, v24
    v_sub_f32 v81, 0, v24
    v_sub_f32 v82, 0, v24
    v_sub_f32 v83, 0, v24
    s_waitcnt lgkmcnt(3)
    v_lshlrev_b32 v20, 16, v112
    v_and_b32 v21, s31, v112
    v_lshlrev_b32 v22, 16, v113
    v_and_b32 v23, s31, v113
    v_pk_mul_f32 v[20:21], v[20:21], s[34:35] op_sel_hi:[1,0]
    v_pk_mul_f32 v[22:23], v[22:23], s[34:35] op_sel_hi:[1,0]
    v_cvt_pk_bf16_f32 v20, v20, v21
    v_cvt_pk_bf16_f32 v22, v22, v23
    v_accvgpr_write_b32 a16, v20
    v_accvgpr_write_b32 a17, v22
    v_lshlrev_b32 v20, 16, v114
    v_and_b32 v21, s31, v114
    v_lshlrev_b32 v22, 16, v115
    v_and_b32 v23, s31, v115
    v_pk_mul_f32 v[20:21], v[20:21], s[34:35] op_sel_hi:[1,0]
    v_pk_mul_f32 v[22:23], v[22:23], s[34:35] op_sel_hi:[1,0]
    v_cvt_pk_bf16_f32 v20, v20, v21
    v_cvt_pk_bf16_f32 v22, v22, v23
    v_accvgpr_write_b32 a18, v20
    v_accvgpr_write_b32 a19, v22
    s_waitcnt lgkmcnt(2)
    v_lshlrev_b32 v20, 16, v116
    v_and_b32 v21, s31, v116
    v_lshlrev_b32 v22, 16, v117
    v_and_b32 v23, s31, v117
    v_pk_mul_f32 v[20:21], v[20:21], s[34:35] op_sel_hi:[1,0]
    v_pk_mul_f32 v[22:23], v[22:23], s[34:35] op_sel_hi:[1,0]
    v_cvt_pk_bf16_f32 v20, v20, v21
    v_cvt_pk_bf16_f32 v22, v22, v23
    v_accvgpr_write_b32 a20, v20
    v_accvgpr_write_b32 a21, v22
    v_lshlrev_b32 v20, 16, v118
    v_and_b32 v21, s31, v118
    v_lshlrev_b32 v22, 16, v119
    v_and_b32 v23, s31, v119
    v_pk_mul_f32 v[20:21], v[20:21], s[34:35] op_sel_hi:[1,0]
    v_pk_mul_f32 v[22:23], v[22:23], s[34:35] op_sel_hi:[1,0]
    v_cvt_pk_bf16_f32 v20, v20, v21
    v_cvt_pk_bf16_f32 v22, v22, v23
    v_accvgpr_write_b32 a22, v20
    v_accvgpr_write_b32 a23, v22
    s_waitcnt lgkmcnt(1)
    v_lshlrev_b32 v20, 16, v120
    v_and_b32 v21, s31, v120
    v_lshlrev_b32 v22, 16, v121
    v_and_b32 v23, s31, v121
    v_pk_mul_f32 v[20:21], v[20:21], s[34:35] op_sel_hi:[1,0]
    v_pk_mul_f32 v[22:23], v[22:23], s[34:35] op_sel_hi:[1,0]
    v_cvt_pk_bf16_f32 v20, v20, v21
    v_cvt_pk_bf16_f32 v22, v22, v23
    v_accvgpr_write_b32 a24, v20
    v_accvgpr_write_b32 a25, v22
    v_lshlrev_b32 v20, 16, v122
    v_and_b32 v21, s31, v122
    v_lshlrev_b32 v22, 16, v123
    v_and_b32 v23, s31, v123
    v_pk_mul_f32 v[20:21], v[20:21], s[34:35] op_sel_hi:[1,0]
    v_pk_mul_f32 v[22:23], v[22:23], s[34:35] op_sel_hi:[1,0]
    v_cvt_pk_bf16_f32 v20, v20, v21
    v_cvt_pk_bf16_f32 v22, v22, v23
    v_accvgpr_write_b32 a26, v20
    v_accvgpr_write_b32 a27, v22
    s_waitcnt lgkmcnt(0)
    s_add_u32 m0, s30, 81920
    s_nop 0
    buffer_load_dwordx4 v16, s[16:19], s32 offen offset:0 nt lds
    buffer_load_dwordx4 v17, s[16:19], s32 offen offset:1024 nt lds
    buffer_load_dwordx4 v16, s[16:19], s32 offen offset:2048 nt lds
    buffer_load_dwordx4 v17, s[16:19], s32 offen offset:3072 nt lds
    s_or_b32 s32, s32, 98304
    s_add_u32 s32, s32, 4096
    s_andn2_b32 s32, s32, 98304
    v_lshlrev_b32 v20, 16, v124
    v_and_b32 v21, s31, v124
    v_lshlrev_b32 v22, 16, v125
    v_and_b32 v23, s31, v125
    v_pk_mul_f32 v[20:21], v[20:21], s[34:35] op_sel_hi:[1,0]
    v_pk_mul_f32 v[22:23], v[22:23], s[34:35] op_sel_hi:[1,0]
    v_cvt_pk_bf16_f32 v20, v20, v21
    v_cvt_pk_bf16_f32 v22, v22, v23
    v_accvgpr_write_b32 a28, v20
    v_accvgpr_write_b32 a29, v22
    v_lshlrev_b32 v20, 16, v126
    v_and_b32 v21, s31, v126
    v_lshlrev_b32 v22, 16, v127
    v_and_b32 v23, s31, v127
    v_pk_mul_f32 v[20:21], v[20:21], s[34:35] op_sel_hi:[1,0]
    v_pk_mul_f32 v[22:23], v[22:23], s[34:35] op_sel_hi:[1,0]
    v_cvt_pk_bf16_f32 v20, v20, v21
    v_cvt_pk_bf16_f32 v22, v22, v23
    v_accvgpr_write_b32 a30, v20
    v_accvgpr_write_b32 a31, v22
    s_nop 1
    v_mfma_f32_16x16x32_bf16 v[48:51], a[64:67], a[16:19], 0
    v_exp_f32 v32, v32
    v_mfma_f32_16x16x32_bf16 v[48:51], a[68:71], a[20:23], v[48:51]
    v_exp_f32 v33, v33
    v_mfma_f32_16x16x32_bf16 v[48:51], a[72:75], a[24:27], v[48:51]
    v_exp_f32 v34, v34
    v_cvt_pk_bf16_f32 v64, v32, v33
    v_mfma_f32_16x16x32_bf16 v[48:51], a[76:79], a[28:31], v[48:51]
    v_exp_f32 v35, v35
    v_mfma_f32_16x16x32_bf16 v[52:55], a[92:95], a[28:31], 0
    v_exp_f32 v36, v36
    v_cvt_pk_bf16_f32 v65, v34, v35
    v_mfma_f32_16x16x32_bf16 v[52:55], a[88:91], a[24:27], v[52:55]
    v_exp_f32 v37, v37
    v_mfma_f32_16x16x32_bf16 v[52:55], a[84:87], a[20:23], v[52:55]
    v_exp_f32 v38, v38
    v_cvt_pk_bf16_f32 v66, v36, v37
    v_mfma_f32_16x16x32_bf16 v[52:55], a[80:83], a[16:19], v[52:55]
    v_exp_f32 v39, v39
    v_mfma_f32_16x16x32_bf16 v[56:59], a[96:99], a[16:19], 0
    v_exp_f32 v40, v40
    v_cvt_pk_bf16_f32 v67, v38, v39
    v_mfma_f32_16x16x32_bf16 v[56:59], a[100:103], a[20:23], v[56:59]
    v_exp_f32 v41, v41
    v_mfma_f32_16x16x32_bf16 v[56:59], a[104:107], a[24:27], v[56:59]
    v_exp_f32 v42, v42
    v_cvt_pk_bf16_f32 v68, v40, v41
    v_mfma_f32_16x16x32_bf16 v[56:59], a[108:111], a[28:31], v[56:59]
    v_exp_f32 v43, v43
    v_mfma_f32_16x16x32_bf16 v[60:63], a[124:127], a[28:31], 0
    v_exp_f32 v44, v44
    v_cvt_pk_bf16_f32 v69, v42, v43
    v_mfma_f32_16x16x32_bf16 v[60:63], a[120:123], a[24:27], v[60:63]
    v_exp_f32 v45, v45
    v_mfma_f32_16x16x32_bf16 v[60:63], a[116:119], a[20:23], v[60:63]
    v_exp_f32 v46, v46
    v_cvt_pk_bf16_f32 v70, v44, v45
    v_mfma_f32_16x16x32_bf16 v[60:63], a[112:115], a[16:19], v[60:63]
    v_exp_f32 v47, v47
    s_nop 0
    v_cvt_pk_bf16_f32 v71, v46, v47
    s_waitcnt vmcnt(12)
    s_barrier
    ds_read_b64_tr_b16 a[128:129], v4 offset:0
    ds_read_b64_tr_b16 a[130:131], v4 offset:4096
    ds_read_b64_tr_b16 a[160:161], v4 offset:8192
    ds_read_b64_tr_b16 a[162:163], v4 offset:12288
    ds_read_b64_tr_b16 a[132:133], v5 offset:0
    ds_read_b64_tr_b16 a[134:135], v5 offset:4096
    ds_read_b64_tr_b16 a[164:165], v5 offset:8192
    ds_read_b64_tr_b16 a[166:167], v5 offset:12288
    ds_read_b64_tr_b16 a[136:137], v6 offset:0
    ds_read_b64_tr_b16 a[138:139], v6 offset:4096
    ds_read_b64_tr_b16 a[168:169], v6 offset:8192
    ds_read_b64_tr_b16 a[170:171], v6 offset:12288
    ds_read_b64_tr_b16 a[140:141], v7 offset:0
    ds_read_b64_tr_b16 a[142:143], v7 offset:4096
    ds_read_b64_tr_b16 a[172:173], v7 offset:8192
    ds_read_b64_tr_b16 a[174:175], v7 offset:12288
    ds_read_b64_tr_b16 a[144:145], v8 offset:0
    ds_read_b64_tr_b16 a[146:147], v8 offset:4096
    ds_read_b64_tr_b16 a[176:177], v8 offset:8192
    ds_read_b64_tr_b16 a[178:179], v8 offset:12288
    ds_read_b64_tr_b16 a[148:149], v9 offset:0
    ds_read_b64_tr_b16 a[150:151], v9 offset:4096
    ds_read_b64_tr_b16 a[180:181], v9 offset:8192
    ds_read_b64_tr_b16 a[182:183], v9 offset:12288
    ds_read_b64_tr_b16 a[152:153], v10 offset:0
    ds_read_b64_tr_b16 a[154:155], v10 offset:4096
    ds_read_b64_tr_b16 a[184:185], v10 offset:8192
    ds_read_b64_tr_b16 a[186:187], v10 offset:12288
    ds_read_b64_tr_b16 a[156:157], v11 offset:0
    ds_read_b64_tr_b16 a[158:159], v11 offset:4096
    ds_read_b64_tr_b16 a[188:189], v11 offset:8192
    ds_read_b64_tr_b16 a[190:191], v11 offset:12288
    s_add_u32 m0, s30, 49152
    s_nop 0
    buffer_load_dwordx4 v12, s[12:15], s32 offen offset:0 nt lds
    buffer_load_dwordx4 v13, s[12:15], s32 offen offset:1024 nt lds
    buffer_load_dwordx4 v14, s[12:15], s32 offen offset:2048 nt lds
    buffer_load_dwordx4 v15, s[12:15], s32 offen offset:3072 nt lds
    s_branch S_B3O
Z_A3O:
.p2align 12
T_W4:
    s_branch L_backE
    s_nop 0
S_W4:
    v_mfma_f32_16x16x32_bf16 v[32:35], a[64:67], a[0:3], v[80:83]
    v_exp_f32 v48, v48
    v_exp_f32 v49, v49
    v_exp_f32 v50, v50
    v_exp_f32 v51, v51
    v_exp_f32 v52, v52
    v_exp_f32 v53, v53
    v_exp_f32 v54, v54
    v_exp_f32 v55, v55
    v_exp_f32 v56, v56
    v_exp_f32 v57, v57
    v_exp_f32 v58, v58
    v_exp_f32 v59, v59
    v_exp_f32 v60, v60
    v_exp_f32 v61, v61
    v_exp_f32 v62, v62
    v_exp_f32 v63, v63
    v_mfma_f32_16x16x32_bf16 v[32:35], a[68:71], a[4:7], v[32:35]
    v_xor_b32 v0, s5, v0
    v_mfma_f32_16x16x32_bf16 v[32:35], a[72:75], a[8:11], v[32:35]
    v_mfma_f32_16x16x32_bf16 v[32:35], a[76:79], a[12:15], v[32:35]
    s_waitcnt lgkmcnt(8)
    v_cvt_pk_bf16_f32 v72, v48, v49
    v_mfma_f32_16x16x32_bf16 v[36:39], a[92:95], a[12:15], v[80:83]
    v_mfma_f32_16x16x32_bf16 v[36:39], a[88:91], a[8:11], v[36:39]
    v_xor_b32 v1, s5, v1
    v_mfma_f32_16x16x32_bf16 v[36:39], a[84:87], a[4:7], v[36:39]
    v_mfma_f32_16x16x32_bf16 v[36:39], a[80:83], a[0:3], v[36:39]
    s_waitcnt lgkmcnt(4)
    v_cvt_pk_bf16_f32 v73, v50, v51
    v_mfma_f32_16x16x32_bf16 v[40:43], a[96:99], a[0:3], v[80:83]
    v_mfma_f32_16x16x32_bf16 v[40:43], a[100:103], a[4:7], v[40:43]
    v_xor_b32 v2, s5, v2
    v_mfma_f32_16x16x32_bf16 v[40:43], a[104:107], a[8:11], v[40:43]
    v_mfma_f32_16x16x32_bf16 v[40:43], a[108:111], a[12:15], v[40:43]
    s_waitcnt lgkmcnt(0)
    v_cvt_pk_bf16_f32 v74, v52, v53
    v_mfma_f32_16x16x32_bf16 v[44:47], a[124:127], a[12:15], v[80:83]
    v_mfma_f32_16x16x32_bf16 v[44:47], a[120:123], a[8:11], v[44:47]
    v_xor_b32 v3, s5, v3
    v_mfma_f32_16x16x32_bf16 v[44:47], a[116:119], a[4:7], v[44:47]
    v_mfma_f32_16x16x32_bf16 v[44:47], a[112:115], a[0:3], v[44:47]
    v_cvt_pk_bf16_f32 v75, v54, v55
    v_mfma_f32_16x16x32_bf16 v[192:195], a[128:131], v[64:67], v[192:195]
    v_mfma_f32_16x16x32_bf16 v[192:195], a[160:163], v[68:71], v[192:195]
    v_xor_b32 v4, s4, v4
    v_mfma_f32_16x16x32_bf16 v[196:199], a[164:167], v[68:71], v[196:199]
    v_mfma_f32_16x16x32_bf16 v[196:199], a[132:135], v[64:67], v[196:199]
    v_cvt_pk_bf16_f32 v76, v56, v57
    v_mfma_f32_16x16x32_bf16 v[200:203], a[136:139], v[64:67], v[200:203]
    v_mfma_f32_16x16x32_bf16 v[200:203], a[168:171], v[68:71], v[200:203]
    v_xor_b32 v5, s4, v5
    v_mfma_f32_16x16x32_bf16 v[204:207], a[172:175], v[68:71], v[204:207]
    v_mfma_f32_16x16x32_bf16 v[204:207], a[140:143], v[64:67], v[204:207]
    v_cvt_pk_bf16_f32 v77, v58, v59
    v_mfma_f32_16x16x32_bf16 v[208:211], a[144:147], v[64:67], v[208:211]
    v_mfma_f32_16x16x32_bf16 v[208:211], a[176:179], v[68:71], v[208:211]
    v_xor_b32 v6, s4, v6
    v_mfma_f32_16x16x32_bf16 v[212:215], a[180:183], v[68:71], v[212:215]
    v_mfma_f32_16x16x32_bf16 v[212:215], a[148:151], v[64:67], v[212:215]
    v_cvt_pk_bf16_f32 v78, v60, v61
    v_mfma_f32_16x16x32_bf16 v[216:219], a[152:155], v[64:67], v[216:219]
    v_mfma_f32_16x16x32_bf16 v[216:219], a[184:187], v[68:71], v[216:219]
    v_xor_b32 v7, s4, v7
    v_mfma_f32_16x16x32_bf16 v[220:223], a[188:191], v[68:71], v[220:223]
    v_mfma_f32_16x16x32_bf16 v[220:223], a[156:159], v[64:67], v[220:223]
    s_waitcnt vmcnt(20)
    v_cvt_pk_bf16_f32 v79, v62, v63
    v_smfmac_f32_16x16x64_bf16 a[200:203], a[208:211], v[64:71], v111
    s_barrier
    v_mfma_f32_16x16x32_bf16 v[48:51], a[64:67], a[16:19], v[84:87]
    s_xor_b32 s6, s6, s5
    v_exp_f32 v32, v32
    v_exp_f32 v33, v33
    v_exp_f32 v34, v34
    v_exp_f32 v35, v35
    v_exp_f32 v36, v36
    v_exp_f32 v37, v37
    v_exp_f32 v38, v38
    v_exp_f32 v39, v39
    v_exp_f32 v40, v40
    v_exp_f32 v41, v41
    v_exp_f32 v42, v42
    v_exp_f32 v43, v43
    v_exp_f32 v44, v44
    v_exp_f32 v45, v45
    v_exp_f32 v46, v46
    v_exp_f32 v47, v47
    v_mfma_f32_16x16x32_bf16 v[48:51], a[68:71], a[20:23], v[48:51]
    s_xor_b32 s7, s7, s4
    v_xor_b32 v8, s4, v8
    v_mfma_f32_16x16x32_bf16 v[48:51], a[72:75], a[24:27], v[48:51]
    s_mov_b32 m0, s6
    v_mfma_f32_16x16x32_bf16 v[48:51], a[76:79], a[28:31], v[48:51]
    buffer_load_dwordx4 v16, s[16:19], s32 offen offset:0 nt lds
    v_cvt_pk_bf16_f32 v64, v32, v33
    v_mfma_f32_16x16x32_bf16 v[52:55], a[92:95], a[28:31], v[84:87]
    v_mfma_f32_16x16x32_bf16 v[52:55], a[88:91], a[24:27], v[52:55]
    v_xor_b32 v9, s4, v9
    v_mfma_f32_16x16x32_bf16 v[52:55], a[84:87], a[20:23], v[52:55]
    v_mfma_f32_16x16x32_bf16 v[52:55], a[80:83], a[16:19], v[52:55]
    buffer_load_dwordx4 v17, s[16:19], s32 offen offset:1024 nt lds
    v_cvt_pk_bf16_f32 v65, v34, v35
    v_mfma_f32_16x16x32_bf16 v[56:59], a[96:99], a[16:19], v[84:87]
    v_mfma_f32_16x16x32_bf16 v[56:59], a[100:103], a[20:23], v[56:59]
    v_xor_b32 v10, s4, v10
    v_mfma_f32_16x16x32_bf16 v[56:59], a[104:107], a[24:27], v[56:59]
    v_mfma_f32_16x16x32_bf16 v[56:59], a[108:111], a[28:31], v[56:59]
    buffer_load_dwordx4 v16, s[16:19], s32 offen offset:2048 nt lds
    v_cvt_pk_bf16_f32 v66, v36, v37
    v_mfma_f32_16x16x32_bf16 v[60:63], a[124:127], a[28:31], v[84:87]
    v_mfma_f32_16x16x32_bf16 v[60:63], a[120:123], a[24:27], v[60:63]
    v_xor_b32 v11, s4, v11
    v_mfma_f32_16x16x32_bf16 v[60:63], a[116:119], a[20:23], v[60:63]
    v_mfma_f32_16x16x32_bf16 v[60:63], a[112:115], a[16:19], v[60:63]
    buffer_load_dwordx4 v17, s[16:19], s32 offen offset:3072 nt lds
    v_cvt_pk_bf16_f32 v67, v38, v39
    v_mfma_f32_16x16x32_bf16 v[224:227], a[128:131], v[72:75], v[224:227]
    s_or_b32 s32, s32, 98304
    v_mfma_f32_16x16x32_bf16 v[224:227], a[160:163], v[76:79], v[224:227]
    ds_read_b64_tr_b16 a[128:129], v4 offset:0
    v_mfma_f32_16x16x32_bf16 v[228:231], a[164:167], v[76:79], v[228:231]
    ds_read_b64_tr_b16 a[130:131], v4 offset:4096
    v_mfma_f32_16x16x32_bf16 v[228:231], a[132:135], v[72:75], v[228:231]
    ds_read_b64_tr_b16 a[160:161], v4 offset:8192
    v_cvt_pk_bf16_f32 v68, v40, v41
    v_mfma_f32_16x16x32_bf16 v[232:235], a[136:139], v[72:75], v[232:235]
    ds_read_b64_tr_b16 a[162:163], v4 offset:12288
    v_mfma_f32_16x16x32_bf16 v[232:235], a[168:171], v[76:79], v[232:235]
    ds_read_b64_tr_b16 a[132:133], v5 offset:0
    v_mfma_f32_16x16x32_bf16 v[236:239], a[172:175], v[76:79], v[236:239]
    ds_read_b64_tr_b16 a[134:135], v5 offset:4096
    v_mfma_f32_16x16x32_bf16 v[236:239], a[140:143], v[72:75], v[236:239]
    ds_read_b64_tr_b16 a[164:165], v5 offset:8192
    v_cvt_pk_bf16_f32 v69, v42, v43
    v_mfma_f32_16x16x32_bf16 v[240:243], a[144:147], v[72:75], v[240:243]
    ds_read_b64_tr_b16 a[166:167], v5 offset:12288
    v_mfma_f32_16x16x32_bf16 v[240:243], a[176:179], v[76:79], v[240:243]
    ds_read_b64_tr_b16 a[136:137], v6 offset:0
    v_mfma_f32_16x16x32_bf16 v[244:247], a[180:183], v[76:79], v[244:247]
    ds_read_b64_tr_b16 a[138:139], v6 offset:4096
    v_mfma_f32_16x16x32_bf16 v[244:247], a[148:151], v[72:75], v[244:247]
    ds_read_b64_tr_b16 a[168:169], v6 offset:8192
    v_cvt_pk_bf16_f32 v70, v44, v45
    v_mfma_f32_16x16x32_bf16 v[248:251], a[152:155], v[72:75], v[248:251]
    ds_read_b64_tr_b16 a[170:171], v6 offset:12288
    v_mfma_f32_16x16x32_bf16 v[248:251], a[184:187], v[76:79], v[248:251]
    ds_read_b64_tr_b16 a[140:141], v7 offset:0
    v_mfma_f32_16x16x32_bf16 v[252:255], a[188:191], v[76:79], v[252:255]
    ds_read_b64_tr_b16 a[142:143], v7 offset:4096
    v_mfma_f32_16x16x32_bf16 v[252:255], a[156:159], v[72:75], v[252:255]
    ds_read_b64_tr_b16 a[172:173], v7 offset:8192
    v_cvt_pk_bf16_f32 v71, v46, v47
    v_smfmac_f32_16x16x64_bf16 a[204:207], a[208:211], v[72:79], v111
    ds_read_b64_tr_b16 a[174:175], v7 offset:12288
    v_mfma_f32_16x16x32_bf16 v[32:35], a[64:67], a[32:35], v[88:91]
    ds_read_b64_tr_b16 a[144:145], v8 offset:0
    v_exp_f32 v48, v48
    v_exp_f32 v49, v49
    v_exp_f32 v50, v50
    v_exp_f32 v51, v51
    v_exp_f32 v52, v52
    v_exp_f32 v53, v53
    v_exp_f32 v54, v54
    v_exp_f32 v55, v55
    v_exp_f32 v56, v56
    v_exp_f32 v57, v57
    v_exp_f32 v58, v58
    v_exp_f32 v59, v59
    v_exp_f32 v60, v60
    v_exp_f32 v61, v61
    v_exp_f32 v62, v62
    v_exp_f32 v63, v63
    v_mfma_f32_16x16x32_bf16 v[32:35], a[68:71], a[36:39], v[32:35]
    ds_read_b64_tr_b16 a[146:147], v8 offset:4096
    v_mfma_f32_16x16x32_bf16 v[32:35], a[72:75], a[40:43], v[32:35]
    ds_read_b64_tr_b16 a[176:177], v8 offset:8192
    v_mfma_f32_16x16x32_bf16 v[32:35], a[76:79], a[44:47], v[32:35]
    ds_read_b64_tr_b16 a[178:179], v8 offset:12288
    v_cvt_pk_bf16_f32 v72, v48, v49
    v_mfma_f32_16x16x32_bf16 v[36:39], a[92:95], a[44:47], v[88:91]
    ds_read_b64_tr_b16 a[148:149], v9 offset:0
    v_mfma_f32_16x16x32_bf16 v[36:39], a[88:91], a[40:43], v[36:39]
    ds_read_b64_tr_b16 a[150:151], v9 offset:4096
    v_mfma_f32_16x16x32_bf16 v[36:39], a[84:87], a[36:39], v[36:39]
    ds_read_b64_tr_b16 a[180:181], v9 offset:8192
    v_mfma_f32_16x16x32_bf16 v[36:39], a[80:83], a[32:35], v[36:39]
    ds_read_b64_tr_b16 a[182:183], v9 offset:12288
    v_cvt_pk_bf16_f32 v73, v50, v51
    v_mfma_f32_16x16x32_bf16 v[40:43], a[96:99], a[32:35], v[88:91]
    ds_read_b64_tr_b16 a[152:153], v10 offset:0
    v_mfma_f32_16x16x32_bf16 v[40:43], a[100:103], a[36:39], v[40:43]
    ds_read_b64_tr_b16 a[154:155], v10 offset:4096
    v_mfma_f32_16x16x32_bf16 v[40:43], a[104:107], a[40:43], v[40:43]
    ds_read_b64_tr_b16 a[184:185], v10 offset:8192
    v_mfma_f32_16x16x32_bf16 v[40:43], a[108:111], a[44:47], v[40:43]
    ds_read_b64_tr_b16 a[186:187], v10 offset:12288
    v_cvt_pk_bf16_f32 v74, v52, v53
    v_mfma_f32_16x16x32_bf16 v[44:47], a[124:127], a[44:47], v[88:91]
    ds_read_b64_tr_b16 a[156:157], v11 offset:0
    v_mfma_f32_16x16x32_bf16 v[44:47], a[120:123], a[40:43], v[44:47]
    ds_read_b64_tr_b16 a[158:159], v11 offset:4096
    v_mfma_f32_16x16x32_bf16 v[44:47], a[116:119], a[36:39], v[44:47]
    ds_read_b64_tr_b16 a[188:189], v11 offset:8192
    v_mfma_f32_16x16x32_bf16 v[44:47], a[112:115], a[32:35], v[44:47]
    ds_read_b64_tr_b16 a[190:191], v11 offset:12288
    s_waitcnt lgkmcnt(15)
    v_cvt_pk_bf16_f32 v75, v54, v55
    v_mfma_f32_16x16x32_bf16 v[128:131], a[128:131], v[64:67], v[128:131]
    s_add_u32 s32, s32, 4096
    v_mfma_f32_16x16x32_bf16 v[128:131], a[160:163], v[68:71], v[128:131]
    s_andn2_b32 s32, s32, 98304
    v_mfma_f32_16x16x32_bf16 v[132:135], a[164:167], v[68:71], v[132:135]
    s_mov_b32 m0, s7
    v_mfma_f32_16x16x32_bf16 v[132:135], a[132:135], v[64:67], v[132:135]
    s_waitcnt lgkmcnt(15)
    v_cvt_pk_bf16_f32 v76, v56, v57
    v_mfma_f32_16x16x32_bf16 v[136:139], a[136:139], v[64:67], v[136:139]
    buffer_load_dwordx4 v12, s[12:15], s32 offen offset:0 nt lds
    v_mfma_f32_16x16x32_bf16 v[136:139], a[168:171], v[68:71], v[136:139]
    v_mfma_f32_16x16x32_bf16 v[140:143], a[172:175], v[68:71], v[140:143]
    v_mfma_f32_16x16x32_bf16 v[140:143], a[140:143], v[64:67], v[140:143]
    s_waitcnt lgkmcnt(8)
    v_cvt_pk_bf16_f32 v77, v58, v59
    v_mfma_f32_16x16x32_bf16 v[144:147], a[144:147], v[64:67], v[144:147]
    buffer_load_dwordx4 v13, s[12:15], s32 offen offset:1024 nt lds
    v_mfma_f32_16x16x32_bf16 v[144:147], a[176:179], v[68:71], v[144:147]
    v_mfma_f32_16x16x32_bf16 v[148:151], a[180:183], v[68:71], v[148:151]
    v_mfma_f32_16x16x32_bf16 v[148:151], a[148:151], v[64:67], v[148:151]
    s_waitcnt lgkmcnt(0)
    v_cvt_pk_bf16_f32 v78, v60, v61
    v_mfma_f32_16x16x32_bf16 v[152:155], a[152:155], v[64:67], v[152:155]
    buffer_load_dwordx4 v14, s[12:15], s32 offen offset:2048 nt lds
    v_mfma_f32_16x16x32_bf16 v[152:155], a[184:187], v[68:71], v[152:155]
    v_mfma_f32_16x16x32_bf16 v[156:159], a[188:191], v[68:71], v[156:159]
    v_mfma_f32_16x16x32_bf16 v[156:159], a[156:159], v[64:67], v[156:159]
    v_cvt_pk_bf16_f32 v79, v62, v63
    v_smfmac_f32_16x16x64_bf16 a[192:195], a[208:211], v[64:71], v111
    buffer_load_dwordx4 v15, s[12:15], s32 offen offset:3072 nt lds
    v_mfma_f32_16x16x32_bf16 v[48:51], a[64:67], a[48:51], v[92:95]
    s_waitcnt vmcnt(24)
    s_barrier
    s_mov_b32 s4, s5
    v_exp_f32 v32, v32
    v_exp_f32 v33, v33
    v_exp_f32 v34, v34
    v_exp_f32 v35, v35
    v_exp_f32 v36, v36
    v_exp_f32 v37, v37
    v_exp_f32 v38, v38
    v_exp_f32 v39, v39
    v_exp_f32 v40, v40
    v_exp_f32 v41, v41
    v_exp_f32 v42, v42
    v_exp_f32 v43, v43
    v_exp_f32 v44, v44
    v_exp_f32 v45, v45
    v_exp_f32 v46, v46
    v_exp_f32 v47, v47
    v_mfma_f32_16x16x32_bf16 v[48:51], a[68:71], a[52:55], v[48:51]
    ds_read_b128 a[64:67], v0 offset:0
    v_mfma_f32_16x16x32_bf16 v[48:51], a[72:75], a[56:59], v[48:51]
    s_xor_b32 s5, s5, 0xc000
    v_mfma_f32_16x16x32_bf16 v[48:51], a[76:79], a[60:63], v[48:51]
    ds_read_b128 a[68:71], v1 offset:0
    v_cvt_pk_bf16_f32 v64, v32, v33
    v_mfma_f32_16x16x32_bf16 v[52:55], a[92:95], a[60:63], v[92:95]
    s_add_u32 s33, s33, 1
    v_mfma_f32_16x16x32_bf16 v[52:55], a[88:91], a[56:59], v[52:55]
    ds_read_b128 a[72:75], v2 offset:0
    v_mfma_f32_16x16x32_bf16 v[52:55], a[84:87], a[52:55], v[52:55]
    v_mfma_f32_16x16x32_bf16 v[52:55], a[80:83], a[48:51], v[52:55]
    ds_read_b128 a[76:79], v3 offset:0
    v_cvt_pk_bf16_f32 v65, v34, v35
    v_mfma_f32_16x16x32_bf16 v[56:59], a[96:99], a[48:51], v[92:95]
    v_mfma_f32_16x16x32_bf16 v[56:59], a[100:103], a[52:55], v[56:59]
    ds_read_b128 a[92:95], v3 offset:4096
    v_mfma_f32_16x16x32_bf16 v[56:59], a[104:107], a[56:59], v[56:59]
    v_mfma_f32_16x16x32_bf16 v[56:59], a[108:111], a[60:63], v[56:59]
    ds_read_b128 a[88:91], v2 offset:4096
    v_cvt_pk_bf16_f32 v66, v36, v37
    v_mfma_f32_16x16x32_bf16 v[60:63], a[124:127], a[60:63], v[92:95]
    v_mfma_f32_16x16x32_bf16 v[60:63], a[120:123], a[56:59], v[60:63]
    ds_read_b128 a[84:87], v1 offset:4096
    v_mfma_f32_16x16x32_bf16 v[60:63], a[116:119], a[52:55], v[60:63]
    v_mfma_f32_16x16x32_bf16 v[60:63], a[112:115], a[48:51], v[60:63]
    ds_read_b128 a[80:83], v0 offset:4096
    v_cvt_pk_bf16_f32 v67, v38, v39
    v_mfma_f32_16x16x32_bf16 v[160:163], a[128:131], v[72:75], v[160:163]
    v_mfma_f32_16x16x32_bf16 v[160:163], a[160:163], v[76:79], v[160:163]
    ds_read_b128 a[96:99], v0 offset:8192
    v_mfma_f32_16x16x32_bf16 v[164:167], a[164:167], v[76:79], v[164:167]
    v_mfma_f32_16x16x32_bf16 v[164:167], a[132:135], v[72:75], v[164:167]
    ds_read_b128 a[100:103], v1 offset:8192
    v_cvt_pk_bf16_f32 v68, v40, v41
    v_mfma_f32_16x16x32_bf16 v[168:171], a[136:139], v[72:75], v[168:171]
    v_mfma_f32_16x16x32_bf16 v[168:171], a[168:171], v[76:79], v[168:171]
    ds_read_b128 a[104:107], v2 offset:8192
    v_mfma_f32_16x16x32_bf16 v[172:175], a[172:175], v[76:79], v[172:175]
    v_mfma_f32_16x16x32_bf16 v[172:175], a[140:143], v[72:75], v[172:175]
    ds_read_b128 a[108:111], v3 offset:8192
    v_cvt_pk_bf16_f32 v69, v42, v43
    v_mfma_f32_16x16x32_bf16 v[176:179], a[144:147], v[72:75], v[176:179]
    v_mfma_f32_16x16x32_bf16 v[176:179], a[176:179], v[76:79], v[176:179]
    ds_read_b128 a[124:127], v3 offset:12288
    v_mfma_f32_16x16x32_bf16 v[180:183], a[180:183], v[76:79], v[180:183]
    v_mfma_f32_16x16x32_bf16 v[180:183], a[148:151], v[72:75], v[180:183]
    ds_read_b128 a[120:123], v2 offset:12288
    v_cvt_pk_bf16_f32 v70, v44, v45
    v_mfma_f32_16x16x32_bf16 v[184:187], a[152:155], v[72:75], v[184:187]
    v_mfma_f32_16x16x32_bf16 v[184:187], a[184:187], v[76:79], v[184:187]
    ds_read_b128 a[116:119], v1 offset:12288
    v_mfma_f32_16x16x32_bf16 v[188:191], a[188:191], v[76:79], v[188:191]
    s_cmp_lt_u32 s33, 4
    v_mfma_f32_16x16x32_bf16 v[188:191], a[156:159], v[72:75], v[188:191]
    ds_read_b128 a[112:115], v0 offset:12288
    v_cvt_pk_bf16_f32 v71, v46, v47
    v_smfmac_f32_16x16x64_bf16 a[196:199], a[208:211], v[72:79], v111
    s_waitcnt lgkmcnt(12)
    s_cbranch_scc1 S_W4
    s_cmp_eq_u32 s11, 0
    s_cbranch_scc1 S_L4E
    s_branch S_L4O
Z_W4:
.p2align 6
T_B3E:
    s_branch L_backE
    s_nop 0
S_B3E:
    s_waitcnt vmcnt(4)
    ds_read_b128 v[112:115], v96 offset:32768
    ds_read_b128 v[116:119], v97 offset:32768
    ds_read_b128 v[120:123], v98 offset:32768
    ds_read_b128 v[124:127], v99 offset:32768
    v_max3_f32 v24, v48, v49, v50
    v_max3_f32 v25, v51, v52, v53
    v_max3_f32 v24, v24, v54, v55
    v_max3_f32 v25, v25, v56, v57
    v_max3_f32 v24, v24, v58, v59
    v_max3_f32 v25, v25, v60, v61
    v_max3_f32 v24, v24, v62, v63
    v_max_f32 v24, v24, v25
    v_mov_b32 v25, v24
    s_nop 1
    v_permlane32_swap_b32 v24, v25
    v_max_f32 v24, v24, v25
    v_mov_b32 v25, v24
    s_nop 1
    v_permlane16_swap_b32 v24, v25
    v_max_f32 v24, v24, v25
    v_sub_f32 v48, v48, v24
    v_sub_f32 v49, v49, v24
    v_sub_f32 v50, v50, v24
    v_sub_f32 v51, v51, v24
    v_sub_f32 v52, v52, v24
    v_sub_f32 v53, v53, v24
    v_sub_f32 v54, v54, v24
    v_sub_f32 v55, v55, v24
    v_sub_f32 v56, v56, v24
    v_sub_f32 v57, v57, v24
    v_sub_f32 v58, v58, v24
    v_sub_f32 v59, v59, v24
    v_sub_f32 v60, v60, v24
    v_sub_f32 v61, v61, v24
    v_sub_f32 v62, v62, v24
    v_sub_f32 v63, v63, v24
    v_sub_f32 v84, 0, v24
    v_sub_f32 v85, 0, v24
    v_sub_f32 v86, 0, v24
    v_sub_f32 v87, 0, v24
    s_waitcnt lgkmcnt(3)
    v_mfma_f32_16x16x32_bf16 v[128:131], a[128:131], v[64:67], v[128:131]
    v_lshlrev_b32 v20, 16, v112
    v_and_b32 v21, s31, v112
    v_lshlrev_b32 v22, 16, v113
    v_and_b32 v23, s31, v113
    v_mul_f32 v20, s34, v20
    v_mul_f32 v21, s34, v21
    v_mfma_f32_16x16x32_bf16 v[128:131], a[160:163], v[68:71], v[128:131]
    v_mul_f32 v22, s34, v22
    v_mul_f32 v23, s34, v23
    v_cvt_pk_bf16_f32 v20, v20, v21
    v_cvt_pk_bf16_f32 v22, v22, v23
    v_accvgpr_write_b32 a32, v20
    v_accvgpr_write_b32 a33, v22
    v_mfma_f32_16x16x32_bf16 v[132:135], a[164:167], v[68:71], v[132:135]
    v_lshlrev_b32 v20, 16, v114
    v_and_b32 v21, s31, v114
    v_lshlrev_b32 v22, 16, v115
    v_and_b32 v23, s31, v115
    v_mul_f32 v20, s34, v20
    v_mul_f32 v21, s34, v21
    v_mfma_f32_16x16x32_bf16 v[132:135], a[132:135], v[64:67], v[132:135]
    v_mul_f32 v22, s34, v22
    v_mul_f32 v23, s34, v23
    v_cvt_pk_bf16_f32 v20, v20, v21
    v_cvt_pk_bf16_f32 v22, v22, v23
    v_accvgpr_write_b32 a34, v20
    v_accvgpr_write_b32 a35, v22
    s_waitcnt lgkmcnt(2)
    v_mfma_f32_16x16x32_bf16 v[136:139], a[136:139], v[64:67], v[136:139]
    v_lshlrev_b32 v20, 16, v116
    v_and_b32 v21, s31, v116
    v_lshlrev_b32 v22, 16, v117
    v_and_b32 v23, s31, v117
    v_mul_f32 v20, s34, v20
    v_mul_f32 v21, s34, v21
    v_mfma_f32_16x16x32_bf16 v[136:139], a[168:171], v[68:71], v[136:139]
    v_mul_f32 v22, s34, v22
    v_mul_f32 v23, s34, v23
    v_cvt_pk_bf16_f32 v20, v20, v21
    v_cvt_pk_bf16_f32 v22, v22, v23
    v_accvgpr_write_b32 a36, v20
    v_accvgpr_write_b32 a37, v22
    v_mfma_f32_16x16x32_bf16 v[140:143], a[172:175], v[68:71], v[140:143]
    v_lshlrev_b32 v20, 16, v118
    v_and_b32 v21, s31, v118
    v_lshlrev_b32 v22, 16, v119
    v_and_b32 v23, s31, v119
    v_mul_f32 v20, s34, v20
    v_mul_f32 v21, s34, v21
    v_mfma_f32_16x16x32_bf16 v[140:143], a[140:143], v[64:67], v[140:143]
    v_mul_f32 v22, s34, v22
    v_mul_f32 v23, s34, v23
    v_cvt_pk_bf16_f32 v20, v20, v21
    v_cvt_pk_bf16_f32 v22, v22, v23
    v_mfma_f32_16x16x32_bf16 v[144:147], a[144:147], v[64:67], v[144:147]
    v_accvgpr_write_b32 a38, v20
    v_accvgpr_write_b32 a39, v22
    s_waitcnt lgkmcnt(1)
    v_mfma_f32_16x16x32_bf16 v[144:147], a[176:179], v[68:71], v[144:147]
    v_lshlrev_b32 v20, 16, v120
    v_and_b32 v21, s31, v120
    v_lshlrev_b32 v22, 16, v121
    v_and_b32 v23, s31, v121
    v_mul_f32 v20, s34, v20
    v_mul_f32 v21, s34, v21
    v_mfma_f32_16x16x32_bf16 v[148:151], a[180:183], v[68:71], v[148:151]
    v_mul_f32 v22, s34, v22
    v_mul_f32 v23, s34, v23
    v_cvt_pk_bf16_f32 v20, v20, v21
    v_cvt_pk_bf16_f32 v22, v22, v23
    v_accvgpr_write_b32 a40, v20
    v_accvgpr_write_b32 a41, v22
    v_mfma_f32_16x16x32_bf16 v[148:151], a[148:151], v[64:67], v[148:151]
    v_lshlrev_b32 v20, 16, v122
    v_and_b32 v21, s31, v122
    v_lshlrev_b32 v22, 16, v123
    v_and_b32 v23, s31, v123
    v_mul_f32 v20, s34, v20
    v_mul_f32 v21, s34, v21
    v_mfma_f32_16x16x32_bf16 v[152:155], a[152:155], v[64:67], v[152:155]
    v_mul_f32 v22, s34, v22
    v_mul_f32 v23, s34, v23
    v_cvt_pk_bf16_f32 v20, v20, v21
    v_cvt_pk_bf16_f32 v22, v22, v23
    v_accvgpr_write_b32 a42, v20
    v_accvgpr_write_b32 a43, v22
    s_waitcnt lgkmcnt(0)
    s_add_u32 m0, s30, 81920
    s_nop 0
    buffer_load_dwordx4 v16, s[16:19], s32 offen offset:0 nt lds
    buffer_load_dwordx4 v17, s[16:19], s32 offen offset:1024 nt lds
    buffer_load_dwordx4 v16, s[16:19], s32 offen offset:2048 nt lds
    buffer_load_dwordx4 v17, s[16:19], s32 offen offset:3072 nt lds
    s_or_b32 s32, s32, 98304
    s_add_u32 s32, s32, 4096
    s_andn2_b32 s32, s32, 98304
    v_mfma_f32_16x16x32_bf16 v[152:155], a[184:187], v[68:71], v[152:155]
    v_lshlrev_b32 v20, 16, v124
    v_and_b32 v21, s31, v124
    v_lshlrev_b32 v22, 16, v125
    v_and_b32 v23, s31, v125
    v_mul_f32 v20, s34, v20
    v_mul_f32 v21, s34, v21
    v_mfma_f32_16x16x32_bf16 v[156:159], a[188:191], v[68:71], v[156:159]
    v_mul_f32 v22, s34, v22
    v_mul_f32 v23, s34, v23
    v_cvt_pk_bf16_f32 v20, v20, v21
    v_cvt_pk_bf16_f32 v22, v22, v23
    v_accvgpr_write_b32 a44, v20
    v_accvgpr_write_b32 a45, v22
    v_mfma_f32_16x16x32_bf16 v[156:159], a[156:159], v[64:67], v[156:159]
    v_lshlrev_b32 v20, 16, v126
    v_and_b32 v21, s31, v126
    v_lshlrev_b32 v22, 16, v127
    v_and_b32 v23, s31, v127
    v_mul_f32 v20, s34, v20
    v_mul_f32 v21, s34, v21
    v_smfmac_f32_16x16x64_bf16 a[192:195], a[208:211], v[64:71], v111
    v_mul_f32 v22, s34, v22
    v_mul_f32 v23, s34, v23
    v_cvt_pk_bf16_f32 v20, v20, v21
    v_cvt_pk_bf16_f32 v22, v22, v23
    v_accvgpr_write_b32 a46, v20
    v_accvgpr_write_b32 a47, v22
    s_nop 1
    v_mfma_f32_16x16x32_bf16 v[224:227], a[64:67], a[32:35], 0
    v_exp_f32 v48, v48
    v_mfma_f32_16x16x32_bf16 v[224:227], a[68:71], a[36:39], v[224:227]
    v_exp_f32 v49, v49
    v_mfma_f32_16x16x32_bf16 v[224:227], a[72:75], a[40:43], v[224:227]
    v_exp_f32 v50, v50
    v_cvt_pk_bf16_f32 v72, v48, v49
    v_mfma_f32_16x16x32_bf16 v[224:227], a[76:79], a[44:47], v[224:227]
    v_exp_f32 v51, v51
    v_mfma_f32_16x16x32_bf16 v[228:231], a[92:95], a[44:47], 0
    v_exp_f32 v52, v52
    v_cvt_pk_bf16_f32 v73, v50, v51
    v_mfma_f32_16x16x32_bf16 v[228:231], a[88:91], a[40:43], v[228:231]
    v_exp_f32 v53, v53
    v_mfma_f32_16x16x32_bf16 v[228:231], a[84:87], a[36:39], v[228:231]
    v_exp_f32 v54, v54
    v_cvt_pk_bf16_f32 v74, v52, v53
    v_mfma_f32_16x16x32_bf16 v[228:231], a[80:83], a[32:35], v[228:231]
    v_exp_f32 v55, v55
    v_mfma_f32_16x16x32_bf16 v[232:235], a[96:99], a[32:35], 0
    v_exp_f32 v56, v56
    v_cvt_pk_bf16_f32 v75, v54, v55
    v_mfma_f32_16x16x32_bf16 v[232:235], a[100:103], a[36:39], v[232:235]
    v_exp_f32 v57, v57
    v_mfma_f32_16x16x32_bf16 v[232:235], a[104:107], a[40:43], v[232:235]
    v_exp_f32 v58, v58
    v_cvt_pk_bf16_f32 v76, v56, v57
    v_mfma_f32_16x16x32_bf16 v[232:235], a[108:111], a[44:47], v[232:235]
    v_exp_f32 v59, v59
    v_mfma_f32_16x16x32_bf16 v[236:239], a[124:127], a[44:47], 0
    v_exp_f32 v60, v60
    v_cvt_pk_bf16_f32 v77, v58, v59
    v_mfma_f32_16x16x32_bf16 v[236:239], a[120:123], a[40:43], v[236:239]
    v_exp_f32 v61, v61
    v_mfma_f32_16x16x32_bf16 v[236:239], a[116:119], a[36:39], v[236:239]
    v_exp_f32 v62, v62
    v_cvt_pk_bf16_f32 v78, v60, v61
    v_mfma_f32_16x16x32_bf16 v[236:239], a[112:115], a[32:35], v[236:239]
    v_exp_f32 v63, v63
    s_nop 0
    v_cvt_pk_bf16_f32 v79, v62, v63
    s_waitcnt vmcnt(4)
    s_barrier
    ds_read_b128 a[64:67], v0 offset:16384
    ds_read_b128 a[68:71], v1 offset:16384
    ds_read_b128 a[72:75], v2 offset:16384
    ds_read_b128 a[76:79], v3 offset:16384
    ds_read_b128 a[80:83], v0 offset:20480
    ds_read_b128 a[84:87], v1 offset:20480
    ds_read_b128 a[88:91], v2 offset:20480
    ds_read_b128 a[92:95], v3 offset:20480
    ds_read_b128 a[96:99], v0 offset:24576
    ds_read_b128 a[100:103], v1 offset:24576
    ds_read_b128 a[104:107], v2 offset:24576
    ds_read_b128 a[108:111], v3 offset:24576
    ds_read_b128 a[112:115], v0 offset:28672
    ds_read_b128 a[116:119], v1 offset:28672
    ds_read_b128 a[120:123], v2 offset:28672
    ds_read_b128 a[124:127], v3 offset:28672
    s_add_u32 m0, s30, 49152
    s_nop 0
    buffer_load_dwordx4 v12, s[12:15], s32 offen offset:0 nt lds
    buffer_load_dwordx4 v13, s[12:15], s32 offen offset:1024 nt lds
    buffer_load_dwordx4 v14, s[12:15], s32 offen offset:2048 nt lds
    buffer_load_dwordx4 v15, s[12:15], s32 offen offset:3072 nt lds
    v_max3_f32 v24, v224, v225, v226
    v_max3_f32 v25, v227, v228, v229
    v_max3_f32 v24, v24, v230, v231
    v_max3_f32 v25, v25, v232, v233
    v_max3_f32 v24, v24, v234, v235
    v_max3_f32 v25, v25, v236, v237
    v_max3_f32 v24, v24, v238, v239
    v_max_f32 v24, v24, v25
    v_mov_b32 v25, v24
    s_nop 1
    v_permlane32_swap_b32 v24, v25
    v_max_f32 v24, v24, v25
    v_mov_b32 v25, v24
    s_nop 1
    v_permlane16_swap_b32 v24, v25
    v_max_f32 v24, v24, v25
    v_sub_f32 v224, v224, v24
    v_sub_f32 v225, v225, v24
    v_sub_f32 v226, v226, v24
    v_sub_f32 v227, v227, v24
    v_sub_f32 v228, v228, v24
    v_sub_f32 v229, v229, v24
    v_sub_f32 v230, v230, v24
    v_sub_f32 v231, v231, v24
    v_sub_f32 v232, v232, v24
    v_sub_f32 v233, v233, v24
    v_sub_f32 v234, v234, v24
    v_sub_f32 v235, v235, v24
    v_sub_f32 v236, v236, v24
    v_sub_f32 v237, v237, v24
    v_sub_f32 v238, v238, v24
    v_sub_f32 v239, v239, v24
    v_sub_f32 v88, 0, v24
    v_sub_f32 v89, 0, v24
    v_sub_f32 v90, 0, v24
    v_sub_f32 v91, 0, v24
    s_add_u32 m0, s30, 114688
    s_nop 0
    buffer_load_dwordx4 v16, s[16:19], s32 offen offset:0 nt lds
    buffer_load_dwordx4 v17, s[16:19], s32 offen offset:1024 nt lds
    buffer_load_dwordx4 v16, s[16:19], s32 offen offset:2048 nt lds
    buffer_load_dwordx4 v17, s[16:19], s32 offen offset:3072 nt lds
    s_or_b32 s32, s32, 98304
    s_add_u32 s32, s32, 4096
    s_andn2_b32 s32, s32, 98304
    s_add_u32 m0, s30, 32768
    s_nop 0
    buffer_load_dwordx4 v12, s[12:15], s32 offen offset:0 nt lds
    buffer_load_dwordx4 v13, s[12:15], s32 offen offset:1024 nt lds
    buffer_load_dwordx4 v14, s[12:15], s32 offen offset:2048 nt lds
    buffer_load_dwordx4 v15, s[12:15], s32 offen offset:3072 nt lds
    s_add_u32 m0, s30, 98304
    s_nop 0
    buffer_load_dwordx4 v16, s[16:19], s32 offen offset:0 nt lds
    buffer_load_dwordx4 v17, s[16:19], s32 offen offset:1024 nt lds
    buffer_load_dwordx4 v16, s[16:19], s32 offen offset:2048 nt lds
    buffer_load_dwordx4 v17, s[16:19], s32 offen offset:3072 nt lds
    s_or_b32 s32, s32, 98304
    s_add_u32 s32, s32, 4096
    s_andn2_b32 s32, s32, 98304
    s_add_u32 m0, s30, 0
    s_nop 0
    buffer_load_dwordx4 v12, s[12:15], s32 offen offset:0 nt lds
    buffer_load_dwordx4 v13, s[12:15], s32 offen offset:1024 nt lds
    buffer_load_dwordx4 v14, s[12:15], s32 offen offset:2048 nt lds
    buffer_load_dwordx4 v15, s[12:15], s32 offen offset:3072 nt lds
    s_sub_u32 s28, s30, s37
    v_add_u32 v100, s28, v12
    v_add_u32 v101, s28, v13
    v_add_u32 v102, s28, v14
    v_add_u32 v103, s28, v15
    v_xor_b32 v0, 16384, v0
    v_xor_b32 v1, 16384, v1
    v_xor_b32 v2, 16384, v2
    v_xor_b32 v3, 16384, v3
    s_waitcnt lgkmcnt(0)
    s_branch S_W3
Z_B3E:
.p2align 12
T_L4O:
    s_branch L_backE
    s_nop 0
S_L4O:
    v_mfma_f32_16x16x32_bf16 v[32:35], a[64:67], a[0:3], v[80:83]
    v_exp_f32 v48, v48
    v_mfma_f32_16x16x32_bf16 v[32:35], a[68:71], a[4:7], v[32:35]
    v_xor_b32 v0, s5, v0
    v_mfma_f32_16x16x32_bf16 v[32:35], a[72:75], a[8:11], v[32:35]
    v_exp_f32 v49, v49
    v_mfma_f32_16x16x32_bf16 v[32:35], a[76:79], a[12:15], v[32:35]
    s_waitcnt lgkmcnt(8)
    v_cvt_pk_bf16_f32 v72, v48, v49
    v_mfma_f32_16x16x32_bf16 v[36:39], a[92:95], a[12:15], v[80:83]
    v_exp_f32 v50, v50
    v_mfma_f32_16x16x32_bf16 v[36:39], a[88:91], a[8:11], v[36:39]
    v_xor_b32 v1, s5, v1
    v_mfma_f32_16x16x32_bf16 v[36:39], a[84:87], a[4:7], v[36:39]
    v_exp_f32 v51, v51
    v_mfma_f32_16x16x32_bf16 v[36:39], a[80:83], a[0:3], v[36:39]
    s_waitcnt lgkmcnt(4)
    v_cvt_pk_bf16_f32 v73, v50, v51
    v_mfma_f32_16x16x32_bf16 v[40:43], a[96:99], a[0:3], v[80:83]
    v_exp_f32 v52, v52
    v_mfma_f32_16x16x32_bf16 v[40:43], a[100:103], a[4:7], v[40:43]
    v_xor_b32 v2, s5, v2
    v_mfma_f32_16x16x32_bf16 v[40:43], a[104:107], a[8:11], v[40:43]
    v_exp_f32 v53, v53
    v_mfma_f32_16x16x32_bf16 v[40:43], a[108:111], a[12:15], v[40:43]
    s_waitcnt lgkmcnt(0)
    v_cvt_pk_bf16_f32 v74, v52, v53
    v_mfma_f32_16x16x32_bf16 v[44:47], a[124:127], a[12:15], v[80:83]
    v_exp_f32 v54, v54
    v_mfma_f32_16x16x32_bf16 v[44:47], a[120:123], a[8:11], v[44:47]
    v_xor_b32 v3, s5, v3
    v_mfma_f32_16x16x32_bf16 v[44:47], a[116:119], a[4:7], v[44:47]
    v_exp_f32 v55, v55
    v_mfma_f32_16x16x32_bf16 v[44:47], a[112:115], a[0:3], v[44:47]
    v_cvt_pk_bf16_f32 v75, v54, v55
    v_mfma_f32_16x16x32_bf16 v[192:195], a[128:131], v[64:67], v[192:195]
    v_exp_f32 v56, v56
    v_mfma_f32_16x16x32_bf16 v[192:195], a[160:163], v[68:71], v[192:195]
    v_xor_b32 v4, s4, v4
    v_mfma_f32_16x16x32_bf16 v[196:199], a[164:167], v[68:71], v[196:199]
    v_exp_f32 v57, v57
    v_mfma_f32_16x16x32_bf16 v[196:199], a[132:135], v[64:67], v[196:199]
    v_cvt_pk_bf16_f32 v76, v56, v57
    v_mfma_f32_16x16x32_bf16 v[200:203], a[136:139], v[64:67], v[200:203]
    v_exp_f32 v58, v58
    v_mfma_f32_16x16x32_bf16 v[200:203], a[168:171], v[68:71], v[200:203]
    v_xor_b32 v5, s4, v5
    v_mfma_f32_16x16x32_bf16 v[204:207], a[172:175], v[68:71], v[204:207]
    v_exp_f32 v59, v59
    v_mfma_f32_16x16x32_bf16 v[204:207], a[140:143], v[64:67], v[204:207]
    v_cvt_pk_bf16_f32 v77, v58, v59
    v_mfma_f32_16x16x32_bf16 v[208:211], a[144:147], v[64:67], v[208:211]
    v_exp_f32 v60, v60
    v_mfma_f32_16x16x32_bf16 v[208:211], a[176:179], v[68:71], v[208:211]
    v_xor_b32 v6, s4, v6
    v_mfma_f32_16x16x32_bf16 v[212:215], a[180:183], v[68:71], v[212:215]
    v_exp_f32 v61, v61
    v_mfma_f32_16x16x32_bf16 v[212:215], a[148:151], v[64:67], v[212:215]
    v_cvt_pk_bf16_f32 v78, v60, v61
    v_mfma_f32_16x16x32_bf16 v[216:219], a[152:155], v[64:67], v[216:219]
    v_exp_f32 v62, v62
    v_mfma_f32_16x16x32_bf16 v[216:219], a[184:187], v[68:71], v[216:219]
    v_xor_b32 v7, s4, v7
    v_mfma_f32_16x16x32_bf16 v[220:223], a[188:191], v[68:71], v[220:223]
    v_exp_f32 v63, v63
    v_mfma_f32_16x16x32_bf16 v[220:223], a[156:159], v[64:67], v[220:223]
    s_waitcnt vmcnt(16)
    v_cvt_pk_bf16_f32 v79, v62, v63
    v_smfmac_f32_16x16x64_bf16 a[200:203], a[208:211], v[64:71], v111
    s_barrier
    v_mfma_f32_16x16x32_bf16 v[48:51], a[64:67], a[16:19], v[84:87]
    s_xor_b32 s6, s6, s5
    v_exp_f32 v32, v32
    v_mfma_f32_16x16x32_bf16 v[48:51], a[68:71], a[20:23], v[48:51]
    s_xor_b32 s7, s7, s4
    v_xor_b32 v8, s4, v8
    v_mfma_f32_16x16x32_bf16 v[48:51], a[72:75], a[24:27], v[48:51]
    s_mov_b32 m0, s6
    v_exp_f32 v33, v33
    v_mfma_f32_16x16x32_bf16 v[48:51], a[76:79], a[28:31], v[48:51]
    buffer_load_dwordx4 v16, s[16:19], s32 offen offset:0 nt lds
    v_cvt_pk_bf16_f32 v64, v32, v33
    v_mfma_f32_16x16x32_bf16 v[52:55], a[92:95], a[28:31], v[84:87]
    v_exp_f32 v34, v34
    v_mfma_f32_16x16x32_bf16 v[52:55], a[88:91], a[24:27], v[52:55]
    v_xor_b32 v9, s4, v9
    v_mfma_f32_16x16x32_bf16 v[52:55], a[84:87], a[20:23], v[52:55]
    v_exp_f32 v35, v35
    v_mfma_f32_16x16x32_bf16 v[52:55], a[80:83], a[16:19], v[52:55]
    buffer_load_dwordx4 v17, s[16:19], s32 offen offset:1024 nt lds
    v_cvt_pk_bf16_f32 v65, v34, v35
    v_mfma_f32_16x16x32_bf16 v[56:59], a[96:99], a[16:19], v[84:87]
    v_exp_f32 v36, v36
    v_mfma_f32_16x16x32_bf16 v[56:59], a[100:103], a[20:23], v[56:59]
    v_xor_b32 v10, s4, v10
    v_mfma_f32_16x16x32_bf16 v[56:59], a[104:107], a[24:27], v[56:59]
    v_exp_f32 v37, v37
    v_mfma_f32_16x16x32_bf16 v[56:59], a[108:111], a[28:31], v[56:59]
    buffer_load_dwordx4 v16, s[16:19], s32 offen offset:2048 nt lds
    v_cvt_pk_bf16_f32 v66, v36, v37
    v_mfma_f32_16x16x32_bf16 v[60:63], a[124:127], a[28:31], v[84:87]
    v_exp_f32 v38, v38
    v_mfma_f32_16x16x32_bf16 v[60:63], a[120:123], a[24:27], v[60:63]
    v_xor_b32 v11, s4, v11
    v_mfma_f32_16x16x32_bf16 v[60:63], a[116:119], a[20:23], v[60:63]
    v_exp_f32 v39, v39
    v_mfma_f32_16x16x32_bf16 v[60:63], a[112:115], a[16:19], v[60:63]
    buffer_load_dwordx4 v17, s[16:19], s32 offen offset:3072 nt lds
    v_cvt_pk_bf16_f32 v67, v38, v39
    v_mfma_f32_16x16x32_bf16 v[224:227], a[128:131], v[72:75], v[224:227]
    s_or_b32 s32, s32, 98304
    v_exp_f32 v40, v40
    v_mfma_f32_16x16x32_bf16 v[224:227], a[160:163], v[76:79], v[224:227]
    ds_read_b64_tr_b16 a[128:129], v4 offset:0
    v_mfma_f32_16x16x32_bf16 v[228:231], a[164:167], v[76:79], v[228:231]
    ds_read_b64_tr_b16 a[130:131], v4 offset:4096
    v_exp_f32 v41, v41
    v_mfma_f32_16x16x32_bf16 v[228:231], a[132:135], v[72:75], v[228:231]
    ds_read_b64_tr_b16 a[160:161], v4 offset:8192
    v_cvt_pk_bf16_f32 v68, v40, v41
    v_mfma_f32_16x16x32_bf16 v[232:235], a[136:139], v[72:75], v[232:235]
    ds_read_b64_tr_b16 a[162:163], v4 offset:12288
    v_exp_f32 v42, v42
    v_mfma_f32_16x16x32_bf16 v[232:235], a[168:171], v[76:79], v[232:235]
    ds_read_b64_tr_b16 a[132:133], v5 offset:0
    v_mfma_f32_16x16x32_bf16 v[236:239], a[172:175], v[76:79], v[236:239]
    ds_read_b64_tr_b16 a[134:135], v5 offset:4096
    v_exp_f32 v43, v43
    v_mfma_f32_16x16x32_bf16 v[236:239], a[140:143], v[72:75], v[236:239]
    ds_read_b64_tr_b16 a[164:165], v5 offset:8192
    v_cvt_pk_bf16_f32 v69, v42, v43
    v_mfma_f32_16x16x32_bf16 v[240:243], a[144:147], v[72:75], v[240:243]
    ds_read_b64_tr_b16 a[166:167], v5 offset:12288
    v_exp_f32 v44, v44
    v_mfma_f32_16x16x32_bf16 v[240:243], a[176:179], v[76:79], v[240:243]
    ds_read_b64_tr_b16 a[136:137], v6 offset:0
    v_mfma_f32_16x16x32_bf16 v[244:247], a[180:183], v[76:79], v[244:247]
    ds_read_b64_tr_b16 a[138:139], v6 offset:4096
    v_exp_f32 v45, v45
    v_mfma_f32_16x16x32_bf16 v[244:247], a[148:151], v[72:75], v[244:247]
    ds_read_b64_tr_b16 a[168:169], v6 offset:8192
    v_cvt_pk_bf16_f32 v70, v44, v45
    v_mfma_f32_16x16x32_bf16 v[248:251], a[152:155], v[72:75], v[248:251]
    ds_read_b64_tr_b16 a[170:171], v6 offset:12288
    v_exp_f32 v46, v46
    v_mfma_f32_16x16x32_bf16 v[248:251], a[184:187], v[76:79], v[248:251]
    ds_read_b64_tr_b16 a[140:141], v7 offset:0
    v_mfma_f32_16x16x32_bf16 v[252:255], a[188:191], v[76:79], v[252:255]
    ds_read_b64_tr_b16 a[142:143], v7 offset:4096
    v_exp_f32 v47, v47
    v_mfma_f32_16x16x32_bf16 v[252:255], a[156:159], v[72:75], v[252:255]
    ds_read_b64_tr_b16 a[172:173], v7 offset:8192
    v_cvt_pk_bf16_f32 v71, v46, v47
    v_smfmac_f32_16x16x64_bf16 a[204:207], a[208:211], v[72:79], v111
    ds_read_b64_tr_b16 a[174:175], v7 offset:12288
    v_mfma_f32_16x16x32_bf16 v[32:35], a[64:67], a[32:35], v[88:91]
    ds_read_b64_tr_b16 a[144:145], v8 offset:0
    v_exp_f32 v48, v48
    v_mfma_f32_16x16x32_bf16 v[32:35], a[68:71], a[36:39], v[32:35]
    ds_read_b64_tr_b16 a[146:147], v8 offset:4096
    v_mfma_f32_16x16x32_bf16 v[32:35], a[72:75], a[40:43], v[32:35]
    ds_read_b64_tr_b16 a[176:177], v8 offset:8192
    v_exp_f32 v49, v49
    v_mfma_f32_16x16x32_bf16 v[32:35], a[76:79], a[44:47], v[32:35]
    ds_read_b64_tr_b16 a[178:179], v8 offset:12288
    v_cvt_pk_bf16_f32 v72, v48, v49
    v_mfma_f32_16x16x32_bf16 v[36:39], a[92:95], a[44:47], v[88:91]
    ds_read_b64_tr_b16 a[148:149], v9 offset:0
    v_exp_f32 v50, v50
    v_mfma_f32_16x16x32_bf16 v[36:39], a[88:91], a[40:43], v[36:39]
    ds_read_b64_tr_b16 a[150:151], v9 offset:4096
    v_mfma_f32_16x16x32_bf16 v[36:39], a[84:87], a[36:39], v[36:39]
    ds_read_b64_tr_b16 a[180:181], v9 offset:8192
    v_exp_f32 v51, v51
    v_mfma_f32_16x16x32_bf16 v[36:39], a[80:83], a[32:35], v[36:39]
    ds_read_b64_tr_b16 a[182:183], v9 offset:12288
    v_cvt_pk_bf16_f32 v73, v50, v51
    v_mfma_f32_16x16x32_bf16 v[40:43], a[96:99], a[32:35], v[88:91]
    ds_read_b64_tr_b16 a[152:153], v10 offset:0
    v_exp_f32 v52, v52
    v_mfma_f32_16x16x32_bf16 v[40:43], a[100:103], a[36:39], v[40:43]
    ds_read_b64_tr_b16 a[154:155], v10 offset:4096
    v_mfma_f32_16x16x32_bf16 v[40:43], a[104:107], a[40:43], v[40:43]
    ds_read_b64_tr_b16 a[184:185], v10 offset:8192
    v_exp_f32 v53, v53
    v_mfma_f32_16x16x32_bf16 v[40:43], a[108:111], a[44:47], v[40:43]
    ds_read_b64_tr_b16 a[186:187], v10 offset:12288
    v_cvt_pk_bf16_f32 v74, v52, v53
    v_mfma_f32_16x16x32_bf16 v[44:47], a[124:127], a[44:47], v[88:91]
    ds_read_b64_tr_b16 a[156:157], v11 offset:0
    v_exp_f32 v54, v54
    v_mfma_f32_16x16x32_bf16 v[44:47], a[120:123], a[40:43], v[44:47]
    ds_read_b64_tr_b16 a[158:159], v11 offset:4096
    v_mfma_f32_16x16x32_bf16 v[44:47], a[116:119], a[36:39], v[44:47]
    ds_read_b64_tr_b16 a[188:189], v11 offset:8192
    v_exp_f32 v55, v55
    v_mfma_f32_16x16x32_bf16 v[44:47], a[112:115], a[32:35], v[44:47]
    ds_read_b64_tr_b16 a[190:191], v11 offset:12288
    s_waitcnt lgkmcnt(15)
    v_cvt_pk_bf16_f32 v75, v54, v55
    v_mfma_f32_16x16x32_bf16 v[128:131], a[128:131], v[64:67], v[128:131]
    s_add_u32 s32, s32, 4096
    v_exp_f32 v56, v56
    v_mfma_f32_16x16x32_bf16 v[128:131], a[160:163], v[68:71], v[128:131]
    s_andn2_b32 s32, s32, 98304
    v_mfma_f32_16x16x32_bf16 v[132:135], a[164:167], v[68:71], v[132:135]
    s_mov_b32 m0, s7
    v_exp_f32 v57, v57
    v_mfma_f32_16x16x32_bf16 v[132:135], a[132:135], v[64:67], v[132:135]
    s_waitcnt lgkmcnt(15)
    v_cvt_pk_bf16_f32 v76, v56, v57
    v_mfma_f32_16x16x32_bf16 v[136:139], a[136:139], v[64:67], v[136:139]
    buffer_load_dwordx4 v12, s[12:15], s32 offen offset:0 nt lds
    v_exp_f32 v58, v58
    v_mfma_f32_16x16x32_bf16 v[136:139], a[168:171], v[68:71], v[136:139]
    v_mfma_f32_16x16x32_bf16 v[140:143], a[172:175], v[68:71], v[140:143]
    v_exp_f32 v59, v59
    v_mfma_f32_16x16x32_bf16 v[140:143], a[140:143], v[64:67], v[140:143]
    s_waitcnt lgkmcnt(8)
    v_cvt_pk_bf16_f32 v77, v58, v59
    v_mfma_f32_16x16x32_bf16 v[144:147], a[144:147], v[64:67], v[144:147]
    buffer_load_dwordx4 v13, s[12:15], s32 offen offset:1024 nt lds
    v_exp_f32 v60, v60
    v_mfma_f32_16x16x32_bf16 v[144:147], a[176:179], v[68:71], v[144:147]
    v_mfma_f32_16x16x32_bf16 v[148:151], a[180:183], v[68:71], v[148:151]
    v_exp_f32 v61, v61
    v_mfma_f32_16x16x32_bf16 v[148:151], a[148:151], v[64:67], v[148:151]
    s_waitcnt lgkmcnt(0)
    v_cvt_pk_bf16_f32 v78, v60, v61
    v_mfma_f32_16x16x32_bf16 v[152:155], a[152:155], v[64:67], v[152:155]
    buffer_load_dwordx4 v14, s[12:15], s32 offen offset:2048 nt lds
    v_exp_f32 v62, v62
    v_mfma_f32_16x16x32_bf16 v[152:155], a[184:187], v[68:71], v[152:155]
    v_mfma_f32_16x16x32_bf16 v[156:159], a[188:191], v[68:71], v[156:159]
    v_exp_f32 v63, v63
    v_mfma_f32_16x16x32_bf16 v[156:159], a[156:159], v[64:67], v[156:159]
    v_cvt_pk_bf16_f32 v79, v62, v63
    v_smfmac_f32_16x16x64_bf16 a[192:195], a[208:211], v[64:71], v111
    buffer_load_dwordx4 v15, s[12:15], s32 offen offset:3072 nt lds
    v_mfma_f32_16x16x32_bf16 v[48:51], a[64:67], a[48:51], v[92:95]
    s_mov_b32 s4, s5
    v_exp_f32 v32, v32
    v_mfma_f32_16x16x32_bf16 v[48:51], a[68:71], a[52:55], v[48:51]
    ds_read_b128 a[64:67], v0 offset:0
    v_mfma_f32_16x16x32_bf16 v[48:51], a[72:75], a[56:59], v[48:51]
    s_xor_b32 s5, s5, 0xc000
    v_exp_f32 v33, v33
    v_mfma_f32_16x16x32_bf16 v[48:51], a[76:79], a[60:63], v[48:51]
    ds_read_b128 a[68:71], v1 offset:0
    v_cvt_pk_bf16_f32 v64, v32, v33
    v_mfma_f32_16x16x32_bf16 v[52:55], a[92:95], a[60:63], v[92:95]
    s_add_u32 s33, s33, 1
    v_exp_f32 v34, v34
    v_mfma_f32_16x16x32_bf16 v[52:55], a[88:91], a[56:59], v[52:55]
    ds_read_b128 a[72:75], v2 offset:0
    v_mfma_f32_16x16x32_bf16 v[52:55], a[84:87], a[52:55], v[52:55]
    v_exp_f32 v35, v35
    v_mfma_f32_16x16x32_bf16 v[52:55], a[80:83], a[48:51], v[52:55]
    ds_read_b128 a[76:79], v3 offset:0
    v_cvt_pk_bf16_f32 v65, v34, v35
    v_mfma_f32_16x16x32_bf16 v[56:59], a[96:99], a[48:51], v[92:95]
    v_exp_f32 v36, v36
    v_mfma_f32_16x16x32_bf16 v[56:59], a[100:103], a[52:55], v[56:59]
    ds_read_b128 a[92:95], v3 offset:4096
    v_mfma_f32_16x16x32_bf16 v[56:59], a[104:107], a[56:59], v[56:59]
    v_exp_f32 v37, v37
    v_mfma_f32_16x16x32_bf16 v[56:59], a[108:111], a[60:63], v[56:59]
    ds_read_b128 a[88:91], v2 offset:4096
    v_cvt_pk_bf16_f32 v66, v36, v37
    v_mfma_f32_16x16x32_bf16 v[60:63], a[124:127], a[60:63], v[92:95]
    v_exp_f32 v38, v38
    v_mfma_f32_16x16x32_bf16 v[60:63], a[120:123], a[56:59], v[60:63]
    ds_read_b128 a[84:87], v1 offset:4096
    v_mfma_f32_16x16x32_bf16 v[60:63], a[116:119], a[52:55], v[60:63]
    v_exp_f32 v39, v39
    v_mfma_f32_16x16x32_bf16 v[60:63], a[112:115], a[48:51], v[60:63]
    ds_read_b128 a[80:83], v0 offset:4096
    v_cvt_pk_bf16_f32 v67, v38, v39
    v_mfma_f32_16x16x32_bf16 v[160:163], a[128:131], v[72:75], v[160:163]
    v_exp_f32 v40, v40
    v_mfma_f32_16x16x32_bf16 v[160:163], a[160:163], v[76:79], v[160:163]
    ds_read_b128 a[96:99], v0 offset:8192
    v_mfma_f32_16x16x32_bf16 v[164:167], a[164:167], v[76:79], v[164:167]
    v_exp_f32 v41, v41
    v_mfma_f32_16x16x32_bf16 v[164:167], a[132:135], v[72:75], v[164:167]
    ds_read_b128 a[100:103], v1 offset:8192
    v_cvt_pk_bf16_f32 v68, v40, v41
    v_mfma_f32_16x16x32_bf16 v[168:171], a[136:139], v[72:75], v[168:171]
    v_exp_f32 v42, v42
    v_mfma_f32_16x16x32_bf16 v[168:171], a[168:171], v[76:79], v[168:171]
    ds_read_b128 a[104:107], v2 offset:8192
    v_mfma_f32_16x16x32_bf16 v[172:175], a[172:175], v[76:79], v[172:175]
    v_exp_f32 v43, v43
    v_mfma_f32_16x16x32_bf16 v[172:175], a[140:143], v[72:75], v[172:175]
    ds_read_b128 a[108:111], v3 offset:8192
    v_cvt_pk_bf16_f32 v69, v42, v43
    v_mfma_f32_16x16x32_bf16 v[176:179], a[144:147], v[72:75], v[176:179]
    v_exp_f32 v44, v44
    v_mfma_f32_16x16x32_bf16 v[176:179], a[176:179], v[76:79], v[176:179]
    ds_read_b128 a[124:127], v3 offset:12288
    v_mfma_f32_16x16x32_bf16 v[180:183], a[180:183], v[76:79], v[180:183]
    v_exp_f32 v45, v45
    v_mfma_f32_16x16x32_bf16 v[180:183], a[148:151], v[72:75], v[180:183]
    ds_read_b128 a[120:123], v2 offset:12288
    v_cvt_pk_bf16_f32 v70, v44, v45
    v_mfma_f32_16x16x32_bf16 v[184:187], a[152:155], v[72:75], v[184:187]
    v_exp_f32 v46, v46
    v_mfma_f32_16x16x32_bf16 v[184:187], a[184:187], v[76:79], v[184:187]
    ds_read_b128 a[116:119], v1 offset:12288
    v_mfma_f32_16x16x32_bf16 v[188:191], a[188:191], v[76:79], v[188:191]
    s_cmp_lt_u32 s33, 32
    v_exp_f32 v47, v47
    v_mfma_f32_16x16x32_bf16 v[188:191], a[156:159], v[72:75], v[188:191]
    ds_read_b128 a[112:115], v0 offset:12288
    v_cvt_pk_bf16_f32 v71, v46, v47
    v_smfmac_f32_16x16x64_bf16 a[196:199], a[208:211], v[72:79], v111
    s_waitcnt lgkmcnt(12)
    s_cbranch_scc1 S_L4O
    s_branch S_E4
Z_L4O:
.p2align 6
T_W3:
    s_branch L_backE
    s_nop 0
S_W3:
    v_mfma_f32_16x16x32_bf16 v[32:35], a[64:67], a[0:3], v[80:83]
    v_exp_f32 v224, v224
    v_exp_f32 v225, v225
    v_exp_f32 v226, v226
    v_exp_f32 v227, v227
    v_exp_f32 v228, v228
    v_exp_f32 v229, v229
    v_exp_f32 v230, v230
    v_exp_f32 v231, v231
    v_exp_f32 v232, v232
    v_exp_f32 v233, v233
    v_exp_f32 v234, v234
    v_exp_f32 v235, v235
    v_exp_f32 v236, v236
    v_exp_f32 v237, v237
    v_exp_f32 v238, v238
    v_exp_f32 v239, v239
    v_mfma_f32_16x16x32_bf16 v[32:35], a[68:71], a[4:7], v[32:35]
    v_xor_b32 v0, s5, v0
    v_mfma_f32_16x16x32_bf16 v[32:35], a[72:75], a[8:11], v[32:35]
    v_mfma_f32_16x16x32_bf16 v[32:35], a[76:79], a[12:15], v[32:35]
    s_waitcnt lgkmcnt(8)
    v_cvt_pk_bf16_f32 v240, v224, v225
    v_mfma_f32_16x16x32_bf16 v[36:39], a[92:95], a[12:15], v[80:83]
    v_mfma_f32_16x16x32_bf16 v[36:39], a[88:91], a[8:11], v[36:39]
    v_xor_b32 v1, s5, v1
    v_mfma_f32_16x16x32_bf16 v[36:39], a[84:87], a[4:7], v[36:39]
    v_mfma_f32_16x16x32_bf16 v[36:39], a[80:83], a[0:3], v[36:39]
    s_waitcnt lgkmcnt(4)
    v_cvt_pk_bf16_f32 v241, v226, v227
    v_mfma_f32_16x16x32_bf16 v[40:43], a[96:99], a[0:3], v[80:83]
    v_mfma_f32_16x16x32_bf16 v[40:43], a[100:103], a[4:7], v[40:43]
    v_xor_b32 v2, s5, v2
    v_mfma_f32_16x16x32_bf16 v[40:43], a[104:107], a[8:11], v[40:43]
    v_mfma_f32_16x16x32_bf16 v[40:43], a[108:111], a[12:15], v[40:43]
    s_waitcnt lgkmcnt(0)
    v_cvt_pk_bf16_f32 v242, v228, v229
    v_mfma_f32_16x16x32_bf16 v[44:47], a[124:127], a[12:15], v[80:83]
    v_mfma_f32_16x16x32_bf16 v[44:47], a[120:123], a[8:11], v[44:47]
    v_xor_b32 v3, s5, v3
    v_mfma_f32_16x16x32_bf16 v[44:47], a[116:119], a[4:7], v[44:47]
    v_mfma_f32_16x16x32_bf16 v[44:47], a[112:115], a[0:3], v[44:47]
    v_cvt_pk_bf16_f32 v243, v230, v231
    v_mfma_f32_16x16x32_bf16 v[160:163], a[128:131], v[72:75], v[160:163]
    v_mfma_f32_16x16x32_bf16 v[160:163], a[160:163], v[76:79], v[160:163]
    v_xor_b32 v4, s4, v4
    v_mfma_f32_16x16x32_bf16 v[164:167], a[164:167], v[76:79], v[164:167]
    v_mfma_f32_16x16x32_bf16 v[164:167], a[132:135], v[72:75], v[164:167]
    v_cvt_pk_bf16_f32 v244, v232, v233
    v_mfma_f32_16x16x32_bf16 v[168:171], a[136:139], v[72:75], v[168:171]
    v_mfma_f32_16x16x32_bf16 v[168:171], a[168:171], v[76:79], v[168:171]
    v_xor_b32 v5, s4, v5
    v_mfma_f32_16x16x32_bf16 v[172:175], a[172:175], v[76:79], v[172:175]
    v_mfma_f32_16x16x32_bf16 v[172:175], a[140:143], v[72:75], v[172:175]
    v_cvt_pk_bf16_f32 v245, v234, v235
    v_mfma_f32_16x16x32_bf16 v[176:179], a[144:147], v[72:75], v[176:179]
    v_mfma_f32_16x16x32_bf16 v[176:179], a[176:179], v[76:79], v[176:179]
    v_xor_b32 v6, s4, v6
    v_mfma_f32_16x16x32_bf16 v[180:183], a[180:183], v[76:79], v[180:183]
    v_mfma_f32_16x16x32_bf16 v[180:183], a[148:151], v[72:75], v[180:183]
    v_cvt_pk_bf16_f32 v246, v236, v237
    v_mfma_f32_16x16x32_bf16 v[184:187], a[152:155], v[72:75], v[184:187]
    v_mfma_f32_16x16x32_bf16 v[184:187], a[184:187], v[76:79], v[184:187]
    v_xor_b32 v7, s4, v7
    v_mfma_f32_16x16x32_bf16 v[188:191], a[188:191], v[76:79], v[188:191]
    v_mfma_f32_16x16x32_bf16 v[188:191], a[156:159], v[72:75], v[188:191]
    s_waitcnt vmcnt(20)
    v_cvt_pk_bf16_f32 v247, v238, v239
    v_smfmac_f32_16x16x64_bf16 a[196:199], a[208:211], v[72:79], v111
    s_barrier
    v_mfma_f32_16x16x32_bf16 v[48:51], a[64:67], a[16:19], v[84:87]
    s_xor_b32 s6, s6, s5
    v_exp_f32 v32, v32
    v_exp_f32 v33, v33
    v_exp_f32 v34, v34
    v_exp_f32 v35, v35
    v_exp_f32 v36, v36
    v_exp_f32 v37, v37
    v_exp_f32 v38, v38
    v_exp_f32 v39, v39
    v_exp_f32 v40, v40
    v_exp_f32 v41, v41
    v_exp_f32 v42, v42
    v_exp_f32 v43, v43
    v_exp_f32 v44, v44
    v_exp_f32 v45, v45
    v_exp_f32 v46, v46
    v_exp_f32 v47, v47
    v_mfma_f32_16x16x32_bf16 v[48:51], a[68:71], a[20:23], v[48:51]
    s_xor_b32 s7, s7, s4
    v_xor_b32 v8, s4, v8
    v_mfma_f32_16x16x32_bf16 v[48:51], a[72:75], a[24:27], v[48:51]
    s_mov_b32 m0, s6
    v_mfma_f32_16x16x32_bf16 v[48:51], a[76:79], a[28:31], v[48:51]
    buffer_load_dwordx4 v16, s[16:19], s32 offen offset:0 nt lds
    v_cvt_pk_bf16_f32 v64, v32, v33
    v_mfma_f32_16x16x32_bf16 v[52:55], a[92:95], a[28:31], v[84:87]
    v_mfma_f32_16x16x32_bf16 v[52:55], a[88:91], a[24:27], v[52:55]
    v_xor_b32 v9, s4, v9
    v_mfma_f32_16x16x32_bf16 v[52:55], a[84:87], a[20:23], v[52:55]
    v_mfma_f32_16x16x32_bf16 v[52:55], a[80:83], a[16:19], v[52:55]
    buffer_load_dwordx4 v17, s[16:19], s32 offen offset:1024 nt lds
    v_cvt_pk_bf16_f32 v65, v34, v35
    v_mfma_f32_16x16x32_bf16 v[56:59], a[96:99], a[16:19], v[84:87]
    v_mfma_f32_16x16x32_bf16 v[56:59], a[100:103], a[20:23], v[56:59]
    v_xor_b32 v10, s4, v10
    v_mfma_f32_16x16x32_bf16 v[56:59], a[104:107], a[24:27], v[56:59]
    v_mfma_f32_16x16x32_bf16 v[56:59], a[108:111], a[28:31], v[56:59]
    buffer_load_dwordx4 v16, s[16:19], s32 offen offset:2048 nt lds
    v_cvt_pk_bf16_f32 v66, v36, v37
    v_mfma_f32_16x16x32_bf16 v[60:63], a[124:127], a[28:31], v[84:87]
    v_mfma_f32_16x16x32_bf16 v[60:63], a[120:123], a[24:27], v[60:63]
    v_xor_b32 v11, s4, v11
    v_mfma_f32_16x16x32_bf16 v[60:63], a[116:119], a[20:23], v[60:63]
    v_mfma_f32_16x16x32_bf16 v[60:63], a[112:115], a[16:19], v[60:63]
    buffer_load_dwordx4 v17, s[16:19], s32 offen offset:3072 nt lds
    v_cvt_pk_bf16_f32 v67, v38, v39
    v_mfma_f32_16x16x32_bf16 v[192:195], a[128:131], v[240:243], v[192:195]
    s_or_b32 s32, s32, 98304
    v_mfma_f32_16x16x32_bf16 v[192:195], a[160:163], v[244:247], v[192:195]
    ds_read_b64_tr_b16 a[128:129], v4 offset:0
    v_mfma_f32_16x16x32_bf16 v[196:199], a[164:167], v[244:247], v[196:199]
    ds_read_b64_tr_b16 a[130:131], v4 offset:4096
    v_mfma_f32_16x16x32_bf16 v[196:199], a[132:135], v[240:243], v[196:199]
    ds_read_b64_tr_b16 a[160:161], v4 offset:8192
    v_cvt_pk_bf16_f32 v68, v40, v41
    v_mfma_f32_16x16x32_bf16 v[200:203], a[136:139], v[240:243], v[200:203]
    ds_read_b64_tr_b16 a[162:163], v4 offset:12288
    v_mfma_f32_16x16x32_bf16 v[200:203], a[168:171], v[244:247], v[200:203]
    ds_read_b64_tr_b16 a[132:133], v5 offset:0
    v_mfma_f32_16x16x32_bf16 v[204:207], a[172:175], v[244:247], v[204:207]
    ds_read_b64_tr_b16 a[134:135], v5 offset:4096
    v_mfma_f32_16x16x32_bf16 v[204:207], a[140:143], v[240:243], v[204:207]
    ds_read_b64_tr_b16 a[164:165], v5 offset:8192
    v_cvt_pk_bf16_f32 v69, v42, v43
    v_mfma_f32_16x16x32_bf16 v[208:211], a[144:147], v[240:243], v[208:211]
    ds_read_b64_tr_b16 a[166:167], v5 offset:12288
    v_mfma_f32_16x16x32_bf16 v[208:211], a[176:179], v[244:247], v[208:211]
    ds_read_b64_tr_b16 a[136:137], v6 offset:0
    v_mfma_f32_16x16x32_bf16 v[212:215], a[180:183], v[244:247], v[212:215]
    ds_read_b64_tr_b16 a[138:139], v6 offset:4096
    v_mfma_f32_16x16x32_bf16 v[212:215], a[148:151], v[240:243], v[212:215]
    ds_read_b64_tr_b16 a[168:169], v6 offset:8192
    v_cvt_pk_bf16_f32 v70, v44, v45
    v_mfma_f32_16x16x32_bf16 v[216:219], a[152:155], v[240:243], v[216:219]
    ds_read_b64_tr_b16 a[170:171], v6 offset:12288
    v_mfma_f32_16x16x32_bf16 v[216:219], a[184:187], v[244:247], v[216:219]
    ds_read_b64_tr_b16 a[140:141], v7 offset:0
    v_mfma_f32_16x16x32_bf16 v[220:223], a[188:191], v[244:247], v[220:223]
    ds_read_b64_tr_b16 a[142:143], v7 offset:4096
    v_mfma_f32_16x16x32_bf16 v[220:223], a[156:159], v[240:243], v[220:223]
    ds_read_b64_tr_b16 a[172:173], v7 offset:8192
    v_cvt_pk_bf16_f32 v71, v46, v47
    v_smfmac_f32_16x16x64_bf16 a[200:203], a[208:211], v[240:247], v111
    ds_read_b64_tr_b16 a[174:175], v7 offset:12288
    v_mfma_f32_16x16x32_bf16 v[224:227], a[64:67], a[32:35], v[88:91]
    ds_read_b64_tr_b16 a[144:145], v8 offset:0
    v_exp_f32 v48, v48
    v_exp_f32 v49, v49
    v_exp_f32 v50, v50
    v_exp_f32 v51, v51
    v_exp_f32 v52, v52
    v_exp_f32 v53, v53
    v_exp_f32 v54, v54
    v_exp_f32 v55, v55
    v_exp_f32 v56, v56
    v_exp_f32 v57, v57
    v_exp_f32 v58, v58
    v_exp_f32 v59, v59
    v_exp_f32 v60, v60
    v_exp_f32 v61, v61
    v_exp_f32 v62, v62
    v_exp_f32 v63, v63
    v_mfma_f32_16x16x32_bf16 v[224:227], a[68:71], a[36:39], v[224:227]
    ds_read_b64_tr_b16 a[146:147], v8 offset:4096
    v_mfma_f32_16x16x32_bf16 v[224:227], a[72:75], a[40:43], v[224:227]
    ds_read_b64_tr_b16 a[176:177], v8 offset:8192
    v_mfma_f32_16x16x32_bf16 v[224:227], a[76:79], a[44:47], v[224:227]
    ds_read_b64_tr_b16 a[178:179], v8 offset:12288
    v_cvt_pk_bf16_f32 v72, v48, v49
    v_mfma_f32_16x16x32_bf16 v[228:231], a[92:95], a[44:47], v[88:91]
    ds_read_b64_tr_b16 a[148:149], v9 offset:0
    v_mfma_f32_16x16x32_bf16 v[228:231], a[88:91], a[40:43], v[228:231]
    ds_read_b64_tr_b16 a[150:151], v9 offset:4096
    v_mfma_f32_16x16x32_bf16 v[228:231], a[84:87], a[36:39], v[228:231]
    ds_read_b64_tr_b16 a[180:181], v9 offset:8192
    s_mov_b32 s4, s5
    v_mfma_f32_16x16x32_bf16 v[228:231], a[80:83], a[32:35], v[228:231]
    ds_read_b64_tr_b16 a[182:183], v9 offset:12288
    v_cvt_pk_bf16_f32 v73, v50, v51
    v_mfma_f32_16x16x32_bf16 v[232:235], a[96:99], a[32:35], v[88:91]
    ds_read_b64_tr_b16 a[152:153], v10 offset:0
    s_xor_b32 s5, s5, 0xc000
    v_mfma_f32_16x16x32_bf16 v[232:235], a[100:103], a[36:39], v[232:235]
    ds_read_b64_tr_b16 a[154:155], v10 offset:4096
    v_mfma_f32_16x16x32_bf16 v[232:235], a[104:107], a[40:43], v[232:235]
    ds_read_b64_tr_b16 a[184:185], v10 offset:8192
    s_add_u32 s33, s33, 1
    v_mfma_f32_16x16x32_bf16 v[232:235], a[108:111], a[44:47], v[232:235]
    ds_read_b64_tr_b16 a[186:187], v10 offset:12288
    v_cvt_pk_bf16_f32 v74, v52, v53
    v_mfma_f32_16x16x32_bf16 v[236:239], a[124:127], a[44:47], v[88:91]
    ds_read_b64_tr_b16 a[156:157], v11 offset:0
    v_mfma_f32_16x16x32_bf16 v[236:239], a[120:123], a[40:43], v[236:239]
    ds_read_b64_tr_b16 a[158:159], v11 offset:4096
    v_mfma_f32_16x16x32_bf16 v[236:239], a[116:119], a[36:39], v[236:239]
    ds_read_b64_tr_b16 a[188:189], v11 offset:8192
    v_mfma_f32_16x16x32_bf16 v[236:239], a[112:115], a[32:35], v[236:239]
    ds_read_b64_tr_b16 a[190:191], v11 offset:12288
    s_waitcnt lgkmcnt(15)
    s_waitcnt vmcnt(20)
    s_barrier
    v_cvt_pk_bf16_f32 v75, v54, v55
    v_mfma_f32_16x16x32_bf16 v[128:131], a[128:131], v[64:67], v[128:131]
    ds_read_b128 a[64:67], v0 offset:0
    s_add_u32 s32, s32, 4096
    v_mfma_f32_16x16x32_bf16 v[128:131], a[160:163], v[68:71], v[128:131]
    ds_read_b128 a[68:71], v1 offset:0
    s_andn2_b32 s32, s32, 98304
    v_mfma_f32_16x16x32_bf16 v[132:135], a[164:167], v[68:71], v[132:135]
    ds_read_b128 a[72:75], v2 offset:0
    s_mov_b32 m0, s7
    v_mfma_f32_16x16x32_bf16 v[132:135], a[132:135], v[64:67], v[132:135]
    s_waitcnt lgkmcnt(15)
    ds_read_b128 a[76:79], v3 offset:0
    v_cvt_pk_bf16_f32 v76, v56, v57
    v_mfma_f32_16x16x32_bf16 v[136:139], a[136:139], v[64:67], v[136:139]
    ds_read_b128 a[92:95], v3 offset:4096
    buffer_load_dwordx4 v12, s[12:15], s32 offen offset:0 nt lds
    v_mfma_f32_16x16x32_bf16 v[136:139], a[168:171], v[68:71], v[136:139]
    ds_read_b128 a[88:91], v2 offset:4096
    v_mfma_f32_16x16x32_bf16 v[140:143], a[172:175], v[68:71], v[140:143]
    ds_read_b128 a[84:87], v1 offset:4096
    v_mfma_f32_16x16x32_bf16 v[140:143], a[140:143], v[64:67], v[140:143]
    s_waitcnt lgkmcnt(15)
    ds_read_b128 a[80:83], v0 offset:4096
    v_cvt_pk_bf16_f32 v77, v58, v59
    v_mfma_f32_16x16x32_bf16 v[144:147], a[144:147], v[64:67], v[144:147]
    ds_read_b128 a[96:99], v0 offset:8192
    buffer_load_dwordx4 v13, s[12:15], s32 offen offset:1024 nt lds
    v_mfma_f32_16x16x32_bf16 v[144:147], a[176:179], v[68:71], v[144:147]
    ds_read_b128 a[100:103], v1 offset:8192
    v_mfma_f32_16x16x32_bf16 v[148:151], a[180:183], v[68:71], v[148:151]
    ds_read_b128 a[104:107], v2 offset:8192
    v_mfma_f32_16x16x32_bf16 v[148:151], a[148:151], v[64:67], v[148:151]
    s_waitcnt lgkmcnt(11)
    ds_read_b128 a[108:111], v3 offset:8192
    v_cvt_pk_bf16_f32 v78, v60, v61
    v_mfma_f32_16x16x32_bf16 v[152:155], a[152:155], v[64:67], v[152:155]
    ds_read_b128 a[124:127], v3 offset:12288
    buffer_load_dwordx4 v14, s[12:15], s32 offen offset:2048 nt lds
    v_mfma_f32_16x16x32_bf16 v[152:155], a[184:187], v[68:71], v[152:155]
    ds_read_b128 a[120:123], v2 offset:12288
    v_mfma_f32_16x16x32_bf16 v[156:159], a[188:191], v[68:71], v[156:159]
    ds_read_b128 a[116:119], v1 offset:12288
    v_mfma_f32_16x16x32_bf16 v[156:159], a[156:159], v[64:67], v[156:159]
    ds_read_b128 a[112:115], v0 offset:12288
    s_cmp_lt_u32 s33, 4
    v_cvt_pk_bf16_f32 v79, v62, v63
    v_smfmac_f32_16x16x64_bf16 a[192:195], a[208:211], v[64:71], v111
    s_waitcnt lgkmcnt(12)
    buffer_load_dwordx4 v15, s[12:15], s32 offen offset:3072 nt lds
    s_cbranch_scc1 S_W3
    s_branch S_L3
Z_W3:
.p2align 12
T_L4E:
    s_branch L_backE
    s_nop 0
S_L4E:
    v_mfma_f32_16x16x32_bf16 v[32:35], a[64:67], a[0:3], v[80:83]
    v_exp_f32 v48, v48
    v_exp_f32 v49, v49
    v_mfma_f32_16x16x32_bf16 v[32:35], a[68:71], a[4:7], v[32:35]
    v_xor_b32 v0, s5, v0
    v_mfma_f32_16x16x32_bf16 v[32:35], a[72:75], a[8:11], v[32:35]
    v_mfma_f32_16x16x32_bf16 v[32:35], a[76:79], a[12:15], v[32:35]
    s_waitcnt lgkmcnt(8)
    v_cvt_pk_bf16_f32 v72, v48, v49
    v_mfma_f32_16x16x32_bf16 v[36:39], a[92:95], a[12:15], v[80:83]
    v_exp_f32 v50, v50
    v_exp_f32 v51, v51
    v_mfma_f32_16x16x32_bf16 v[36:39], a[88:91], a[8:11], v[36:39]
    v_xor_b32 v1, s5, v1
    v_mfma_f32_16x16x32_bf16 v[36:39], a[84:87], a[4:7], v[36:39]
    v_mfma_f32_16x16x32_bf16 v[36:39], a[80:83], a[0:3], v[36:39]
    s_waitcnt lgkmcnt(4)
    v_cvt_pk_bf16_f32 v73, v50, v51
    v_mfma_f32_16x16x32_bf16 v[40:43], a[96:99], a[0:3], v[80:83]
    v_exp_f32 v52, v52
    v_exp_f32 v53, v53
    v_mfma_f32_16x16x32_bf16 v[40:43], a[100:103], a[4:7], v[40:43]
    v_xor_b32 v2, s5, v2
    v_mfma_f32_16x16x32_bf16 v[40:43], a[104:107], a[8:11], v[40:43]
    v_mfma_f32_16x16x32_bf16 v[40:43], a[108:111], a[12:15], v[40:43]
    s_waitcnt lgkmcnt(0)
    v_cvt_pk_bf16_f32 v74, v52, v53
    v_mfma_f32_16x16x32_bf16 v[44:47], a[124:127], a[12:15], v[80:83]
    v_exp_f32 v54, v54
    v_exp_f32 v55, v55
    v_mfma_f32_16x16x32_bf16 v[44:47], a[120:123], a[8:11], v[44:47]
    v_xor_b32 v3, s5, v3
    v_mfma_f32_16x16x32_bf16 v[44:47], a[116:119], a[4:7], v[44:47]
    v_mfma_f32_16x16x32_bf16 v[44:47], a[112:115], a[0:3], v[44:47]
    v_cvt_pk_bf16_f32 v75, v54, v55
    v_mfma_f32_16x16x32_bf16 v[192:195], a[128:131], v[64:67], v[192:195]
    v_exp_f32 v56, v56
    v_exp_f32 v57, v57
    v_mfma_f32_16x16x32_bf16 v[192:195], a[160:163], v[68:71], v[192:195]
    v_xor_b32 v4, s4, v4
    v_mfma_f32_16x16x32_bf16 v[196:199], a[164:167], v[68:71], v[196:199]
    v_mfma_f32_16x16x32_bf16 v[196:199], a[132:135], v[64:67], v[196:199]
    v_cvt_pk_bf16_f32 v76, v56, v57
    v_mfma_f32_16x16x32_bf16 v[200:203], a[136:139], v[64:67], v[200:203]
    v_exp_f32 v58, v58
    v_exp_f32 v59, v59
    v_mfma_f32_16x16x32_bf16 v[200:203], a[168:171], v[68:71], v[200:203]
    v_xor_b32 v5, s4, v5
    v_mfma_f32_16x16x32_bf16 v[204:207], a[172:175], v[68:71], v[204:207]
    v_mfma_f32_16x16x32_bf16 v[204:207], a[140:143], v[64:67], v[204:207]
    v_cvt_pk_bf16_f32 v77, v58, v59
    v_mfma_f32_16x16x32_bf16 v[208:211], a[144:147], v[64:67], v[208:211]
    v_exp_f32 v60, v60
    v_exp_f32 v61, v61
    v_mfma_f32_16x16x32_bf16 v[208:211], a[176:179], v[68:71], v[208:211]
    v_xor_b32 v6, s4, v6
    v_mfma_f32_16x16x32_bf16 v[212:215], a[180:183], v[68:71], v[212:215]
    v_mfma_f32_16x16x32_bf16 v[212:215], a[148:151], v[64:67], v[212:215]
    v_cvt_pk_bf16_f32 v78, v60, v61
    v_mfma_f32_16x16x32_bf16 v[216:219], a[152:155], v[64:67], v[216:219]
    v_exp_f32 v62, v62
    v_exp_f32 v63, v63
    v_mfma_f32_16x16x32_bf16 v[216:219], a[184:187], v[68:71], v[216:219]
    v_xor_b32 v7, s4, v7
    v_mfma_f32_16x16x32_bf16 v[220:223], a[188:191], v[68:71], v[220:223]
    v_mfma_f32_16x16x32_bf16 v[220:223], a[156:159], v[64:67], v[220:223]
    s_waitcnt vmcnt(16)
    v_cvt_pk_bf16_f32 v79, v62, v63
    v_smfmac_f32_16x16x64_bf16 a[200:203], a[208:211], v[64:71], v111
    s_barrier
    v_mfma_f32_16x16x32_bf16 v[48:51], a[64:67], a[16:19], v[84:87]
    s_xor_b32 s6, s6, s5
    v_exp_f32 v32, v32
    v_mfma_f32_16x16x32_bf16 v[48:51], a[68:71], a[20:23], v[48:51]
    s_xor_b32 s7, s7, s4
    v_xor_b32 v8, s4, v8
    v_mfma_f32_16x16x32_bf16 v[48:51], a[72:75], a[24:27], v[48:51]
    s_mov_b32 m0, s6
    v_exp_f32 v33, v33
    v_mfma_f32_16x16x32_bf16 v[48:51], a[76:79], a[28:31], v[48:51]
    buffer_load_dwordx4 v16, s[16:19], s32 offen offset:0 nt lds
    v_cvt_pk_bf16_f32 v64, v32, v33
    v_mfma_f32_16x16x32_bf16 v[52:55], a[92:95], a[28:31], v[84:87]
    v_exp_f32 v34, v34
    v_mfma_f32_16x16x32_bf16 v[52:55], a[88:91], a[24:27], v[52:55]
    v_xor_b32 v9, s4, v9
    v_mfma_f32_16x16x32_bf16 v[52:55], a[84:87], a[20:23], v[52:55]
    v_exp_f32 v35, v35
    v_mfma_f32_16x16x32_bf16 v[52:55], a[80:83], a[16:19], v[52:55]
    buffer_load_dwordx4 v17, s[16:19], s32 offen offset:1024 nt lds
    v_cvt_pk_bf16_f32 v65, v34, v35
    v_mfma_f32_16x16x32_bf16 v[56:59], a[96:99], a[16:19], v[84:87]
    v_exp_f32 v36, v36
    v_mfma_f32_16x16x32_bf16 v[56:59], a[100:103], a[20:23], v[56:59]
    v_xor_b32 v10, s4, v10
    v_mfma_f32_16x16x32_bf16 v[56:59], a[104:107], a[24:27], v[56:59]
    v_exp_f32 v37, v37
    v_mfma_f32_16x16x32_bf16 v[56:59], a[108:111], a[28:31], v[56:59]
    buffer_load_dwordx4 v16, s[16:19], s32 offen offset:2048 nt lds
    v_cvt_pk_bf16_f32 v66, v36, v37
    v_mfma_f32_16x16x32_bf16 v[60:63], a[124:127], a[28:31], v[84:87]
    v_exp_f32 v38, v38
    v_mfma_f32_16x16x32_bf16 v[60:63], a[120:123], a[24:27], v[60:63]
    v_xor_b32 v11, s4, v11
    v_mfma_f32_16x16x32_bf16 v[60:63], a[116:119], a[20:23], v[60:63]
    v_exp_f32 v39, v39
    v_mfma_f32_16x16x32_bf16 v[60:63], a[112:115], a[16:19], v[60:63]
    buffer_load_dwordx4 v17, s[16:19], s32 offen offset:3072 nt lds
    v_cvt_pk_bf16_f32 v67, v38, v39
    v_mfma_f32_16x16x32_bf16 v[224:227], a[128:131], v[72:75], v[224:227]
    s_or_b32 s32, s32, 98304
    v_exp_f32 v40, v40
    v_mfma_f32_16x16x32_bf16 v[224:227], a[160:163], v[76:79], v[224:227]
    ds_read_b64_tr_b16 a[128:129], v4 offset:0
    v_mfma_f32_16x16x32_bf16 v[228:231], a[164:167], v[76:79], v[228:231]
    ds_read_b64_tr_b16 a[130:131], v4 offset:4096
    v_exp_f32 v41, v41
    v_mfma_f32_16x16x32_bf16 v[228:231], a[132:135], v[72:75], v[228:231]
    ds_read_b64_tr_b16 a[160:161], v4 offset:8192
    v_cvt_pk_bf16_f32 v68, v40, v41
    v_mfma_f32_16x16x32_bf16 v[232:235], a[136:139], v[72:75], v[232:235]
    ds_read_b64_tr_b16 a[162:163], v4 offset:12288
    v_exp_f32 v42, v42
    v_mfma_f32_16x16x32_bf16 v[232:235], a[168:171], v[76:79], v[232:235]
    ds_read_b64_tr_b16 a[132:133], v5 offset:0
    v_mfma_f32_16x16x32_bf16 v[236:239], a[172:175], v[76:79], v[236:239]
    ds_read_b64_tr_b16 a[134:135], v5 offset:4096
    v_exp_f32 v43, v43
    v_mfma_f32_16x16x32_bf16 v[236:239], a[140:143], v[72:75], v[236:239]
    ds_read_b64_tr_b16 a[164:165], v5 offset:8192
    v_cvt_pk_bf16_f32 v69, v42, v43
    v_mfma_f32_16x16x32_bf16 v[240:243], a[144:147], v[72:75], v[240:243]
    ds_read_b64_tr_b16 a[166:167], v5 offset:12288
    v_exp_f32 v44, v44
    v_mfma_f32_16x16x32_bf16 v[240:243], a[176:179], v[76:79], v[240:243]
    ds_read_b64_tr_b16 a[136:137], v6 offset:0
    v_mfma_f32_16x16x32_bf16 v[244:247], a[180:183], v[76:79], v[244:247]
    ds_read_b64_tr_b16 a[138:139], v6 offset:4096
    v_exp_f32 v45, v45
    v_mfma_f32_16x16x32_bf16 v[244:247], a[148:151], v[72:75], v[244:247]
    ds_read_b64_tr_b16 a[168:169], v6 offset:8192
    v_cvt_pk_bf16_f32 v70, v44, v45
    v_mfma_f32_16x16x32_bf16 v[248:251], a[152:155], v[72:75], v[248:251]
    ds_read_b64_tr_b16 a[170:171], v6 offset:12288
    v_exp_f32 v46, v46
    v_mfma_f32_16x16x32_bf16 v[248:251], a[184:187], v[76:79], v[248:251]
    ds_read_b64_tr_b16 a[140:141], v7 offset:0
    v_mfma_f32_16x16x32_bf16 v[252:255], a[188:191], v[76:79], v[252:255]
    ds_read_b64_tr_b16 a[142:143], v7 offset:4096
    v_exp_f32 v47, v47
    v_mfma_f32_16x16x32_bf16 v[252:255], a[156:159], v[72:75], v[252:255]
    ds_read_b64_tr_b16 a[172:173], v7 offset:8192
    v_cvt_pk_bf16_f32 v71, v46, v47
    v_smfmac_f32_16x16x64_bf16 a[204:207], a[208:211], v[72:79], v111
    ds_read_b64_tr_b16 a[174:175], v7 offset:12288
    v_mfma_f32_16x16x32_bf16 v[32:35], a[64:67], a[32:35], v[88:91]
    ds_read_b64_tr_b16 a[144:145], v8 offset:0
    v_exp_f32 v48, v48
    v_exp_f32 v49, v49
    v_mfma_f32_16x16x32_bf16 v[32:35], a[68:71], a[36:39], v[32:35]
    ds_read_b64_tr_b16 a[146:147], v8 offset:4096
    v_mfma_f32_16x16x32_bf16 v[32:35], a[72:75], a[40:43], v[32:35]
    ds_read_b64_tr_b16 a[176:177], v8 offset:8192
    v_mfma_f32_16x16x32_bf16 v[32:35], a[76:79], a[44:47], v[32:35]
    ds_read_b64_tr_b16 a[178:179], v8 offset:12288
    v_cvt_pk_bf16_f32 v72, v48, v49
    v_mfma_f32_16x16x32_bf16 v[36:39], a[92:95], a[44:47], v[88:91]
    ds_read_b64_tr_b16 a[148:149], v9 offset:0
    v_exp_f32 v50, v50
    v_exp_f32 v51, v51
    v_mfma_f32_16x16x32_bf16 v[36:39], a[88:91], a[40:43], v[36:39]
    ds_read_b64_tr_b16 a[150:151], v9 offset:4096
    v_mfma_f32_16x16x32_bf16 v[36:39], a[84:87], a[36:39], v[36:39]
    ds_read_b64_tr_b16 a[180:181], v9 offset:8192
    v_mfma_f32_16x16x32_bf16 v[36:39], a[80:83], a[32:35], v[36:39]
    ds_read_b64_tr_b16 a[182:183], v9 offset:12288
    v_cvt_pk_bf16_f32 v73, v50, v51
    v_mfma_f32_16x16x32_bf16 v[40:43], a[96:99], a[32:35], v[88:91]
    ds_read_b64_tr_b16 a[152:153], v10 offset:0
    v_exp_f32 v52, v52
    v_exp_f32 v53, v53
    v_mfma_f32_16x16x32_bf16 v[40:43], a[100:103], a[36:39], v[40:43]
    ds_read_b64_tr_b16 a[154:155], v10 offset:4096
    v_mfma_f32_16x16x32_bf16 v[40:43], a[104:107], a[40:43], v[40:43]
    ds_read_b64_tr_b16 a[184:185], v10 offset:8192
    v_mfma_f32_16x16x32_bf16 v[40:43], a[108:111], a[44:47], v[40:43]
    ds_read_b64_tr_b16 a[186:187], v10 offset:12288
    v_cvt_pk_bf16_f32 v74, v52, v53
    v_mfma_f32_16x16x32_bf16 v[44:47], a[124:127], a[44:47], v[88:91]
    ds_read_b64_tr_b16 a[156:157], v11 offset:0
    v_exp_f32 v54, v54
    v_exp_f32 v55, v55
    v_mfma_f32_16x16x32_bf16 v[44:47], a[120:123], a[40:43], v[44:47]
    ds_read_b64_tr_b16 a[158:159], v11 offset:4096
    v_mfma_f32_16x16x32_bf16 v[44:47], a[116:119], a[36:39], v[44:47]
    ds_read_b64_tr_b16 a[188:189], v11 offset:8192
    v_mfma_f32_16x16x32_bf16 v[44:47], a[112:115], a[32:35], v[44:47]
    ds_read_b64_tr_b16 a[190:191], v11 offset:12288
    s_waitcnt lgkmcnt(15)
    v_cvt_pk_bf16_f32 v75, v54, v55
    v_mfma_f32_16x16x32_bf16 v[128:131], a[128:131], v[64:67], v[128:131]
    s_add_u32 s32, s32, 4096
    v_exp_f32 v56, v56
    v_exp_f32 v57, v57
    v_mfma_f32_16x16x32_bf16 v[128:131], a[160:163], v[68:71], v[128:131]
    s_andn2_b32 s32, s32, 98304
    v_mfma_f32_16x16x32_bf16 v[132:135], a[164:167], v[68:71], v[132:135]
    s_mov_b32 m0, s7
    v_mfma_f32_16x16x32_bf16 v[132:135], a[132:135], v[64:67], v[132:135]
    s_waitcnt lgkmcnt(15)
    v_cvt_pk_bf16_f32 v76, v56, v57
    v_mfma_f32_16x16x32_bf16 v[136:139], a[136:139], v[64:67], v[136:139]
    buffer_load_dwordx4 v12, s[12:15], s32 offen offset:0 nt lds
    v_exp_f32 v58, v58
    v_exp_f32 v59, v59
    v_mfma_f32_16x16x32_bf16 v[136:139], a[168:171], v[68:71], v[136:139]
    v_mfma_f32_16x16x32_bf16 v[140:143], a[172:175], v[68:71], v[140:143]
    v_mfma_f32_16x16x32_bf16 v[140:143], a[140:143], v[64:67], v[140:143]
    s_waitcnt lgkmcnt(8)
    v_cvt_pk_bf16_f32 v77, v58, v59
    v_mfma_f32_16x16x32_bf16 v[144:147], a[144:147], v[64:67], v[144:147]
    buffer_load_dwordx4 v13, s[12:15], s32 offen offset:1024 nt lds
    v_exp_f32 v60, v60
    v_exp_f32 v61, v61
    v_mfma_f32_16x16x32_bf16 v[144:147], a[176:179], v[68:71], v[144:147]
    v_mfma_f32_16x16x32_bf16 v[148:151], a[180:183], v[68:71], v[148:151]
    v_mfma_f32_16x16x32_bf16 v[148:151], a[148:151], v[64:67], v[148:151]
    s_waitcnt lgkmcnt(0)
    v_cvt_pk_bf16_f32 v78, v60, v61
    v_mfma_f32_16x16x32_bf16 v[152:155], a[152:155], v[64:67], v[152:155]
    buffer_load_dwordx4 v14, s[12:15], s32 offen offset:2048 nt lds
    v_exp_f32 v62, v62
    v_exp_f32 v63, v63
    v_mfma_f32_16x16x32_bf16 v[152:155], a[184:187], v[68:71], v[152:155]
    v_mfma_f32_16x16x32_bf16 v[156:159], a[188:191], v[68:71], v[156:159]
    v_mfma_f32_16x16x32_bf16 v[156:159], a[156:159], v[64:67], v[156:159]
    v_cvt_pk_bf16_f32 v79, v62, v63
    v_smfmac_f32_16x16x64_bf16 a[192:195], a[208:211], v[64:71], v111
    buffer_load_dwordx4 v15, s[12:15], s32 offen offset:3072 nt lds
    v_mfma_f32_16x16x32_bf16 v[48:51], a[64:67], a[48:51], v[92:95]
    s_mov_b32 s4, s5
    v_exp_f32 v32, v32
    v_mfma_f32_16x16x32_bf16 v[48:51], a[68:71], a[52:55], v[48:51]
    ds_read_b128 a[64:67], v0 offset:0
    v_mfma_f32_16x16x32_bf16 v[48:51], a[72:75], a[56:59], v[48:51]
    s_xor_b32 s5, s5, 0xc000
    v_exp_f32 v33, v33
    v_mfma_f32_16x16x32_bf16 v[48:51], a[76:79], a[60:63], v[48:51]
    ds_read_b128 a[68:71], v1 offset:0
    v_cvt_pk_bf16_f32 v64, v32, v33
    v_mfma_f32_16x16x32_bf16 v[52:55], a[92:95], a[60:63], v[92:95]
    s_add_u32 s33, s33, 1
    v_exp_f32 v34, v34
    v_mfma_f32_16x16x32_bf16 v[52:55], a[88:91], a[56:59], v[52:55]
    ds_read_b128 a[72:75], v2 offset:0
    v_mfma_f32_16x16x32_bf16 v[52:55], a[84:87], a[52:55], v[52:55]
    v_exp_f32 v35, v35
    v_mfma_f32_16x16x32_bf16 v[52:55], a[80:83], a[48:51], v[52:55]
    ds_read_b128 a[76:79], v3 offset:0
    v_cvt_pk_bf16_f32 v65, v34, v35
    v_mfma_f32_16x16x32_bf16 v[56:59], a[96:99], a[48:51], v[92:95]
    v_exp_f32 v36, v36
    v_mfma_f32_16x16x32_bf16 v[56:59], a[100:103], a[52:55], v[56:59]
    ds_read_b128 a[92:95], v3 offset:4096
    v_mfma_f32_16x16x32_bf16 v[56:59], a[104:107], a[56:59], v[56:59]
    v_exp_f32 v37, v37
    v_mfma_f32_16x16x32_bf16 v[56:59], a[108:111], a[60:63], v[56:59]
    ds_read_b128 a[88:91], v2 offset:4096
    v_cvt_pk_bf16_f32 v66, v36, v37
    v_mfma_f32_16x16x32_bf16 v[60:63], a[124:127], a[60:63], v[92:95]
    v_exp_f32 v38, v38
    v_mfma_f32_16x16x32_bf16 v[60:63], a[120:123], a[56:59], v[60:63]
    ds_read_b128 a[84:87], v1 offset:4096
    v_mfma_f32_16x16x32_bf16 v[60:63], a[116:119], a[52:55], v[60:63]
    v_exp_f32 v39, v39
    v_mfma_f32_16x16x32_bf16 v[60:63], a[112:115], a[48:51], v[60:63]
    ds_read_b128 a[80:83], v0 offset:4096
    v_cvt_pk_bf16_f32 v67, v38, v39
    v_mfma_f32_16x16x32_bf16 v[160:163], a[128:131], v[72:75], v[160:163]
    v_exp_f32 v40, v40
    v_mfma_f32_16x16x32_bf16 v[160:163], a[160:163], v[76:79], v[160:163]
    ds_read_b128 a[96:99], v0 offset:8192
    v_mfma_f32_16x16x32_bf16 v[164:167], a[164:167], v[76:79], v[164:167]
    v_exp_f32 v41, v41
    v_mfma_f32_16x16x32_bf16 v[164:167], a[132:135], v[72:75], v[164:167]
    ds_read_b128 a[100:103], v1 offset:8192
    v_cvt_pk_bf16_f32 v68, v40, v41
    v_mfma_f32_16x16x32_bf16 v[168:171], a[136:139], v[72:75], v[168:171]
    v_exp_f32 v42, v42
    v_mfma_f32_16x16x32_bf16 v[168:171], a[168:171], v[76:79], v[168:171]
    ds_read_b128 a[104:107], v2 offset:8192
    v_mfma_f32_16x16x32_bf16 v[172:175], a[172:175], v[76:79], v[172:175]
    v_exp_f32 v43, v43
    v_mfma_f32_16x16x32_bf16 v[172:175], a[140:143], v[72:75], v[172:175]
    ds_read_b128 a[108:111], v3 offset:8192
    v_cvt_pk_bf16_f32 v69, v42, v43
    v_mfma_f32_16x16x32_bf16 v[176:179], a[144:147], v[72:75], v[176:179]
    v_exp_f32 v44, v44
    v_mfma_f32_16x16x32_bf16 v[176:179], a[176:179], v[76:79], v[176:179]
    ds_read_b128 a[124:127], v3 offset:12288
    v_mfma_f32_16x16x32_bf16 v[180:183], a[180:183], v[76:79], v[180:183]
    v_exp_f32 v45, v45
    v_mfma_f32_16x16x32_bf16 v[180:183], a[148:151], v[72:75], v[180:183]
    ds_read_b128 a[120:123], v2 offset:12288
    v_cvt_pk_bf16_f32 v70, v44, v45
    v_mfma_f32_16x16x32_bf16 v[184:187], a[152:155], v[72:75], v[184:187]
    v_exp_f32 v46, v46
    v_mfma_f32_16x16x32_bf16 v[184:187], a[184:187], v[76:79], v[184:187]
    ds_read_b128 a[116:119], v1 offset:12288
    v_mfma_f32_16x16x32_bf16 v[188:191], a[188:191], v[76:79], v[188:191]
    s_cmp_lt_u32 s33, 32
    v_exp_f32 v47, v47
    v_mfma_f32_16x16x32_bf16 v[188:191], a[156:159], v[72:75], v[188:191]
    ds_read_b128 a[112:115], v0 offset:12288
    v_cvt_pk_bf16_f32 v71, v46, v47
    v_smfmac_f32_16x16x64_bf16 a[196:199], a[208:211], v[72:79], v111
    s_waitcnt lgkmcnt(12)
    s_cbranch_scc1 S_L4E
    s_branch S_E4
Z_L4E:
.p2align 6
T_L3:
    s_branch L_backE
    s_nop 0
S_L3:
    v_mfma_f32_16x16x32_bf16 v[32:35], a[64:67], a[0:3], v[80:83]
    v_exp_f32 v224, v224
    v_mfma_f32_16x16x32_bf16 v[32:35], a[68:71], a[4:7], v[32:35]
    v_xor_b32 v0, s5, v0
    v_mfma_f32_16x16x32_bf16 v[32:35], a[72:75], a[8:11], v[32:35]
    v_exp_f32 v225, v225
    v_mfma_f32_16x16x32_bf16 v[32:35], a[76:79], a[12:15], v[32:35]
    s_waitcnt lgkmcnt(8)
    v_cvt_pk_bf16_f32 v240, v224, v225
    v_mfma_f32_16x16x32_bf16 v[36:39], a[92:95], a[12:15], v[80:83]
    v_exp_f32 v226, v226
    v_mfma_f32_16x16x32_bf16 v[36:39], a[88:91], a[8:11], v[36:39]
    v_xor_b32 v1, s5, v1
    v_mfma_f32_16x16x32_bf16 v[36:39], a[84:87], a[4:7], v[36:39]
    v_exp_f32 v227, v227
    v_mfma_f32_16x16x32_bf16 v[36:39], a[80:83], a[0:3], v[36:39]
    s_waitcnt lgkmcnt(4)
    v_cvt_pk_bf16_f32 v241, v226, v227
    v_mfma_f32_16x16x32_bf16 v[40:43], a[96:99], a[0:3], v[80:83]
    v_exp_f32 v228, v228
    v_mfma_f32_16x16x32_bf16 v[40:43], a[100:103], a[4:7], v[40:43]
    v_xor_b32 v2, s5, v2
    v_mfma_f32_16x16x32_bf16 v[40:43], a[104:107], a[8:11], v[40:43]
    v_exp_f32 v229, v229
    v_mfma_f32_16x16x32_bf16 v[40:43], a[108:111], a[12:15], v[40:43]
    s_waitcnt lgkmcnt(0)
    v_cvt_pk_bf16_f32 v242, v228, v229
    v_mfma_f32_16x16x32_bf16 v[44:47], a[124:127], a[12:15], v[80:83]
    v_exp_f32 v230, v230
    v_mfma_f32_16x16x32_bf16 v[44:47], a[120:123], a[8:11], v[44:47]
    v_xor_b32 v3, s5, v3
    v_mfma_f32_16x16x32_bf16 v[44:47], a[116:119], a[4:7], v[44:47]
    v_exp_f32 v231, v231
    v_mfma_f32_16x16x32_bf16 v[44:47], a[112:115], a[0:3], v[44:47]
    v_cvt_pk_bf16_f32 v243, v230, v231
    v_mfma_f32_16x16x32_bf16 v[160:163], a[128:131], v[72:75], v[160:163]
    v_exp_f32 v232, v232
    v_mfma_f32_16x16x32_bf16 v[160:163], a[160:163], v[76:79], v[160:163]
    v_xor_b32 v4, s4, v4
    v_mfma_f32_16x16x32_bf16 v[164:167], a[164:167], v[76:79], v[164:167]
    v_exp_f32 v233, v233
    v_mfma_f32_16x16x32_bf16 v[164:167], a[132:135], v[72:75], v[164:167]
    v_cvt_pk_bf16_f32 v244, v232, v233
    v_mfma_f32_16x16x32_bf16 v[168:171], a[136:139], v[72:75], v[168:171]
    v_exp_f32 v234, v234
    v_mfma_f32_16x16x32_bf16 v[168:171], a[168:171], v[76:79], v[168:171]
    v_xor_b32 v5, s4, v5
    v_mfma_f32_16x16x32_bf16 v[172:175], a[172:175], v[76:79], v[172:175]
    v_exp_f32 v235, v235
    v_mfma_f32_16x16x32_bf16 v[172:175], a[140:143], v[72:75], v[172:175]
    v_cvt_pk_bf16_f32 v245, v234, v235
    v_mfma_f32_16x16x32_bf16 v[176:179], a[144:147], v[72:75], v[176:179]
    v_exp_f32 v236, v236
    v_mfma_f32_16x16x32_bf16 v[176:179], a[176:179], v[76:79], v[176:179]
    v_xor_b32 v6, s4, v6
    v_mfma_f32_16x16x32_bf16 v[180:183], a[180:183], v[76:79], v[180:183]
    v_exp_f32 v237, v237
    v_mfma_f32_16x16x32_bf16 v[180:183], a[148:151], v[72:75], v[180:183]
    v_cvt_pk_bf16_f32 v246, v236, v237
    v_mfma_f32_16x16x32_bf16 v[184:187], a[152:155], v[72:75], v[184:187]
    v_exp_f32 v238, v238
    v_mfma_f32_16x16x32_bf16 v[184:187], a[184:187], v[76:79], v[184:187]
    v_xor_b32 v7, s4, v7
    v_mfma_f32_16x16x32_bf16 v[188:191], a[188:191], v[76:79], v[188:191]
    v_exp_f32 v239, v239
    v_mfma_f32_16x16x32_bf16 v[188:191], a[156:159], v[72:75], v[188:191]
    s_waitcnt vmcnt(16)
    v_cvt_pk_bf16_f32 v247, v238, v239
    v_smfmac_f32_16x16x64_bf16 a[196:199], a[208:211], v[72:79], v111
    s_barrier
    v_mfma_f32_16x16x32_bf16 v[48:51], a[64:67], a[16:19], v[84:87]
    s_xor_b32 s6, s6, s5
    v_exp_f32 v32, v32
    v_mfma_f32_16x16x32_bf16 v[48:51], a[68:71], a[20:23], v[48:51]
    s_xor_b32 s7, s7, s4
    v_xor_b32 v8, s4, v8
    v_mfma_f32_16x16x32_bf16 v[48:51], a[72:75], a[24:27], v[48:51]
    s_mov_b32 m0, s6
    v_exp_f32 v33, v33
    v_mfma_f32_16x16x32_bf16 v[48:51], a[76:79], a[28:31], v[48:51]
    buffer_load_dwordx4 v16, s[16:19], s32 offen offset:0 nt lds
    v_cvt_pk_bf16_f32 v64, v32, v33
    v_mfma_f32_16x16x32_bf16 v[52:55], a[92:95], a[28:31], v[84:87]
    v_exp_f32 v34, v34
    v_mfma_f32_16x16x32_bf16 v[52:55], a[88:91], a[24:27], v[52:55]
    v_xor_b32 v9, s4, v9
    v_mfma_f32_16x16x32_bf16 v[52:55], a[84:87], a[20:23], v[52:55]
    v_exp_f32 v35, v35
    v_mfma_f32_16x16x32_bf16 v[52:55], a[80:83], a[16:19], v[52:55]
    buffer_load_dwordx4 v17, s[16:19], s32 offen offset:1024 nt lds
    v_cvt_pk_bf16_f32 v65, v34, v35
    v_mfma_f32_16x16x32_bf16 v[56:59], a[96:99], a[16:19], v[84:87]
    v_exp_f32 v36, v36
    v_mfma_f32_16x16x32_bf16 v[56:59], a[100:103], a[20:23], v[56:59]
    v_xor_b32 v10, s4, v10
    v_mfma_f32_16x16x32_bf16 v[56:59], a[104:107], a[24:27], v[56:59]
    v_exp_f32 v37, v37
    v_mfma_f32_16x16x32_bf16 v[56:59], a[108:111], a[28:31], v[56:59]
    buffer_load_dwordx4 v16, s[16:19], s32 offen offset:2048 nt lds
    v_cvt_pk_bf16_f32 v66, v36, v37
    v_mfma_f32_16x16x32_bf16 v[60:63], a[124:127], a[28:31], v[84:87]
    v_exp_f32 v38, v38
    v_mfma_f32_16x16x32_bf16 v[60:63], a[120:123], a[24:27], v[60:63]
    v_xor_b32 v11, s4, v11
    v_mfma_f32_16x16x32_bf16 v[60:63], a[116:119], a[20:23], v[60:63]
    v_exp_f32 v39, v39
    v_mfma_f32_16x16x32_bf16 v[60:63], a[112:115], a[16:19], v[60:63]
    buffer_load_dwordx4 v17, s[16:19], s32 offen offset:3072 nt lds
    v_cvt_pk_bf16_f32 v67, v38, v39
    v_mfma_f32_16x16x32_bf16 v[192:195], a[128:131], v[240:243], v[192:195]
    s_or_b32 s32, s32, 98304
    v_exp_f32 v40, v40
    v_mfma_f32_16x16x32_bf16 v[192:195], a[160:163], v[244:247], v[192:195]
    ds_read_b64_tr_b16 a[128:129], v4 offset:0
    v_mfma_f32_16x16x32_bf16 v[196:199], a[164:167], v[244:247], v[196:199]
    ds_read_b64_tr_b16 a[130:131], v4 offset:4096
    v_exp_f32 v41, v41
    v_mfma_f32_16x16x32_bf16 v[196:199], a[132:135], v[240:243], v[196:199]
    ds_read_b64_tr_b16 a[160:161], v4 offset:8192
    v_cvt_pk_bf16_f32 v68, v40, v41
    v_mfma_f32_16x16x32_bf16 v[200:203], a[136:139], v[240:243], v[200:203]
    ds_read_b64_tr_b16 a[162:163], v4 offset:12288
    v_exp_f32 v42, v42
    v_mfma_f32_16x16x32_bf16 v[200:203], a[168:171], v[244:247], v[200:203]
    ds_read_b64_tr_b16 a[132:133], v5 offset:0
    v_mfma_f32_16x16x32_bf16 v[204:207], a[172:175], v[244:247], v[204:207]
    ds_read_b64_tr_b16 a[134:135], v5 offset:4096
    v_exp_f32 v43, v43
    v_mfma_f32_16x16x32_bf16 v[204:207], a[140:143], v[240:243], v[204:207]
    ds_read_b64_tr_b16 a[164:165], v5 offset:8192
    v_cvt_pk_bf16_f32 v69, v42, v43
    v_mfma_f32_16x16x32_bf16 v[208:211], a[144:147], v[240:243], v[208:211]
    ds_read_b64_tr_b16 a[166:167], v5 offset:12288
    v_exp_f32 v44, v44
    v_mfma_f32_16x16x32_bf16 v[208:211], a[176:179], v[244:247], v[208:211]
    ds_read_b64_tr_b16 a[136:137], v6 offset:0
    v_mfma_f32_16x16x32_bf16 v[212:215], a[180:183], v[244:247], v[212:215]
    ds_read_b64_tr_b16 a[138:139], v6 offset:4096
    v_exp_f32 v45, v45
    v_mfma_f32_16x16x32_bf16 v[212:215], a[148:151], v[240:243], v[212:215]
    ds_read_b64_tr_b16 a[168:169], v6 offset:8192
    v_cvt_pk_bf16_f32 v70, v44, v45
    v_mfma_f32_16x16x32_bf16 v[216:219], a[152:155], v[240:243], v[216:219]
    ds_read_b64_tr_b16 a[170:171], v6 offset:12288
    v_exp_f32 v46, v46
    v_mfma_f32_16x16x32_bf16 v[216:219], a[184:187], v[244:247], v[216:219]
    ds_read_b64_tr_b16 a[140:141], v7 offset:0
    v_mfma_f32_16x16x32_bf16 v[220:223], a[188:191], v[244:247], v[220:223]
    ds_read_b64_tr_b16 a[142:143], v7 offset:4096
    v_exp_f32 v47, v47
    v_mfma_f32_16x16x32_bf16 v[220:223], a[156:159], v[240:243], v[220:223]
    ds_read_b64_tr_b16 a[172:173], v7 offset:8192
    v_cvt_pk_bf16_f32 v71, v46, v47
    v_smfmac_f32_16x16x64_bf16 a[200:203], a[208:211], v[240:247], v111
    ds_read_b64_tr_b16 a[174:175], v7 offset:12288
    v_mfma_f32_16x16x32_bf16 v[224:227], a[64:67], a[32:35], v[88:91]
    ds_read_b64_tr_b16 a[144:145], v8 offset:0
    v_exp_f32 v48, v48
    v_mfma_f32_16x16x32_bf16 v[224:227], a[68:71], a[36:39], v[224:227]
    ds_read_b64_tr_b16 a[146:147], v8 offset:4096
    v_mfma_f32_16x16x32_bf16 v[224:227], a[72:75], a[40:43], v[224:227]
    ds_read_b64_tr_b16 a[176:177], v8 offset:8192
    v_exp_f32 v49, v49
    v_mfma_f32_16x16x32_bf16 v[224:227], a[76:79], a[44:47], v[224:227]
    ds_read_b64_tr_b16 a[178:179], v8 offset:12288
    v_cvt_pk_bf16_f32 v72, v48, v49
    v_mfma_f32_16x16x32_bf16 v[228:231], a[92:95], a[44:47], v[88:91]
    ds_read_b64_tr_b16 a[148:149], v9 offset:0
    v_exp_f32 v50, v50
    v_mfma_f32_16x16x32_bf16 v[228:231], a[88:91], a[40:43], v[228:231]
    ds_read_b64_tr_b16 a[150:151], v9 offset:4096
    v_mfma_f32_16x16x32_bf16 v[228:231], a[84:87], a[36:39], v[228:231]
    ds_read_b64_tr_b16 a[180:181], v9 offset:8192
    s_mov_b32 s4, s5
    v_exp_f32 v51, v51
    v_mfma_f32_16x16x32_bf16 v[228:231], a[80:83], a[32:35], v[228:231]
    ds_read_b64_tr_b16 a[182:183], v9 offset:12288
    v_cvt_pk_bf16_f32 v73, v50, v51
    v_mfma_f32_16x16x32_bf16 v[232:235], a[96:99], a[32:35], v[88:91]
    ds_read_b64_tr_b16 a[152:153], v10 offset:0
    s_xor_b32 s5, s5, 0xc000
    v_exp_f32 v52, v52
    v_mfma_f32_16x16x32_bf16 v[232:235], a[100:103], a[36:39], v[232:235]
    ds_read_b64_tr_b16 a[154:155], v10 offset:4096
    v_mfma_f32_16x16x32_bf16 v[232:235], a[104:107], a[40:43], v[232:235]
    ds_read_b64_tr_b16 a[184:185], v10 offset:8192
    s_add_u32 s33, s33, 1
    v_exp_f32 v53, v53
    v_mfma_f32_16x16x32_bf16 v[232:235], a[108:111], a[44:47], v[232:235]
    ds_read_b64_tr_b16 a[186:187], v10 offset:12288
    v_cvt_pk_bf16_f32 v74, v52, v53
    v_mfma_f32_16x16x32_bf16 v[236:239], a[124:127], a[44:47], v[88:91]
    ds_read_b64_tr_b16 a[156:157], v11 offset:0
    v_exp_f32 v54, v54
    v_mfma_f32_16x16x32_bf16 v[236:239], a[120:123], a[40:43], v[236:239]
    ds_read_b64_tr_b16 a[158:159], v11 offset:4096
    v_mfma_f32_16x16x32_bf16 v[236:239], a[116:119], a[36:39], v[236:239]
    ds_read_b64_tr_b16 a[188:189], v11 offset:8192
    v_exp_f32 v55, v55
    v_mfma_f32_16x16x32_bf16 v[236:239], a[112:115], a[32:35], v[236:239]
    ds_read_b64_tr_b16 a[190:191], v11 offset:12288
    s_waitcnt lgkmcnt(15)
    v_cvt_pk_bf16_f32 v75, v54, v55
    v_mfma_f32_16x16x32_bf16 v[128:131], a[128:131], v[64:67], v[128:131]
    ds_read_b128 a[64:67], v0 offset:0
    s_add_u32 s32, s32, 4096
    v_exp_f32 v56, v56
    v_mfma_f32_16x16x32_bf16 v[128:131], a[160:163], v[68:71], v[128:131]
    ds_read_b128 a[68:71], v1 offset:0
    s_andn2_b32 s32, s32, 98304
    v_mfma_f32_16x16x32_bf16 v[132:135], a[164:167], v[68:71], v[132:135]
    ds_read_b128 a[72:75], v2 offset:0
    s_mov_b32 m0, s7
    v_exp_f32 v57, v57
    v_mfma_f32_16x16x32_bf16 v[132:135], a[132:135], v[64:67], v[132:135]
    s_waitcnt lgkmcnt(15)
    ds_read_b128 a[76:79], v3 offset:0
    v_cvt_pk_bf16_f32 v76, v56, v57
    v_mfma_f32_16x16x32_bf16 v[136:139], a[136:139], v[64:67], v[136:139]
    ds_read_b128 a[92:95], v3 offset:4096
    buffer_load_dwordx4 v12, s[12:15], s32 offen offset:0 nt lds
    v_exp_f32 v58, v58
    v_mfma_f32_16x16x32_bf16 v[136:139], a[168:171], v[68:71], v[136:139]
    ds_read_b128 a[88:91], v2 offset:4096
    v_mfma_f32_16x16x32_bf16 v[140:143], a[172:175], v[68:71], v[140:143]
    ds_read_b128 a[84:87], v1 offset:4096
    v_exp_f32 v59, v59
    v_mfma_f32_16x16x32_bf16 v[140:143], a[140:143], v[64:67], v[140:143]
    s_waitcnt lgkmcnt(15)
    ds_read_b128 a[80:83], v0 offset:4096
    v_cvt_pk_bf16_f32 v77, v58, v59
    v_mfma_f32_16x16x32_bf16 v[144:147], a[144:147], v[64:67], v[144:147]
    ds_read_b128 a[96:99], v0 offset:8192
    buffer_load_dwordx4 v13, s[12:15], s32 offen offset:1024 nt lds
    v_exp_f32 v60, v60
    v_mfma_f32_16x16x32_bf16 v[144:147], a[176:179], v[68:71], v[144:147]
    ds_read_b128 a[100:103], v1 offset:8192
    v_mfma_f32_16x16x32_bf16 v[148:151], a[180:183], v[68:71], v[148:151]
    ds_read_b128 a[104:107], v2 offset:8192
    v_exp_f32 v61, v61
    v_mfma_f32_16x16x32_bf16 v[148:151], a[148:151], v[64:67], v[148:151]
    s_waitcnt lgkmcnt(11)
    ds_read_b128 a[108:111], v3 offset:8192
    v_cvt_pk_bf16_f32 v78, v60, v61
    v_mfma_f32_16x16x32_bf16 v[152:155], a[152:155], v[64:67], v[152:155]
    ds_read_b128 a[124:127], v3 offset:12288
    buffer_load_dwordx4 v14, s[12:15], s32 offen offset:2048 nt lds
    v_exp_f32 v62, v62
    v_mfma_f32_16x16x32_bf16 v[152:155], a[184:187], v[68:71], v[152:155]
    ds_read_b128 a[120:123], v2 offset:12288
    v_mfma_f32_16x16x32_bf16 v[156:159], a[188:191], v[68:71], v[156:159]
    ds_read_b128 a[116:119], v1 offset:12288
    v_exp_f32 v63, v63
    v_mfma_f32_16x16x32_bf16 v[156:159], a[156:159], v[64:67], v[156:159]
    ds_read_b128 a[112:115], v0 offset:12288
    s_cmp_lt_u32 s33, 32
    v_cvt_pk_bf16_f32 v79, v62, v63
    v_smfmac_f32_16x16x64_bf16 a[192:195], a[208:211], v[64:71], v111
    s_waitcnt lgkmcnt(12)
    buffer_load_dwordx4 v15, s[12:15], s32 offen offset:3072 nt lds
    s_cbranch_scc1 S_L3
    s_branch S_E3
Z_L3:
.p2align 12
T_E4:
    s_branch L_backE
    s_nop 0
S_E4:
    s_waitcnt vmcnt(0)
    v_accvgpr_read_b32 v104, a192
    v_accvgpr_read_b32 v20, a193
    v_add_f32 v104, v104, v20
    v_rcp_f32 v20, v104
    s_nop 0
    v_pk_mul_f32 v[128:129], v[128:129], v[20:21] op_sel_hi:[1,0]
    v_pk_mul_f32 v[130:131], v[130:131], v[20:21] op_sel_hi:[1,0]
    v_pk_mul_f32 v[132:133], v[132:133], v[20:21] op_sel_hi:[1,0]
    v_pk_mul_f32 v[134:135], v[134:135], v[20:21] op_sel_hi:[1,0]
    v_pk_mul_f32 v[136:137], v[136:137], v[20:21] op_sel_hi:[1,0]
    v_pk_mul_f32 v[138:139], v[138:139], v[20:21] op_sel_hi:[1,0]
    v_pk_mul_f32 v[140:141], v[140:141], v[20:21] op_sel_hi:[1,0]
    v_pk_mul_f32 v[142:143], v[142:143], v[20:21] op_sel_hi:[1,0]
    v_pk_mul_f32 v[144:145], v[144:145], v[20:21] op_sel_hi:[1,0]
    v_pk_mul_f32 v[146:147], v[146:147], v[20:21] op_sel_hi:[1,0]
    v_pk_mul_f32 v[148:149], v[148:149], v[20:21] op_sel_hi:[1,0]
    v_pk_mul_f32 v[150:151], v[150:151], v[20:21] op_sel_hi:[1,0]
    v_pk_mul_f32 v[152:153], v[152:153], v[20:21] op_sel_hi:[1,0]
    v_pk_mul_f32 v[154:155], v[154:155], v[20:21] op_sel_hi:[1,0]
    v_pk_mul_f32 v[156:157], v[156:157], v[20:21] op_sel_hi:[1,0]
    v_pk_mul_f32 v[158:159], v[158:159], v[20:21] op_sel_hi:[1,0]
    v_accvgpr_read_b32 v105, a196
    v_accvgpr_read_b32 v22, a197
    v_add_f32 v105, v105, v22
    v_rcp_f32 v22, v105
    v_cvt_pk_bf16_f32 v112, v128, v129
    v_cvt_pk_bf16_f32 v113, v130, v131
    ds_write_b64 v26, v[112:113] offset:0
    v_cvt_pk_bf16_f32 v114, v132, v133
    v_cvt_pk_bf16_f32 v115, v134, v135
    ds_write_b64 v27, v[114:115] offset:0
    v_cvt_pk_bf16_f32 v116, v136, v137
    v_cvt_pk_bf16_f32 v117, v138, v139
    ds_write_b64 v28, v[116:117] offset:0
    v_cvt_pk_bf16_f32 v118, v140, v141
    v_cvt_pk_bf16_f32 v119, v142, v143
    ds_write_b64 v29, v[118:119] offset:0
    v_cvt_pk_bf16_f32 v120, v144, v145
    v_cvt_pk_bf16_f32 v121, v146, v147
    ds_write_b64 v30, v[120:121] offset:0
    v_cvt_pk_bf16_f32 v122, v148, v149
    v_cvt_pk_bf16_f32 v123, v150, v151
    ds_write_b64 v31, v[122:123] offset:0
    v_cvt_pk_bf16_f32 v124, v152, v153
    v_cvt_pk_bf16_f32 v125, v154, v155
    ds_write_b64 v19, v[124:125] offset:0
    v_cvt_pk_bf16_f32 v126, v156, v157
    v_cvt_pk_bf16_f32 v127, v158, v159
    ds_write_b64 v108, v[126:127] offset:0
    v_pk_mul_f32 v[160:161], v[160:161], v[22:23] op_sel_hi:[1,0]
    v_pk_mul_f32 v[162:163], v[162:163], v[22:23] op_sel_hi:[1,0]
    v_pk_mul_f32 v[164:165], v[164:165], v[22:23] op_sel_hi:[1,0]
    v_pk_mul_f32 v[166:167], v[166:167], v[22:23] op_sel_hi:[1,0]
    v_pk_mul_f32 v[168:169], v[168:169], v[22:23] op_sel_hi:[1,0]
    v_pk_mul_f32 v[170:171], v[170:171], v[22:23] op_sel_hi:[1,0]
    v_pk_mul_f32 v[172:173], v[172:173], v[22:23] op_sel_hi:[1,0]
    v_pk_mul_f32 v[174:175], v[174:175], v[22:23] op_sel_hi:[1,0]
    v_pk_mul_f32 v[176:177], v[176:177], v[22:23] op_sel_hi:[1,0]
    v_pk_mul_f32 v[178:179], v[178:179], v[22:23] op_sel_hi:[1,0]
    v_pk_mul_f32 v[180:181], v[180:181], v[22:23] op_sel_hi:[1,0]
    v_pk_mul_f32 v[182:183], v[182:183], v[22:23] op_sel_hi:[1,0]
    v_pk_mul_f32 v[184:185], v[184:185], v[22:23] op_sel_hi:[1,0]
    v_pk_mul_f32 v[186:187], v[186:187], v[22:23] op_sel_hi:[1,0]
    v_pk_mul_f32 v[188:189], v[188:189], v[22:23] op_sel_hi:[1,0]
    v_pk_mul_f32 v[190:191], v[190:191], v[22:23] op_sel_hi:[1,0]
    v_mfma_f32_16x16x32_bf16 v[192:195], a[128:131], v[64:67], v[192:195]
    v_exp_f32 v48, v48
    v_mfma_f32_16x16x32_bf16 v[192:195], a[160:163], v[68:71], v[192:195]
    s_waitcnt lgkmcnt(0)
    v_exp_f32 v49, v49
    v_mfma_f32_16x16x32_bf16 v[196:199], a[164:167], v[68:71], v[196:199]
    ds_read_b128 v[128:131], v100 offset:0
    v_exp_f32 v50, v50
    v_cvt_pk_bf16_f32 v72, v48, v49
    v_mfma_f32_16x16x32_bf16 v[196:199], a[132:135], v[64:67], v[196:199]
    ds_read_b128 v[132:135], v101 offset:1024
    v_exp_f32 v51, v51
    v_mfma_f32_16x16x32_bf16 v[200:203], a[136:139], v[64:67], v[200:203]
    ds_read_b128 v[136:139], v102 offset:2048
    v_exp_f32 v52, v52
    v_cvt_pk_bf16_f32 v73, v50, v51
    v_mfma_f32_16x16x32_bf16 v[200:203], a[168:171], v[68:71], v[200:203]
    ds_read_b128 v[140:143], v103 offset:3072
    v_exp_f32 v53, v53
    v_mfma_f32_16x16x32_bf16 v[204:207], a[172:175], v[68:71], v[204:207]
    v_exp_f32 v54, v54
    v_cvt_pk_bf16_f32 v74, v52, v53
    v_mfma_f32_16x16x32_bf16 v[204:207], a[140:143], v[64:67], v[204:207]
    v_exp_f32 v55, v55
    v_mfma_f32_16x16x32_bf16 v[208:211], a[144:147], v[64:67], v[208:211]
    v_exp_f32 v56, v56
    v_cvt_pk_bf16_f32 v75, v54, v55
    v_mfma_f32_16x16x32_bf16 v[208:211], a[176:179], v[68:71], v[208:211]
    s_waitcnt lgkmcnt(0)
    v_exp_f32 v57, v57
    v_mfma_f32_16x16x32_bf16 v[212:215], a[180:183], v[68:71], v[212:215]
    buffer_store_dwordx4 v[128:131], v109, s[24:27], 0 offen offset:0 sc1
    v_exp_f32 v58, v58
    v_cvt_pk_bf16_f32 v76, v56, v57
    v_mfma_f32_16x16x32_bf16 v[212:215], a[148:151], v[64:67], v[212:215]
    v_exp_f32 v59, v59
    v_mfma_f32_16x16x32_bf16 v[216:219], a[152:155], v[64:67], v[216:219]
    buffer_store_dwordx4 v[132:135], v109, s[24:27], 0 offen offset:1024 sc1
    v_exp_f32 v60, v60
    v_cvt_pk_bf16_f32 v77, v58, v59
    v_mfma_f32_16x16x32_bf16 v[216:219], a[184:187], v[68:71], v[216:219]
    v_exp_f32 v61, v61
    v_mfma_f32_16x16x32_bf16 v[220:223], a[188:191], v[68:71], v[220:223]
    buffer_store_dwordx4 v[136:139], v109, s[24:27], 0 offen offset:2048 sc1
    v_exp_f32 v62, v62
    v_cvt_pk_bf16_f32 v78, v60, v61
    v_mfma_f32_16x16x32_bf16 v[220:223], a[156:159], v[64:67], v[220:223]
    v_exp_f32 v63, v63
    v_smfmac_f32_16x16x64_bf16 a[200:203], a[208:211], v[64:71], v111
    buffer_store_dwordx4 v[140:143], v109, s[24:27], 0 offen offset:3072 sc1
    v_cvt_pk_bf16_f32 v79, v62, v63
    s_nop 1
    v_mfma_f32_16x16x32_bf16 v[224:227], a[128:131], v[72:75], v[224:227]
    v_cvt_pk_bf16_f32 v112, v160, v161
    v_mfma_f32_16x16x32_bf16 v[224:227], a[160:163], v[76:79], v[224:227]
    v_cvt_pk_bf16_f32 v113, v162, v163
    v_mfma_f32_16x16x32_bf16 v[228:231], a[164:167], v[76:79], v[228:231]
    ds_write_b64 v26, v[112:113] offset:16384
    v_cvt_pk_bf16_f32 v114, v164, v165
    v_mfma_f32_16x16x32_bf16 v[228:231], a[132:135], v[72:75], v[228:231]
    v_cvt_pk_bf16_f32 v115, v166, v167
    v_mfma_f32_16x16x32_bf16 v[232:235], a[136:139], v[72:75], v[232:235]
    ds_write_b64 v27, v[114:115] offset:16384
    v_cvt_pk_bf16_f32 v116, v168, v169
    v_mfma_f32_16x16x32_bf16 v[232:235], a[168:171], v[76:79], v[232:235]
    v_cvt_pk_bf16_f32 v117, v170, v171
    v_mfma_f32_16x16x32_bf16 v[236:239], a[172:175], v[76:79], v[236:239]
    ds_write_b64 v28, v[116:117] offset:16384
    v_cvt_pk_bf16_f32 v118, v172, v173
    v_mfma_f32_16x16x32_bf16 v[236:239], a[140:143], v[72:75], v[236:239]
    v_cvt_pk_bf16_f32 v119, v174, v175
    v_mfma_f32_16x16x32_bf16 v[240:243], a[144:147], v[72:75], v[240:243]
    ds_write_b64 v29, v[118:119] offset:16384
    v_cvt_pk_bf16_f32 v120, v176, v177
    v_mfma_f32_16x16x32_bf16 v[240:243], a[176:179], v[76:79], v[240:243]
    v_cvt_pk_bf16_f32 v121, v178, v179
    v_mfma_f32_16x16x32_bf16 v[244:247], a[180:183], v[76:79], v[244:247]
    ds_write_b64 v30, v[120:121] offset:16384
    v_cvt_pk_bf16_f32 v122, v180, v181
    v_mfma_f32_16x16x32_bf16 v[244:247], a[148:151], v[72:75], v[244:247]
    v_cvt_pk_bf16_f32 v123, v182, v183
    v_mfma_f32_16x16x32_bf16 v[248:251], a[152:155], v[72:75], v[248:251]
    ds_write_b64 v31, v[122:123] offset:16384
    v_cvt_pk_bf16_f32 v124, v184, v185
    v_mfma_f32_16x16x32_bf16 v[248:251], a[184:187], v[76:79], v[248:251]
    v_cvt_pk_bf16_f32 v125, v186, v187
    v_mfma_f32_16x16x32_bf16 v[252:255], a[188:191], v[76:79], v[252:255]
    ds_write_b64 v19, v[124:125] offset:16384
    v_cvt_pk_bf16_f32 v126, v188, v189
    v_mfma_f32_16x16x32_bf16 v[252:255], a[156:159], v[72:75], v[252:255]
    v_cvt_pk_bf16_f32 v127, v190, v191
    v_smfmac_f32_16x16x64_bf16 a[204:207], a[208:211], v[72:79], v111
    ds_write_b64 v108, v[126:127] offset:16384
    s_waitcnt lgkmcnt(0)
    ds_read_b128 v[160:163], v100 offset:16384
    ds_read_b128 v[164:167], v101 offset:17408
    ds_read_b128 v[168:171], v102 offset:18432
    ds_read_b128 v[172:175], v103 offset:19456
    v_accvgpr_read_b32 v106, a200
    v_accvgpr_read_b32 v20, a201
    v_add_f32 v106, v106, v20
    v_rcp_f32 v20, v106
    s_nop 0
    v_pk_mul_f32 v[192:193], v[192:193], v[20:21] op_sel_hi:[1,0]
    v_pk_mul_f32 v[194:195], v[194:195], v[20:21] op_sel_hi:[1,0]
    v_pk_mul_f32 v[196:197], v[196:197], v[20:21] op_sel_hi:[1,0]
    v_pk_mul_f32 v[198:199], v[198:199], v[20:21] op_sel_hi:[1,0]
    v_pk_mul_f32 v[200:201], v[200:201], v[20:21] op_sel_hi:[1,0]
    v_pk_mul_f32 v[202:203], v[202:203], v[20:21] op_sel_hi:[1,0]
    v_pk_mul_f32 v[204:205], v[204:205], v[20:21] op_sel_hi:[1,0]
    v_pk_mul_f32 v[206:207], v[206:207], v[20:21] op_sel_hi:[1,0]
    s_waitcnt lgkmcnt(0)
    v_pk_mul_f32 v[208:209], v[208:209], v[20:21] op_sel_hi:[1,0]
    v_pk_mul_f32 v[210:211], v[210:211], v[20:21] op_sel_hi:[1,0]
    buffer_store_dwordx4 v[160:163], v109, s[24:27], s8 offen offset:0 sc1
    v_pk_mul_f32 v[212:213], v[212:213], v[20:21] op_sel_hi:[1,0]
    v_pk_mul_f32 v[214:215], v[214:215], v[20:21] op_sel_hi:[1,0]
    buffer_store_dwordx4 v[164:167], v109, s[24:27], s8 offen offset:1024 sc1
    v_pk_mul_f32 v[216:217], v[216:217], v[20:21] op_sel_hi:[1,0]
    v_pk_mul_f32 v[218:219], v[218:219], v[20:21] op_sel_hi:[1,0]
    buffer_store_dwordx4 v[168:171], v109, s[24:27], s8 offen offset:2048 sc1
    v_pk_mul_f32 v[220:221], v[220:221], v[20:21] op_sel_hi:[1,0]
    v_pk_mul_f32 v[222:223], v[222:223], v[20:21] op_sel_hi:[1,0]
    buffer_store_dwordx4 v[172:175], v109, s[24:27], s8 offen offset:3072 sc1
    v_cvt_pk_bf16_f32 v112, v192, v193
    v_cvt_pk_bf16_f32 v113, v194, v195
    ds_write_b64 v26, v[112:113] offset:32768
    v_cvt_pk_bf16_f32 v114, v196, v197
    v_cvt_pk_bf16_f32 v115, v198, v199
    ds_write_b64 v27, v[114:115] offset:32768
    v_cvt_pk_bf16_f32 v116, v200, v201
    v_cvt_pk_bf16_f32 v117, v202, v203
    ds_write_b64 v28, v[116:117] offset:32768
    v_cvt_pk_bf16_f32 v118, v204, v205
    v_cvt_pk_bf16_f32 v119, v206, v207
    ds_write_b64 v29, v[118:119] offset:32768
    v_cvt_pk_bf16_f32 v120, v208, v209
    v_cvt_pk_bf16_f32 v121, v210, v211
    ds_write_b64 v30, v[120:121] offset:32768
    v_cvt_pk_bf16_f32 v122, v212, v213
    v_cvt_pk_bf16_f32 v123, v214, v215
    ds_write_b64 v31, v[122:123] offset:32768
    v_cvt_pk_bf16_f32 v124, v216, v217
    v_cvt_pk_bf16_f32 v125, v218, v219
    ds_write_b64 v19, v[124:125] offset:32768
    v_cvt_pk_bf16_f32 v126, v220, v221
    v_cvt_pk_bf16_f32 v127, v222, v223
    ds_write_b64 v108, v[126:127] offset:32768
    s_waitcnt lgkmcnt(0)
    ds_read_b128 v[192:195], v100 offset:32768
    ds_read_b128 v[196:199], v101 offset:33792
    ds_read_b128 v[200:203], v102 offset:34816
    ds_read_b128 v[204:207], v103 offset:35840
    v_accvgpr_read_b32 v107, a204
    v_accvgpr_read_b32 v22, a205
    v_add_f32 v107, v107, v22
    v_rcp_f32 v22, v107
    s_nop 0
    v_pk_mul_f32 v[224:225], v[224:225], v[22:23] op_sel_hi:[1,0]
    v_pk_mul_f32 v[226:227], v[226:227], v[22:23] op_sel_hi:[1,0]
    v_pk_mul_f32 v[228:229], v[228:229], v[22:23] op_sel_hi:[1,0]
    v_pk_mul_f32 v[230:231], v[230:231], v[22:23] op_sel_hi:[1,0]
    v_pk_mul_f32 v[232:233], v[232:233], v[22:23] op_sel_hi:[1,0]
    v_pk_mul_f32 v[234:235], v[234:235], v[22:23] op_sel_hi:[1,0]
    v_pk_mul_f32 v[236:237], v[236:237], v[22:23] op_sel_hi:[1,0]
    v_pk_mul_f32 v[238:239], v[238:239], v[22:23] op_sel_hi:[1,0]
    s_waitcnt lgkmcnt(0)
    v_pk_mul_f32 v[240:241], v[240:241], v[22:23] op_sel_hi:[1,0]
    v_pk_mul_f32 v[242:243], v[242:243], v[22:23] op_sel_hi:[1,0]
    buffer_store_dwordx4 v[192:195], v109, s[24:27], s9 offen offset:0 sc1
    v_pk_mul_f32 v[244:245], v[244:245], v[22:23] op_sel_hi:[1,0]
    v_pk_mul_f32 v[246:247], v[246:247], v[22:23] op_sel_hi:[1,0]
    buffer_store_dwordx4 v[196:199], v109, s[24:27], s9 offen offset:1024 sc1
    v_pk_mul_f32 v[248:249], v[248:249], v[22:23] op_sel_hi:[1,0]
    v_pk_mul_f32 v[250:251], v[250:251], v[22:23] op_sel_hi:[1,0]
    buffer_store_dwordx4 v[200:203], v109, s[24:27], s9 offen offset:2048 sc1
    v_pk_mul_f32 v[252:253], v[252:253], v[22:23] op_sel_hi:[1,0]
    v_pk_mul_f32 v[254:255], v[254:255], v[22:23] op_sel_hi:[1,0]
    buffer_store_dwordx4 v[204:207], v109, s[24:27], s9 offen offset:3072 sc1
    v_cvt_pk_bf16_f32 v112, v224, v225
    v_cvt_pk_bf16_f32 v113, v226, v227
    ds_write_b64 v26, v[112:113] offset:49152
    v_cvt_pk_bf16_f32 v114, v228, v229
    v_cvt_pk_bf16_f32 v115, v230, v231
    ds_write_b64 v27, v[114:115] offset:49152
    v_cvt_pk_bf16_f32 v116, v232, v233
    v_cvt_pk_bf16_f32 v117, v234, v235
    ds_write_b64 v28, v[116:117] offset:49152
    v_cvt_pk_bf16_f32 v118, v236, v237
    v_cvt_pk_bf16_f32 v119, v238, v239
    ds_write_b64 v29, v[118:119] offset:49152
    v_cvt_pk_bf16_f32 v120, v240, v241
    v_cvt_pk_bf16_f32 v121, v242, v243
    ds_write_b64 v30, v[120:121] offset:49152
    v_cvt_pk_bf16_f32 v122, v244, v245
    v_cvt_pk_bf16_f32 v123, v246, v247
    ds_write_b64 v31, v[122:123] offset:49152
    v_cvt_pk_bf16_f32 v124, v248, v249
    v_cvt_pk_bf16_f32 v125, v250, v251
    ds_write_b64 v19, v[124:125] offset:49152
    v_cvt_pk_bf16_f32 v126, v252, v253
    v_cvt_pk_bf16_f32 v127, v254, v255
    ds_write_b64 v108, v[126:127] offset:49152
    v_add_f32 v21, v104, v105
    v_add_f32 v21, v21, v106
    v_add_f32 v21, v21, v107
    s_waitcnt lgkmcnt(0)
    ds_read_b128 v[224:227], v100 offset:49152
    ds_read_b128 v[228:231], v101 offset:50176
    ds_read_b128 v[232:235], v102 offset:51200
    ds_read_b128 v[236:239], v103 offset:52224
    v_cmp_nlt_f32 vcc, v21, s35
    s_waitcnt lgkmcnt(0)
    buffer_store_dwordx4 v[224:227], v109, s[24:27], s10 offen offset:0 sc1
    buffer_store_dwordx4 v[228:231], v109, s[24:27], s10 offen offset:1024 sc1
    buffer_store_dwordx4 v[232:235], v109, s[24:27], s10 offen offset:2048 sc1
    buffer_store_dwordx4 v[236:239], v109, s[24:27], s10 offen offset:3072 sc1
    s_cbranch_vccnz S_slow4
L_fin4:
    s_endpgm
Z_E4:
.p2align 6
T_B4O:
    s_branch L_backE
    s_nop 0
S_B4O:
    s_waitcnt vmcnt(12)
    ds_read_b128 v[112:115], v100 offset:32768
    ds_read_b128 v[116:119], v101 offset:32768
    ds_read_b128 v[120:123], v102 offset:32768
    ds_read_b128 v[124:127], v103 offset:32768
    v_max3_f32 v24, v32, v33, v34
    v_max3_f32 v25, v35, v36, v37
    v_max3_f32 v24, v24, v38, v39
    v_max3_f32 v25, v25, v40, v41
    v_max3_f32 v24, v24, v42, v43
    v_max3_f32 v25, v25, v44, v45
    v_max3_f32 v24, v24, v46, v47
    v_max_f32 v24, v24, v25
    v_mov_b32 v25, v24
    s_nop 1
    v_permlane32_swap_b32 v24, v25
    v_max_f32 v24, v24, v25
    v_mov_b32 v25, v24
    s_nop 1
    v_permlane16_swap_b32 v24, v25
    v_max_f32 v24, v24, v25
    v_sub_f32 v32, v32, v24
    v_sub_f32 v33, v33, v24
    v_sub_f32 v34, v34, v24
    v_sub_f32 v35, v35, v24
    v_sub_f32 v36, v36, v24
    v_sub_f32 v37, v37, v24
    v_sub_f32 v38, v38, v24
    v_sub_f32 v39, v39, v24
    v_sub_f32 v40, v40, v24
    v_sub_f32 v41, v41, v24
    v_sub_f32 v42, v42, v24
    v_sub_f32 v43, v43, v24
    v_sub_f32 v44, v44, v24
    v_sub_f32 v45, v45, v24
    v_sub_f32 v46, v46, v24
    v_sub_f32 v47, v47, v24
    v_sub_f32 v88, 0, v24
    v_sub_f32 v89, 0, v24
    v_sub_f32 v90, 0, v24
    v_sub_f32 v91, 0, v24
    s_waitcnt lgkmcnt(3)
    v_mfma_f32_16x16x32_bf16 v[160:163], a[128:131], v[72:75], v[160:163]
    v_lshlrev_b32 v20, 16, v112
    v_and_b32 v21, s31, v112
    v_lshlrev_b32 v22, 16, v113
    v_and_b32 v23, s31, v113
    v_mul_f32 v20, s34, v20
    v_mul_f32 v21, s34, v21
    v_mfma_f32_16x16x32_bf16 v[160:163], a[160:163], v[76:79], v[160:163]
    v_mul_f32 v22, s34, v22
    v_mul_f32 v23, s34, v23
    v_cvt_pk_bf16_f32 v20, v20, v21
    v_cvt_pk_bf16_f32 v22, v22, v23
    v_accvgpr_write_b32 a48, v20
    v_accvgpr_write_b32 a49, v22
    v_mfma_f32_16x16x32_bf16 v[164:167], a[164:167], v[76:79], v[164:167]
    v_lshlrev_b32 v20, 16, v114
    v_and_b32 v21, s31, v114
    v_lshlrev_b32 v22, 16, v115
    v_and_b32 v23, s31, v115
    v_mul_f32 v20, s34, v20
    v_mul_f32 v21, s34, v21
    v_mfma_f32_16x16x32_bf16 v[164:167], a[132:135], v[72:75], v[164:167]
    v_mul_f32 v22, s34, v22
    v_mul_f32 v23, s34, v23
    v_cvt_pk_bf16_f32 v20, v20, v21
    v_cvt_pk_bf16_f32 v22, v22, v23
    v_accvgpr_write_b32 a50, v20
    v_accvgpr_write_b32 a51, v22
    s_waitcnt lgkmcnt(2)
    v_mfma_f32_16x16x32_bf16 v[168:171], a[136:139], v[72:75], v[168:171]
    v_lshlrev_b32 v20, 16, v116
    v_and_b32 v21, s31, v116
    v_lshlrev_b32 v22, 16, v117
    v_and_b32 v23, s31, v117
    v_mul_f32 v20, s34, v20
    v_mul_f32 v21, s34, v21
    v_mfma_f32_16x16x32_bf16 v[168:171], a[168:171], v[76:79], v[168:171]
    v_mul_f32 v22, s34, v22
    v_mul_f32 v23, s34, v23
    v_cvt_pk_bf16_f32 v20, v20, v21
    v_cvt_pk_bf16_f32 v22, v22, v23
    v_accvgpr_write_b32 a52, v20
    v_accvgpr_write_b32 a53, v22
    v_mfma_f32_16x16x32_bf16 v[172:175], a[172:175], v[76:79], v[172:175]
    v_lshlrev_b32 v20, 16, v118
    v_and_b32 v21, s31, v118
    v_lshlrev_b32 v22, 16, v119
    v_and_b32 v23, s31, v119
    v_mul_f32 v20, s34, v20
    v_mul_f32 v21, s34, v21
    v_mfma_f32_16x16x32_bf16 v[172:175], a[140:143], v[72:75], v[172:175]
    v_mul_f32 v22, s34, v22
    v_mul_f32 v23, s34, v23
    v_cvt_pk_bf16_f32 v20, v20, v21
    v_cvt_pk_bf16_f32 v22, v22, v23
    v_mfma_f32_16x16x32_bf16 v[176:179], a[144:147], v[72:75], v[176:179]
    v_accvgpr_write_b32 a54, v20
    v_accvgpr_write_b32 a55, v22
    s_waitcnt lgkmcnt(1)
    v_mfma_f32_16x16x32_bf16 v[176:179], a[176:179], v[76:79], v[176:179]
    v_lshlrev_b32 v20, 16, v120
    v_and_b32 v21, s31, v120
    v_lshlrev_b32 v22, 16, v121
    v_and_b32 v23, s31, v121
    v_mul_f32 v20, s34, v20
    v_mul_f32 v21, s34, v21
    v_mfma_f32_16x16x32_bf16 v[180:183], a[180:183], v[76:79], v[180:183]
    v_mul_f32 v22, s34, v22
    v_mul_f32 v23, s34, v23
    v_cvt_pk_bf16_f32 v20, v20, v21
    v_cvt_pk_bf16_f32 v22, v22, v23
    v_accvgpr_write_b32 a56, v20
    v_accvgpr_write_b32 a57, v22
    v_mfma_f32_16x16x32_bf16 v[180:183], a[148:151], v[72:75], v[180:183]
    v_lshlrev_b32 v20, 16, v122
    v_and_b32 v21, s31, v122
    v_lshlrev_b32 v22, 16, v123
    v_and_b32 v23, s31, v123
    v_mul_f32 v20, s34, v20
    v_mul_f32 v21, s34, v21
    v_mfma_f32_16x16x32_bf16 v[184:187], a[152:155], v[72:75], v[184:187]
    v_mul_f32 v22, s34, v22
    v_mul_f32 v23, s34, v23
    v_cvt_pk_bf16_f32 v20, v20, v21
    v_cvt_pk_bf16_f32 v22, v22, v23
    v_accvgpr_write_b32 a58, v20
    v_accvgpr_write_b32 a59, v22
    s_waitcnt lgkmcnt(0)
    s_add_u32 m0, s30, 114688
    s_nop 0
    buffer_load_dwordx4 v16, s[16:19], s32 offen offset:0 nt lds
    buffer_load_dwordx4 v17, s[16:19], s32 offen offset:1024 nt lds
    buffer_load_dwordx4 v16, s[16:19], s32 offen offset:2048 nt lds
    buffer_load_dwordx4 v17, s[16:19], s32 offen offset:3072 nt lds
    s_or_b32 s32, s32, 98304
    s_add_u32 s32, s32, 4096
    s_andn2_b32 s32, s32, 98304
    v_mfma_f32_16x16x32_bf16 v[184:187], a[184:187], v[76:79], v[184:187]
    v_lshlrev_b32 v20, 16, v124
    v_and_b32 v21, s31, v124
    v_lshlrev_b32 v22, 16, v125
    v_and_b32 v23, s31, v125
    v_mul_f32 v20, s34, v20
    v_mul_f32 v21, s34, v21
    v_mfma_f32_16x16x32_bf16 v[188:191], a[188:191], v[76:79], v[188:191]
    v_mul_f32 v22, s34, v22
    v_mul_f32 v23, s34, v23
    v_cvt_pk_bf16_f32 v20, v20, v21
    v_cvt_pk_bf16_f32 v22, v22, v23
    v_accvgpr_write_b32 a60, v20
    v_accvgpr_write_b32 a61, v22
    v_mfma_f32_16x16x32_bf16 v[188:191], a[156:159], v[72:75], v[188:191]
    v_lshlrev_b32 v20, 16, v126
    v_and_b32 v21, s31, v126
    v_lshlrev_b32 v22, 16, v127
    v_and_b32 v23, s31, v127
    v_mul_f32 v20, s34, v20
    v_mul_f32 v21, s34, v21
    v_smfmac_f32_16x16x64_bf16 a[196:199], a[208:211], v[72:79], v111
    v_mul_f32 v22, s34, v22
    v_mul_f32 v23, s34, v23
    v_cvt_pk_bf16_f32 v20, v20, v21
    v_cvt_pk_bf16_f32 v22, v22, v23
    v_accvgpr_write_b32 a62, v20
    v_accvgpr_write_b32 a63, v22
    s_nop 1
    v_mfma_f32_16x16x32_bf16 v[48:51], a[64:67], a[48:51], 0
    v_exp_f32 v32, v32
    v_mfma_f32_16x16x32_bf16 v[48:51], a[68:71], a[52:55], v[48:51]
    v_exp_f32 v33, v33
    v_mfma_f32_16x16x32_bf16 v[48:51], a[72:75], a[56:59], v[48:51]
    v_exp_f32 v34, v34
    v_cvt_pk_bf16_f32 v64, v32, v33
    v_mfma_f32_16x16x32_bf16 v[48:51], a[76:79], a[60:63], v[48:51]
    v_exp_f32 v35, v35
    v_mfma_f32_16x16x32_bf16 v[52:55], a[92:95], a[60:63], 0
    v_exp_f32 v36, v36
    v_cvt_pk_bf16_f32 v65, v34, v35
    v_mfma_f32_16x16x32_bf16 v[52:55], a[88:91], a[56:59], v[52:55]
    v_exp_f32 v37, v37
    v_mfma_f32_16x16x32_bf16 v[52:55], a[84:87], a[52:55], v[52:55]
    v_exp_f32 v38, v38
    v_cvt_pk_bf16_f32 v66, v36, v37
    v_mfma_f32_16x16x32_bf16 v[52:55], a[80:83], a[48:51], v[52:55]
    v_exp_f32 v39, v39
    v_mfma_f32_16x16x32_bf16 v[56:59], a[96:99], a[48:51], 0
    v_exp_f32 v40, v40
    v_cvt_pk_bf16_f32 v67, v38, v39
    v_mfma_f32_16x16x32_bf16 v[56:59], a[100:103], a[52:55], v[56:59]
    v_exp_f32 v41, v41
    v_mfma_f32_16x16x32_bf16 v[56:59], a[104:107], a[56:59], v[56:59]
    v_exp_f32 v42, v42
    v_cvt_pk_bf16_f32 v68, v40, v41
    v_mfma_f32_16x16x32_bf16 v[56:59], a[108:111], a[60:63], v[56:59]
    v_exp_f32 v43, v43
    v_mfma_f32_16x16x32_bf16 v[60:63], a[124:127], a[60:63], 0
    v_exp_f32 v44, v44
    v_cvt_pk_bf16_f32 v69, v42, v43
    v_mfma_f32_16x16x32_bf16 v[60:63], a[120:123], a[56:59], v[60:63]
    v_exp_f32 v45, v45
    v_mfma_f32_16x16x32_bf16 v[60:63], a[116:119], a[52:55], v[60:63]
    v_exp_f32 v46, v46
    v_cvt_pk_bf16_f32 v70, v44, v45
    v_mfma_f32_16x16x32_bf16 v[60:63], a[112:115], a[48:51], v[60:63]
    v_exp_f32 v47, v47
    s_nop 0
    v_cvt_pk_bf16_f32 v71, v46, v47
    s_waitcnt vmcnt(12)
    s_barrier
    ds_read_b128 a[64:67], v0 offset:16384
    ds_read_b128 a[68:71], v1 offset:16384
    ds_read_b128 a[72:75], v2 offset:16384
    ds_read_b128 a[76:79], v3 offset:16384
    ds_read_b128 a[80:83], v0 offset:20480
    ds_read_b128 a[84:87], v1 offset:20480
    ds_read_b128 a[88:91], v2 offset:20480
    ds_read_b128 a[92:95], v3 offset:20480
    ds_read_b128 a[96:99], v0 offset:24576
    ds_read_b128 a[100:103], v1 offset:24576
    ds_read_b128 a[104:107], v2 offset:24576
    ds_read_b128 a[108:111], v3 offset:24576
    ds_read_b128 a[112:115], v0 offset:28672
    ds_read_b128 a[116:119], v1 offset:28672
    ds_read_b128 a[120:123], v2 offset:28672
    ds_read_b128 a[124:127], v3 offset:28672
    s_add_u32 m0, s30, 32768
    s_nop 0
    buffer_load_dwordx4 v12, s[12:15], s32 offen offset:0 nt lds
    buffer_load_dwordx4 v13, s[12:15], s32 offen offset:1024 nt lds
    buffer_load_dwordx4 v14, s[12:15], s32 offen offset:2048 nt lds
    buffer_load_dwordx4 v15, s[12:15], s32 offen offset:3072 nt lds
    v_max3_f32 v24, v48, v49, v50
    v_max3_f32 v25, v51, v52, v53
    v_max3_f32 v24, v24, v54, v55
    v_max3_f32 v25, v25, v56, v57
    v_max3_f32 v24, v24, v58, v59
    v_max3_f32 v25, v25, v60, v61
    v_max3_f32 v24, v24, v62, v63
    v_max_f32 v24, v24, v25
    v_mov_b32 v25, v24
    s_nop 1
    v_permlane32_swap_b32 v24, v25
    v_max_f32 v24, v24, v25
    v_mov_b32 v25, v24
    s_nop 1
    v_permlane16_swap_b32 v24, v25
    v_max_f32 v24, v24, v25
    v_sub_f32 v48, v48, v24
    v_sub_f32 v49, v49, v24
    v_sub_f32 v50, v50, v24
    v_sub_f32 v51, v51, v24
    v_sub_f32 v52, v52, v24
    v_sub_f32 v53, v53, v24
    v_sub_f32 v54, v54, v24
    v_sub_f32 v55, v55, v24
    v_sub_f32 v56, v56, v24
    v_sub_f32 v57, v57, v24
    v_sub_f32 v58, v58, v24
    v_sub_f32 v59, v59, v24
    v_sub_f32 v60, v60, v24
    v_sub_f32 v61, v61, v24
    v_sub_f32 v62, v62, v24
    v_sub_f32 v63, v63, v24
    v_sub_f32 v92, 0, v24
    v_sub_f32 v93, 0, v24
    v_sub_f32 v94, 0, v24
    v_sub_f32 v95, 0, v24
    s_add_u32 m0, s30, 98304
    s_nop 0
    buffer_load_dwordx4 v16, s[16:19], s32 offen offset:0 nt lds
    buffer_load_dwordx4 v17, s[16:19], s32 offen offset:1024 nt lds
    buffer_load_dwordx4 v16, s[16:19], s32 offen offset:2048 nt lds
    buffer_load_dwordx4 v17, s[16:19], s32 offen offset:3072 nt lds
    s_or_b32 s32, s32, 98304
    s_add_u32 s32, s32, 4096
    s_andn2_b32 s32, s32, 98304
    s_add_u32 m0, s30, 0
    s_nop 0
    buffer_load_dwordx4 v12, s[12:15], s32 offen offset:0 nt lds
    buffer_load_dwordx4 v13, s[12:15], s32 offen offset:1024 nt lds
    buffer_load_dwordx4 v14, s[12:15], s32 offen offset:2048 nt lds
    buffer_load_dwordx4 v15, s[12:15], s32 offen offset:3072 nt lds
    s_sub_u32 s28, s30, s37
    v_add_u32 v100, s28, v12
    v_add_u32 v101, s28, v13
    v_add_u32 v102, s28, v14
    v_add_u32 v103, s28, v15
    v_xor_b32 v0, 16384, v0
    v_xor_b32 v1, 16384, v1
    v_xor_b32 v2, 16384, v2
    v_xor_b32 v3, 16384, v3
    s_waitcnt lgkmcnt(0)
    s_branch S_W4
Z_B4O:
.p2align 12
T_B3O:
    s_branch L_backE
    s_nop 0
S_B3O:
    s_waitcnt vmcnt(12)
    ds_read_b128 v[112:115], v96 offset:32768
    ds_read_b128 v[116:119], v97 offset:32768
    ds_read_b128 v[120:123], v98 offset:32768
    ds_read_b128 v[124:127], v99 offset:32768
    v_max3_f32 v24, v48, v49, v50
    v_max3_f32 v25, v51, v52, v53
    v_max3_f32 v24, v24, v54, v55
    v_max3_f32 v25, v25, v56, v57
    v_max3_f32 v24, v24, v58, v59
    v_max3_f32 v25, v25, v60, v61
    v_max3_f32 v24, v24, v62, v63
    v_max_f32 v24, v24, v25
    v_mov_b32 v25, v24
    s_nop 1
    v_permlane32_swap_b32 v24, v25
    v_max_f32 v24, v24, v25
    v_mov_b32 v25, v24
    s_nop 1
    v_permlane16_swap_b32 v24, v25
    v_max_f32 v24, v24, v25
    v_sub_f32 v48, v48, v24
    v_sub_f32 v49, v49, v24
    v_sub_f32 v50, v50, v24
    v_sub_f32 v51, v51, v24
    v_sub_f32 v52, v52, v24
    v_sub_f32 v53, v53, v24
    v_sub_f32 v54, v54, v24
    v_sub_f32 v55, v55, v24
    v_sub_f32 v56, v56, v24
    v_sub_f32 v57, v57, v24
    v_sub_f32 v58, v58, v24
    v_sub_f32 v59, v59, v24
    v_sub_f32 v60, v60, v24
    v_sub_f32 v61, v61, v24
    v_sub_f32 v62, v62, v24
    v_sub_f32 v63, v63, v24
    v_sub_f32 v84, 0, v24
    v_sub_f32 v85, 0, v24
    v_sub_f32 v86, 0, v24
    v_sub_f32 v87, 0, v24
    s_waitcnt lgkmcnt(3)
    v_mfma_f32_16x16x32_bf16 v[128:131], a[128:131], v[64:67], v[128:131]
    v_lshlrev_b32 v20, 16, v112
    v_and_b32 v21, s31, v112
    v_lshlrev_b32 v22, 16, v113
    v_and_b32 v23, s31, v113
    v_mul_f32 v20, s34, v20
    v_mul_f32 v21, s34, v21
    v_mfma_f32_16x16x32_bf16 v[128:131], a[160:163], v[68:71], v[128:131]
    v_mul_f32 v22, s34, v22
    v_mul_f32 v23, s34, v23
    v_cvt_pk_bf16_f32 v20, v20, v21
    v_cvt_pk_bf16_f32 v22, v22, v23
    v_accvgpr_write_b32 a32, v20
    v_accvgpr_write_b32 a33, v22
    v_mfma_f32_16x16x32_bf16 v[132:135], a[164:167], v[68:71], v[132:135]
    v_lshlrev_b32 v20, 16, v114
    v_and_b32 v21, s31, v114
    v_lshlrev_b32 v22, 16, v115
    v_and_b32 v23, s31, v115
    v_mul_f32 v20, s34, v20
    v_mul_f32 v21, s34, v21
    v_mfma_f32_16x16x32_bf16 v[132:135], a[132:135], v[64:67], v[132:135]
    v_mul_f32 v22, s34, v22
    v_mul_f32 v23, s34, v23
    v_cvt_pk_bf16_f32 v20, v20, v21
    v_cvt_pk_bf16_f32 v22, v22, v23
    v_accvgpr_write_b32 a34, v20
    v_accvgpr_write_b32 a35, v22
    s_waitcnt lgkmcnt(2)
    v_mfma_f32_16x16x32_bf16 v[136:139], a[136:139], v[64:67], v[136:139]
    v_lshlrev_b32 v20, 16, v116
    v_and_b32 v21, s31, v116
    v_lshlrev_b32 v22, 16, v117
    v_and_b32 v23, s31, v117
    v_mul_f32 v20, s34, v20
    v_mul_f32 v21, s34, v21
    v_mfma_f32_16x16x32_bf16 v[136:139], a[168:171], v[68:71], v[136:139]
    v_mul_f32 v22, s34, v22
    v_mul_f32 v23, s34, v23
    v_cvt_pk_bf16_f32 v20, v20, v21
    v_cvt_pk_bf16_f32 v22, v22, v23
    v_accvgpr_write_b32 a36, v20
    v_accvgpr_write_b32 a37, v22
    v_mfma_f32_16x16x32_bf16 v[140:143], a[172:175], v[68:71], v[140:143]
    v_lshlrev_b32 v20, 16, v118
    v_and_b32 v21, s31, v118
    v_lshlrev_b32 v22, 16, v119
    v_and_b32 v23, s31, v119
    v_mul_f32 v20, s34, v20
    v_mul_f32 v21, s34, v21
    v_mfma_f32_16x16x32_bf16 v[140:143], a[140:143], v[64:67], v[140:143]
    v_mul_f32 v22, s34, v22
    v_mul_f32 v23, s34, v23
    v_cvt_pk_bf16_f32 v20, v20, v21
    v_cvt_pk_bf16_f32 v22, v22, v23
    v_mfma_f32_16x16x32_bf16 v[144:147], a[144:147], v[64:67], v[144:147]
    v_accvgpr_write_b32 a38, v20
    v_accvgpr_write_b32 a39, v22
    s_waitcnt lgkmcnt(1)
    v_mfma_f32_16x16x32_bf16 v[144:147], a[176:179], v[68:71], v[144:147]
    v_lshlrev_b32 v20, 16, v120
    v_and_b32 v21, s31, v120
    v_lshlrev_b32 v22, 16, v121
    v_and_b32 v23, s31, v121
    v_mul_f32 v20, s34, v20
    v_mul_f32 v21, s34, v21
    v_mfma_f32_16x16x32_bf16 v[148:151], a[180:183], v[68:71], v[148:151]
    v_mul_f32 v22, s34, v22
    v_mul_f32 v23, s34, v23
    v_cvt_pk_bf16_f32 v20, v20, v21
    v_cvt_pk_bf16_f32 v22, v22, v23
    v_accvgpr_write_b32 a40, v20
    v_accvgpr_write_b32 a41, v22
    v_mfma_f32_16x16x32_bf16 v[148:151], a[148:151], v[64:67], v[148:151]
    v_lshlrev_b32 v20, 16, v122
    v_and_b32 v21, s31, v122
    v_lshlrev_b32 v22, 16, v123
    v_and_b32 v23, s31, v123
    v_mul_f32 v20, s34, v20
    v_mul_f32 v21, s34, v21
    v_mfma_f32_16x16x32_bf16 v[152:155], a[152:155], v[64:67], v[152:155]
    v_mul_f32 v22, s34, v22
    v_mul_f32 v23, s34, v23
    v_cvt_pk_bf16_f32 v20, v20, v21
    v_cvt_pk_bf16_f32 v22, v22, v23
    v_accvgpr_write_b32 a42, v20
    v_accvgpr_write_b32 a43, v22
    s_waitcnt lgkmcnt(0)
    s_add_u32 m0, s30, 114688
    s_nop 0
    buffer_load_dwordx4 v16, s[16:19], s32 offen offset:0 nt lds
    buffer_load_dwordx4 v17, s[16:19], s32 offen offset:1024 nt lds
    buffer_load_dwordx4 v16, s[16:19], s32 offen offset:2048 nt lds
    buffer_load_dwordx4 v17, s[16:19], s32 offen offset:3072 nt lds
    s_or_b32 s32, s32, 98304
    s_add_u32 s32, s32, 4096
    s_andn2_b32 s32, s32, 98304
    v_mfma_f32_16x16x32_bf16 v[152:155], a[184:187], v[68:71], v[152:155]
    v_lshlrev_b32 v20, 16, v124
    v_and_b32 v21, s31, v124
    v_lshlrev_b32 v22, 16, v125
    v_and_b32 v23, s31, v125
    v_mul_f32 v20, s34, v20
    v_mul_f32 v21, s34, v21
    v_mfma_f32_16x16x32_bf16 v[156:159], a[188:191], v[68:71], v[156:159]
    v_mul_f32 v22, s34, v22
    v_mul_f32 v23, s34, v23
    v_cvt_pk_bf16_f32 v20, v20, v21
    v_cvt_pk_bf16_f32 v22, v22, v23
    v_accvgpr_write_b32 a44, v20
    v_accvgpr_write_b32 a45, v22
    v_mfma_f32_16x16x32_bf16 v[156:159], a[156:159], v[64:67], v[156:159]
    v_lshlrev_b32 v20, 16, v126
    v_and_b32 v21, s31, v126
    v_lshlrev_b32 v22, 16, v127
    v_and_b32 v23, s31, v127
    v_mul_f32 v20, s34, v20
    v_mul_f32 v21, s34, v21
    v_smfmac_f32_16x16x64_bf16 a[192:195], a[208:211], v[64:71], v111
    v_mul_f32 v22, s34, v22
    v_mul_f32 v23, s34, v23
    v_cvt_pk_bf16_f32 v20, v20, v21
    v_cvt_pk_bf16_f32 v22, v22, v23
    v_accvgpr_write_b32 a46, v20
    v_accvgpr_write_b32 a47, v22
    s_nop 1
    v_mfma_f32_16x16x32_bf16 v[224:227], a[64:67], a[32:35], 0
    v_exp_f32 v48, v48
    v_mfma_f32_16x16x32_bf16 v[224:227], a[68:71], a[36:39], v[224:227]
    v_exp_f32 v49, v49
    v_mfma_f32_16x16x32_bf16 v[224:227], a[72:75], a[40:43], v[224:227]
    v_exp_f32 v50, v50
    v_cvt_pk_bf16_f32 v72, v48, v49
    v_mfma_f32_16x16x32_bf16 v[224:227], a[76:79], a[44:47], v[224:227]
    v_exp_f32 v51, v51
    v_mfma_f32_16x16x32_bf16 v[228:231], a[92:95], a[44:47], 0
    v_exp_f32 v52, v52
    v_cvt_pk_bf16_f32 v73, v50, v51
    v_mfma_f32_16x16x32_bf16 v[228:231], a[88:91], a[40:43], v[228:231]
    v_exp_f32 v53, v53
    v_mfma_f32_16x16x32_bf16 v[228:231], a[84:87], a[36:39], v[228:231]
    v_exp_f32 v54, v54
    v_cvt_pk_bf16_f32 v74, v52, v53
    v_mfma_f32_16x16x32_bf16 v[228:231], a[80:83], a[32:35], v[228:231]
    v_exp_f32 v55, v55
    v_mfma_f32_16x16x32_bf16 v[232:235], a[96:99], a[32:35], 0
    v_exp_f32 v56, v56
    v_cvt_pk_bf16_f32 v75, v54, v55
    v_mfma_f32_16x16x32_bf16 v[232:235], a[100:103], a[36:39], v[232:235]
    v_exp_f32 v57, v57
    v_mfma_f32_16x16x32_bf16 v[232:235], a[104:107], a[40:43], v[232:235]
    v_exp_f32 v58, v58
    v_cvt_pk_bf16_f32 v76, v56, v57
    v_mfma_f32_16x16x32_bf16 v[232:235], a[108:111], a[44:47], v[232:235]
    v_exp_f32 v59, v59
    v_mfma_f32_16x16x32_bf16 v[236:239], a[124:127], a[44:47], 0
    v_exp_f32 v60, v60
    v_cvt_pk_bf16_f32 v77, v58, v59
    v_mfma_f32_16x16x32_bf16 v[236:239], a[120:123], a[40:43], v[236:239]
    v_exp_f32 v61, v61
    v_mfma_f32_16x16x32_bf16 v[236:239], a[116:119], a[36:39], v[236:239]
    v_exp_f32 v62, v62
    v_cvt_pk_bf16_f32 v78, v60, v61
    v_mfma_f32_16x16x32_bf16 v[236:239], a[112:115], a[32:35], v[236:239]
    v_exp_f32 v63, v63
    s_nop 0
    v_cvt_pk_bf16_f32 v79, v62, v63
    s_waitcnt vmcnt(12)
    s_barrier
    ds_read_b128 a[64:67], v0 offset:16384
    ds_read_b128 a[68:71], v1 offset:16384
    ds_read_b128 a[72:75], v2 offset:16384
    ds_read_b128 a[76:79], v3 offset:16384
    ds_read_b128 a[80:83], v0 offset:20480
    ds_read_b128 a[84:87], v1 offset:20480
    ds_read_b128 a[88:91], v2 offset:20480
    ds_read_b128 a[92:95], v3 offset:20480
    ds_read_b128 a[96:99], v0 offset:24576
    ds_read_b128 a[100:103], v1 offset:24576
    ds_read_b128 a[104:107], v2 offset:24576
    ds_read_b128 a[108:111], v3 offset:24576
    ds_read_b128 a[112:115], v0 offset:28672
    ds_read_b128 a[116:119], v1 offset:28672
    ds_read_b128 a[120:123], v2 offset:28672
    ds_read_b128 a[124:127], v3 offset:28672
    s_add_u32 m0, s30, 32768
    s_nop 0
    buffer_load_dwordx4 v12, s[12:15], s32 offen offset:0 nt lds
    buffer_load_dwordx4 v13, s[12:15], s32 offen offset:1024 nt lds
    buffer_load_dwordx4 v14, s[12:15], s32 offen offset:2048 nt lds
    buffer_load_dwordx4 v15, s[12:15], s32 offen offset:3072 nt lds
    v_max3_f32 v24, v224, v225, v226
    v_max3_f32 v25, v227, v228, v229
    v_max3_f32 v24, v24, v230, v231
    v_max3_f32 v25, v25, v232, v233
    v_max3_f32 v24, v24, v234, v235
    v_max3_f32 v25, v25, v236, v237
    v_max3_f32 v24, v24, v238, v239
    v_max_f32 v24, v24, v25
    v_mov_b32 v25, v24
    s_nop 1
    v_permlane32_swap_b32 v24, v25
    v_max_f32 v24, v24, v25
    v_mov_b32 v25, v24
    s_nop 1
    v_permlane16_swap_b32 v24, v25
    v_max_f32 v24, v24, v25
    v_sub_f32 v224, v224, v24
    v_sub_f32 v225, v225, v24
    v_sub_f32 v226, v226, v24
    v_sub_f32 v227, v227, v24
    v_sub_f32 v228, v228, v24
    v_sub_f32 v229, v229, v24
    v_sub_f32 v230, v230, v24
    v_sub_f32 v231, v231, v24
    v_sub_f32 v232, v232, v24
    v_sub_f32 v233, v233, v24
    v_sub_f32 v234, v234, v24
    v_sub_f32 v235, v235, v24
    v_sub_f32 v236, v236, v24
    v_sub_f32 v237, v237, v24
    v_sub_f32 v238, v238, v24
    v_sub_f32 v239, v239, v24
    v_sub_f32 v88, 0, v24
    v_sub_f32 v89, 0, v24
    v_sub_f32 v90, 0, v24
    v_sub_f32 v91, 0, v24
    s_add_u32 m0, s30, 98304
    s_nop 0
    buffer_load_dwordx4 v16, s[16:19], s32 offen offset:0 nt lds
    buffer_load_dwordx4 v17, s[16:19], s32 offen offset:1024 nt lds
    buffer_load_dwordx4 v16, s[16:19], s32 offen offset:2048 nt lds
    buffer_load_dwordx4 v17, s[16:19], s32 offen offset:3072 nt lds
    s_or_b32 s32, s32, 98304
    s_add_u32 s32, s32, 4096
    s_andn2_b32 s32, s32, 98304
    s_add_u32 m0, s30, 0
    s_nop 0
    buffer_load_dwordx4 v12, s[12:15], s32 offen offset:0 nt lds
    buffer_load_dwordx4 v13, s[12:15], s32 offen offset:1024 nt lds
    buffer_load_dwordx4 v14, s[12:15], s32 offen offset:2048 nt lds
    buffer_load_dwordx4 v15, s[12:15], s32 offen offset:3072 nt lds
    s_sub_u32 s28, s30, s37
    v_add_u32 v100, s28, v12
    v_add_u32 v101, s28, v13
    v_add_u32 v102, s28, v14
    v_add_u32 v103, s28, v15
    v_xor_b32 v0, 16384, v0
    v_xor_b32 v1, 16384, v1
    v_xor_b32 v2, 16384, v2
    v_xor_b32 v3, 16384, v3
    s_waitcnt lgkmcnt(0)
    s_branch S_W3
Z_B3O:
.p2align 6
S_slow4:
    s_waitcnt vmcnt(0) lgkmcnt(0)
    s_add_u32 s28, s30, 65536
    v_lshrrev_b32 v22, 2, v18
    v_and_b32 v20, 7, v22
    v_lshlrev_b32 v22, 8, v22
    v_and_b32 v23, 3, v18
    v_lshl_add_u32 v22, v23, 3, v22
    v_add_u32 v22, s28, v22
    v_xor_b32 v24, 0, v20
    v_lshl_add_u32 v4, v24, 5, v22
    v_xor_b32 v24, 1, v20
    v_lshl_add_u32 v5, v24, 5, v22
    v_xor_b32 v24, 2, v20
    v_lshl_add_u32 v6, v24, 5, v22
    v_xor_b32 v24, 3, v20
    v_lshl_add_u32 v7, v24, 5, v22
    v_xor_b32 v24, 4, v20
    v_lshl_add_u32 v8, v24, 5, v22
    v_xor_b32 v24, 5, v20
    v_lshl_add_u32 v9, v24, 5, v22
    v_xor_b32 v24, 6, v20
    v_lshl_add_u32 v10, v24, 5, v22
    v_xor_b32 v24, 7, v20
    v_lshl_add_u32 v11, v24, 5, v22
    s_lshl_b32 s28, s3, 14
    v_and_b32 v21, 15, v18
    v_lshrrev_b32 v20, 5, v18
    v_bfe_u32 v23, v18, 4, 1
    v_lshlrev_b32 v110, 8, v21
    v_lshl_add_u32 v110, v23, 5, v110
    v_lshl_add_u32 v110, v20, 4, v110
    v_add_u32 v110, s28, v110
    v_mfma_f32_32x32x16_bf16 v[128:143], a[212:215], a[212:215], 0
    v_mfma_f32_32x32x16_bf16 v[144:159], a[212:215], a[212:215], 0
    v_mfma_f32_32x32x16_bf16 v[160:175], a[212:215], a[212:215], 0
    v_mfma_f32_32x32x16_bf16 v[176:191], a[212:215], a[212:215], 0
    v_mfma_f32_32x32x16_bf16 v[192:207], a[212:215], a[212:215], 0
    v_mfma_f32_32x32x16_bf16 v[208:223], a[212:215], a[212:215], 0
    v_mfma_f32_32x32x16_bf16 v[224:239], a[212:215], a[212:215], 0
    v_mfma_f32_32x32x16_bf16 v[240:255], a[212:215], a[212:215], 0
    v_mfma_f32_32x32x16_bf16 a[192:207], a[212:215], a[212:215], 0
    v_mov_b32 v80, 0xff7fffff
    v_mov_b32 v84, 0
    v_mov_b32 v81, 0xff7fffff
    v_mov_b32 v85, 0
    v_mov_b32 v82, 0xff7fffff
    v_mov_b32 v86, 0
    v_mov_b32 v83, 0xff7fffff
    v_mov_b32 v87, 0
    v_subrev_u32 v112, s37, v12
    v_subrev_u32 v113, s37, v13
    v_subrev_u32 v114, s37, v14
    v_subrev_u32 v115, s37, v15
    v_subrev_u32 v116, s37, v16
    v_subrev_u32 v117, s37, v17
    s_mov_b32 s32, 0
L_sl4:
    s_add_u32 m0, s30, 0
    s_add_u32 s28, s32, 0
    buffer_load_dwordx4 v112, s[12:15], s28 offen offset:0 lds
    buffer_load_dwordx4 v113, s[12:15], s28 offen offset:1024 lds
    buffer_load_dwordx4 v114, s[12:15], s28 offen offset:2048 lds
    buffer_load_dwordx4 v115, s[12:15], s28 offen offset:3072 lds
    s_add_u32 m0, s30, 65536
    s_nop 0
    buffer_load_dwordx4 v116, s[16:19], s28 offen offset:0 lds
    buffer_load_dwordx4 v117, s[16:19], s28 offen offset:1024 lds
    buffer_load_dwordx4 v116, s[16:19], s28 offen offset:2048 lds
    buffer_load_dwordx4 v117, s[16:19], s28 offen offset:3072 lds
    s_add_u32 m0, s30, 16384
    s_add_u32 s28, s32, 4096
    buffer_load_dwordx4 v112, s[12:15], s28 offen offset:0 lds
    buffer_load_dwordx4 v113, s[12:15], s28 offen offset:1024 lds
    buffer_load_dwordx4 v114, s[12:15], s28 offen offset:2048 lds
    buffer_load_dwordx4 v115, s[12:15], s28 offen offset:3072 lds
    s_add_u32 m0, s30, 81920
    s_nop 0
    buffer_load_dwordx4 v116, s[16:19], s28 offen offset:0 lds
    buffer_load_dwordx4 v117, s[16:19], s28 offen offset:1024 lds
    buffer_load_dwordx4 v116, s[16:19], s28 offen offset:2048 lds
    buffer_load_dwordx4 v117, s[16:19], s28 offen offset:3072 lds
    s_waitcnt vmcnt(0)
    ds_read_b128 a[64:67], v96 offset:0
    ds_read_b128 a[68:71], v97 offset:0
    ds_read_b128 a[72:75], v98 offset:0
    ds_read_b128 a[76:79], v99 offset:0
    ds_read_b128 a[80:83], v96 offset:16384
    ds_read_b128 a[84:87], v97 offset:16384
    ds_read_b128 a[88:91], v98 offset:16384
    ds_read_b128 a[92:95], v99 offset:16384
    s_waitcnt lgkmcnt(0)
    ds_read_b64_tr_b16 a[128:129], v4 offset:0
    ds_read_b64_tr_b16 a[130:131], v4 offset:16384
    ds_read_b64_tr_b16 a[132:133], v5 offset:0
    ds_read_b64_tr_b16 a[134:135], v5 offset:16384
    ds_read_b64_tr_b16 a[136:137], v6 offset:0
    ds_read_b64_tr_b16 a[138:139], v6 offset:16384
    ds_read_b64_tr_b16 a[140:141], v7 offset:0
    ds_read_b64_tr_b16 a[142:143], v7 offset:16384
    ds_read_b64_tr_b16 a[144:145], v8 offset:0
    ds_read_b64_tr_b16 a[146:147], v8 offset:16384
    ds_read_b64_tr_b16 a[148:149], v9 offset:0
    ds_read_b64_tr_b16 a[150:151], v9 offset:16384
    ds_read_b64_tr_b16 a[152:153], v10 offset:0
    ds_read_b64_tr_b16 a[154:155], v10 offset:16384
    ds_read_b64_tr_b16 a[156:157], v11 offset:0
    ds_read_b64_tr_b16 a[158:159], v11 offset:16384
    s_waitcnt lgkmcnt(0)
    v_mfma_f32_16x16x32_bf16 v[32:35], a[64:67], a[0:3], 0
    v_mfma_f32_16x16x32_bf16 v[32:35], a[68:71], a[4:7], v[32:35]
    v_mfma_f32_16x16x32_bf16 v[32:35], a[72:75], a[8:11], v[32:35]
    v_mfma_f32_16x16x32_bf16 v[32:35], a[76:79], a[12:15], v[32:35]
    v_mfma_f32_16x16x32_bf16 v[36:39], a[80:83], a[0:3], 0
    v_mfma_f32_16x16x32_bf16 v[36:39], a[84:87], a[4:7], v[36:39]
    v_mfma_f32_16x16x32_bf16 v[36:39], a[88:91], a[8:11], v[36:39]
    v_mfma_f32_16x16x32_bf16 v[36:39], a[92:95], a[12:15], v[36:39]
    s_nop 7
    v_max3_f32 v24, v32, v33, v34
    v_max3_f32 v25, v35, v36, v37
    v_max3_f32 v24, v24, v38, v39
    v_max3_f32 v24, v24, v25, v80
    v_mov_b32 v25, v24
    s_nop 1
    v_permlane32_swap_b32 v24, v25
    v_max_f32 v24, v24, v25
    v_mov_b32 v25, v24
    s_nop 1
    v_permlane16_swap_b32 v24, v25
    v_max_f32 v24, v24, v25
    v_sub_f32 v22, v80, v24
    v_exp_f32 v22, v22
    v_mov_b32 v80, v24
    v_sub_f32 v32, v32, v24
    v_sub_f32 v33, v33, v24
    v_sub_f32 v34, v34, v24
    v_sub_f32 v35, v35, v24
    v_sub_f32 v36, v36, v24
    v_sub_f32 v37, v37, v24
    v_sub_f32 v38, v38, v24
    v_sub_f32 v39, v39, v24
    v_exp_f32 v32, v32
    v_exp_f32 v33, v33
    v_exp_f32 v34, v34
    v_exp_f32 v35, v35
    v_exp_f32 v36, v36
    v_exp_f32 v37, v37
    v_exp_f32 v38, v38
    v_exp_f32 v39, v39
    v_mul_f32 v84, v84, v22
    v_cvt_pk_bf16_f32 v64, v32, v33
    v_cvt_pk_bf16_f32 v65, v34, v35
    v_cvt_pk_bf16_f32 v66, v36, v37
    v_cvt_pk_bf16_f32 v67, v38, v39
    v_lshlrev_b32 v25, 16, v64
    v_add_f32 v84, v84, v25
    v_and_b32 v25, s31, v64
    v_add_f32 v84, v84, v25
    v_lshlrev_b32 v25, 16, v65
    v_add_f32 v84, v84, v25
    v_and_b32 v25, s31, v65
    v_add_f32 v84, v84, v25
    v_lshlrev_b32 v25, 16, v66
    v_add_f32 v84, v84, v25
    v_and_b32 v25, s31, v66
    v_add_f32 v84, v84, v25
    v_lshlrev_b32 v25, 16, v67
    v_add_f32 v84, v84, v25
    v_and_b32 v25, s31, v67
    v_add_f32 v84, v84, v25
    v_mul_f32 v128, v128, v22
    v_mul_f32 v129, v129, v22
    v_mul_f32 v130, v130, v22
    v_mul_f32 v131, v131, v22
    v_mul_f32 v132, v132, v22
    v_mul_f32 v133, v133, v22
    v_mul_f32 v134, v134, v22
    v_mul_f32 v135, v135, v22
    v_mul_f32 v136, v136, v22
    v_mul_f32 v137, v137, v22
    v_mul_f32 v138, v138, v22
    v_mul_f32 v139, v139, v22
    v_mul_f32 v140, v140, v22
    v_mul_f32 v141, v141, v22
    v_mul_f32 v142, v142, v22
    v_mul_f32 v143, v143, v22
    v_mul_f32 v144, v144, v22
    v_mul_f32 v145, v145, v22
    v_mul_f32 v146, v146, v22
    v_mul_f32 v147, v147, v22
    v_mul_f32 v148, v148, v22
    v_mul_f32 v149, v149, v22
    v_mul_f32 v150, v150, v22
    v_mul_f32 v151, v151, v22
    v_mul_f32 v152, v152, v22
    v_mul_f32 v153, v153, v22
    v_mul_f32 v154, v154, v22
    v_mul_f32 v155, v155, v22
    v_mul_f32 v156, v156, v22
    v_mul_f32 v157, v157, v22
    v_mul_f32 v158, v158, v22
    v_mul_f32 v159, v159, v22
    s_nop 1
    v_mfma_f32_16x16x32_bf16 v[128:131], a[128:131], v[64:67], v[128:131]
    v_mfma_f32_16x16x32_bf16 v[132:135], a[132:135], v[64:67], v[132:135]
    v_mfma_f32_16x16x32_bf16 v[136:139], a[136:139], v[64:67], v[136:139]
    v_mfma_f32_16x16x32_bf16 v[140:143], a[140:143], v[64:67], v[140:143]
    v_mfma_f32_16x16x32_bf16 v[144:147], a[144:147], v[64:67], v[144:147]
    v_mfma_f32_16x16x32_bf16 v[148:151], a[148:151], v[64:67], v[148:151]
    v_mfma_f32_16x16x32_bf16 v[152:155], a[152:155], v[64:67], v[152:155]
    v_mfma_f32_16x16x32_bf16 v[156:159], a[156:159], v[64:67], v[156:159]
    s_nop 7
    v_mfma_f32_16x16x32_bf16 v[32:35], a[64:67], a[16:19], 0
    v_mfma_f32_16x16x32_bf16 v[32:35], a[68:71], a[20:23], v[32:35]
    v_mfma_f32_16x16x32_bf16 v[32:35], a[72:75], a[24:27], v[32:35]
    v_mfma_f32_16x16x32_bf16 v[32:35], a[76:79], a[28:31], v[32:35]
    v_mfma_f32_16x16x32_bf16 v[36:39], a[80:83], a[16:19], 0
    v_mfma_f32_16x16x32_bf16 v[36:39], a[84:87], a[20:23], v[36:39]
    v_mfma_f32_16x16x32_bf16 v[36:39], a[88:91], a[24:27], v[36:39]
    v_mfma_f32_16x16x32_bf16 v[36:39], a[92:95], a[28:31], v[36:39]
    s_nop 7
    v_max3_f32 v24, v32, v33, v34
    v_max3_f32 v25, v35, v36, v37
    v_max3_f32 v24, v24, v38, v39
    v_max3_f32 v24, v24, v25, v81
    v_mov_b32 v25, v24
    s_nop 1
    v_permlane32_swap_b32 v24, v25
    v_max_f32 v24, v24, v25
    v_mov_b32 v25, v24
    s_nop 1
    v_permlane16_swap_b32 v24, v25
    v_max_f32 v24, v24, v25
    v_sub_f32 v22, v81, v24
    v_exp_f32 v22, v22
    v_mov_b32 v81, v24
    v_sub_f32 v32, v32, v24
    v_sub_f32 v33, v33, v24
    v_sub_f32 v34, v34, v24
    v_sub_f32 v35, v35, v24
    v_sub_f32 v36, v36, v24
    v_sub_f32 v37, v37, v24
    v_sub_f32 v38, v38, v24
    v_sub_f32 v39, v39, v24
    v_exp_f32 v32, v32
    v_exp_f32 v33, v33
    v_exp_f32 v34, v34
    v_exp_f32 v35, v35
    v_exp_f32 v36, v36
    v_exp_f32 v37, v37
    v_exp_f32 v38, v38
    v_exp_f32 v39, v39
    v_mul_f32 v85, v85, v22
    v_cvt_pk_bf16_f32 v64, v32, v33
    v_cvt_pk_bf16_f32 v65, v34, v35
    v_cvt_pk_bf16_f32 v66, v36, v37
    v_cvt_pk_bf16_f32 v67, v38, v39
    v_lshlrev_b32 v25, 16, v64
    v_add_f32 v85, v85, v25
    v_and_b32 v25, s31, v64
    v_add_f32 v85, v85, v25
    v_lshlrev_b32 v25, 16, v65
    v_add_f32 v85, v85, v25
    v_and_b32 v25, s31, v65
    v_add_f32 v85, v85, v25
    v_lshlrev_b32 v25, 16, v66
    v_add_f32 v85, v85, v25
    v_and_b32 v25, s31, v66
    v_add_f32 v85, v85, v25
    v_lshlrev_b32 v25, 16, v67
    v_add_f32 v85, v85, v25
    v_and_b32 v25, s31, v67
    v_add_f32 v85, v85, v25
    v_mul_f32 v160, v160, v22
    v_mul_f32 v161, v161, v22
    v_mul_f32 v162, v162, v22
    v_mul_f32 v163, v163, v22
    v_mul_f32 v164, v164, v22
    v_mul_f32 v165, v165, v22
    v_mul_f32 v166, v166, v22
    v_mul_f32 v167, v167, v22
    v_mul_f32 v168, v168, v22
    v_mul_f32 v169, v169, v22
    v_mul_f32 v170, v170, v22
    v_mul_f32 v171, v171, v22
    v_mul_f32 v172, v172, v22
    v_mul_f32 v173, v173, v22
    v_mul_f32 v174, v174, v22
    v_mul_f32 v175, v175, v22
    v_mul_f32 v176, v176, v22
    v_mul_f32 v177, v177, v22
    v_mul_f32 v178, v178, v22
    v_mul_f32 v179, v179, v22
    v_mul_f32 v180, v180, v22
    v_mul_f32 v181, v181, v22
    v_mul_f32 v182, v182, v22
    v_mul_f32 v183, v183, v22
    v_mul_f32 v184, v184, v22
    v_mul_f32 v185, v185, v22
    v_mul_f32 v186, v186, v22
    v_mul_f32 v187, v187, v22
    v_mul_f32 v188, v188, v22
    v_mul_f32 v189, v189, v22
    v_mul_f32 v190, v190, v22
    v_mul_f32 v191, v191, v22
    s_nop 1
    v_mfma_f32_16x16x32_bf16 v[160:163], a[128:131], v[64:67], v[160:163]
    v_mfma_f32_16x16x32_bf16 v[164:167], a[132:135], v[64:67], v[164:167]
    v_mfma_f32_16x16x32_bf16 v[168:171], a[136:139], v[64:67], v[168:171]
    v_mfma_f32_16x16x32_bf16 v[172:175], a[140:143], v[64:67], v[172:175]
    v_mfma_f32_16x16x32_bf16 v[176:179], a[144:147], v[64:67], v[176:179]
    v_mfma_f32_16x16x32_bf16 v[180:183], a[148:151], v[64:67], v[180:183]
    v_mfma_f32_16x16x32_bf16 v[184:187], a[152:155], v[64:67], v[184:187]
    v_mfma_f32_16x16x32_bf16 v[188:191], a[156:159], v[64:67], v[188:191]
    s_nop 7
    v_mfma_f32_16x16x32_bf16 v[32:35], a[64:67], a[32:35], 0
    v_mfma_f32_16x16x32_bf16 v[32:35], a[68:71], a[36:39], v[32:35]
    v_mfma_f32_16x16x32_bf16 v[32:35], a[72:75], a[40:43], v[32:35]
    v_mfma_f32_16x16x32_bf16 v[32:35], a[76:79], a[44:47], v[32:35]
    v_mfma_f32_16x16x32_bf16 v[36:39], a[80:83], a[32:35], 0
    v_mfma_f32_16x16x32_bf16 v[36:39], a[84:87], a[36:39], v[36:39]
    v_mfma_f32_16x16x32_bf16 v[36:39], a[88:91], a[40:43], v[36:39]
    v_mfma_f32_16x16x32_bf16 v[36:39], a[92:95], a[44:47], v[36:39]
    s_nop 7
    v_max3_f32 v24, v32, v33, v34
    v_max3_f32 v25, v35, v36, v37
    v_max3_f32 v24, v24, v38, v39
    v_max3_f32 v24, v24, v25, v82
    v_mov_b32 v25, v24
    s_nop 1
    v_permlane32_swap_b32 v24, v25
    v_max_f32 v24, v24, v25
    v_mov_b32 v25, v24
    s_nop 1
    v_permlane16_swap_b32 v24, v25
    v_max_f32 v24, v24, v25
    v_sub_f32 v22, v82, v24
    v_exp_f32 v22, v22
    v_mov_b32 v82, v24
    v_sub_f32 v32, v32, v24
    v_sub_f32 v33, v33, v24
    v_sub_f32 v34, v34, v24
    v_sub_f32 v35, v35, v24
    v_sub_f32 v36, v36, v24
    v_sub_f32 v37, v37, v24
    v_sub_f32 v38, v38, v24
    v_sub_f32 v39, v39, v24
    v_exp_f32 v32, v32
    v_exp_f32 v33, v33
    v_exp_f32 v34, v34
    v_exp_f32 v35, v35
    v_exp_f32 v36, v36
    v_exp_f32 v37, v37
    v_exp_f32 v38, v38
    v_exp_f32 v39, v39
    v_mul_f32 v86, v86, v22
    v_cvt_pk_bf16_f32 v64, v32, v33
    v_cvt_pk_bf16_f32 v65, v34, v35
    v_cvt_pk_bf16_f32 v66, v36, v37
    v_cvt_pk_bf16_f32 v67, v38, v39
    v_lshlrev_b32 v25, 16, v64
    v_add_f32 v86, v86, v25
    v_and_b32 v25, s31, v64
    v_add_f32 v86, v86, v25
    v_lshlrev_b32 v25, 16, v65
    v_add_f32 v86, v86, v25
    v_and_b32 v25, s31, v65
    v_add_f32 v86, v86, v25
    v_lshlrev_b32 v25, 16, v66
    v_add_f32 v86, v86, v25
    v_and_b32 v25, s31, v66
    v_add_f32 v86, v86, v25
    v_lshlrev_b32 v25, 16, v67
    v_add_f32 v86, v86, v25
    v_and_b32 v25, s31, v67
    v_add_f32 v86, v86, v25
    v_mul_f32 v192, v192, v22
    v_mul_f32 v193, v193, v22
    v_mul_f32 v194, v194, v22
    v_mul_f32 v195, v195, v22
    v_mul_f32 v196, v196, v22
    v_mul_f32 v197, v197, v22
    v_mul_f32 v198, v198, v22
    v_mul_f32 v199, v199, v22
    v_mul_f32 v200, v200, v22
    v_mul_f32 v201, v201, v22
    v_mul_f32 v202, v202, v22
    v_mul_f32 v203, v203, v22
    v_mul_f32 v204, v204, v22
    v_mul_f32 v205, v205, v22
    v_mul_f32 v206, v206, v22
    v_mul_f32 v207, v207, v22
    v_mul_f32 v208, v208, v22
    v_mul_f32 v209, v209, v22
    v_mul_f32 v210, v210, v22
    v_mul_f32 v211, v211, v22
    v_mul_f32 v212, v212, v22
    v_mul_f32 v213, v213, v22
    v_mul_f32 v214, v214, v22
    v_mul_f32 v215, v215, v22
    v_mul_f32 v216, v216, v22
    v_mul_f32 v217, v217, v22
    v_mul_f32 v218, v218, v22
    v_mul_f32 v219, v219, v22
    v_mul_f32 v220, v220, v22
    v_mul_f32 v221, v221, v22
    v_mul_f32 v222, v222, v22
    v_mul_f32 v223, v223, v22
    s_nop 1
    v_mfma_f32_16x16x32_bf16 v[192:195], a[128:131], v[64:67], v[192:195]
    v_mfma_f32_16x16x32_bf16 v[196:199], a[132:135], v[64:67], v[196:199]
    v_mfma_f32_16x16x32_bf16 v[200:203], a[136:139], v[64:67], v[200:203]
    v_mfma_f32_16x16x32_bf16 v[204:207], a[140:143], v[64:67], v[204:207]
    v_mfma_f32_16x16x32_bf16 v[208:211], a[144:147], v[64:67], v[208:211]
    v_mfma_f32_16x16x32_bf16 v[212:215], a[148:151], v[64:67], v[212:215]
    v_mfma_f32_16x16x32_bf16 v[216:219], a[152:155], v[64:67], v[216:219]
    v_mfma_f32_16x16x32_bf16 v[220:223], a[156:159], v[64:67], v[220:223]
    s_nop 7
    v_mfma_f32_16x16x32_bf16 v[32:35], a[64:67], a[48:51], 0
    v_mfma_f32_16x16x32_bf16 v[32:35], a[68:71], a[52:55], v[32:35]
    v_mfma_f32_16x16x32_bf16 v[32:35], a[72:75], a[56:59], v[32:35]
    v_mfma_f32_16x16x32_bf16 v[32:35], a[76:79], a[60:63], v[32:35]
    v_mfma_f32_16x16x32_bf16 v[36:39], a[80:83], a[48:51], 0
    v_mfma_f32_16x16x32_bf16 v[36:39], a[84:87], a[52:55], v[36:39]
    v_mfma_f32_16x16x32_bf16 v[36:39], a[88:91], a[56:59], v[36:39]
    v_mfma_f32_16x16x32_bf16 v[36:39], a[92:95], a[60:63], v[36:39]
    s_nop 7
    v_max3_f32 v24, v32, v33, v34
    v_max3_f32 v25, v35, v36, v37
    v_max3_f32 v24, v24, v38, v39
    v_max3_f32 v24, v24, v25, v83
    v_mov_b32 v25, v24
    s_nop 1
    v_permlane32_swap_b32 v24, v25
    v_max_f32 v24, v24, v25
    v_mov_b32 v25, v24
    s_nop 1
    v_permlane16_swap_b32 v24, v25
    v_max_f32 v24, v24, v25
    v_sub_f32 v22, v83, v24
    v_exp_f32 v22, v22
    v_mov_b32 v83, v24
    v_sub_f32 v32, v32, v24
    v_sub_f32 v33, v33, v24
    v_sub_f32 v34, v34, v24
    v_sub_f32 v35, v35, v24
    v_sub_f32 v36, v36, v24
    v_sub_f32 v37, v37, v24
    v_sub_f32 v38, v38, v24
    v_sub_f32 v39, v39, v24
    v_exp_f32 v32, v32
    v_exp_f32 v33, v33
    v_exp_f32 v34, v34
    v_exp_f32 v35, v35
    v_exp_f32 v36, v36
    v_exp_f32 v37, v37
    v_exp_f32 v38, v38
    v_exp_f32 v39, v39
    v_mul_f32 v87, v87, v22
    v_cvt_pk_bf16_f32 v64, v32, v33
    v_cvt_pk_bf16_f32 v65, v34, v35
    v_cvt_pk_bf16_f32 v66, v36, v37
    v_cvt_pk_bf16_f32 v67, v38, v39
    v_lshlrev_b32 v25, 16, v64
    v_add_f32 v87, v87, v25
    v_and_b32 v25, s31, v64
    v_add_f32 v87, v87, v25
    v_lshlrev_b32 v25, 16, v65
    v_add_f32 v87, v87, v25
    v_and_b32 v25, s31, v65
    v_add_f32 v87, v87, v25
    v_lshlrev_b32 v25, 16, v66
    v_add_f32 v87, v87, v25
    v_and_b32 v25, s31, v66
    v_add_f32 v87, v87, v25
    v_lshlrev_b32 v25, 16, v67
    v_add_f32 v87, v87, v25
    v_and_b32 v25, s31, v67
    v_add_f32 v87, v87, v25
    v_mul_f32 v224, v224, v22
    v_mul_f32 v225, v225, v22
    v_mul_f32 v226, v226, v22
    v_mul_f32 v227, v227, v22
    v_mul_f32 v228, v228, v22
    v_mul_f32 v229, v229, v22
    v_mul_f32 v230, v230, v22
    v_mul_f32 v231, v231, v22
    v_mul_f32 v232, v232, v22
    v_mul_f32 v233, v233, v22
    v_mul_f32 v234, v234, v22
    v_mul_f32 v235, v235, v22
    v_mul_f32 v236, v236, v22
    v_mul_f32 v237, v237, v22
    v_mul_f32 v238, v238, v22
    v_mul_f32 v239, v239, v22
    v_mul_f32 v240, v240, v22
    v_mul_f32 v241, v241, v22
    v_mul_f32 v242, v242, v22
    v_mul_f32 v243, v243, v22
    v_mul_f32 v244, v244, v22
    v_mul_f32 v245, v245, v22
    v_mul_f32 v246, v246, v22
    v_mul_f32 v247, v247, v22
    v_mul_f32 v248, v248, v22
    v_mul_f32 v249, v249, v22
    v_mul_f32 v250, v250, v22
    v_mul_f32 v251, v251, v22
    v_mul_f32 v252, v252, v22
    v_mul_f32 v253, v253, v22
    v_mul_f32 v254, v254, v22
    v_mul_f32 v255, v255, v22
    s_nop 1
    v_mfma_f32_16x16x32_bf16 v[224:227], a[128:131], v[64:67], v[224:227]
    v_mfma_f32_16x16x32_bf16 v[228:231], a[132:135], v[64:67], v[228:231]
    v_mfma_f32_16x16x32_bf16 v[232:235], a[136:139], v[64:67], v[232:235]
    v_mfma_f32_16x16x32_bf16 v[236:239], a[140:143], v[64:67], v[236:239]
    v_mfma_f32_16x16x32_bf16 v[240:243], a[144:147], v[64:67], v[240:243]
    v_mfma_f32_16x16x32_bf16 v[244:247], a[148:151], v[64:67], v[244:247]
    v_mfma_f32_16x16x32_bf16 v[248:251], a[152:155], v[64:67], v[248:251]
    v_mfma_f32_16x16x32_bf16 v[252:255], a[156:159], v[64:67], v[252:255]
    s_nop 7
    s_add_u32 s32, s32, 8192
    s_cmp_lt_u32 s32, 0x80000
    s_cbranch_scc1 L_sl4
    v_mov_b32 v25, v84
    s_nop 1
    v_permlane32_swap_b32 v84, v25
    v_add_f32 v84, v84, v25
    v_mov_b32 v25, v84
    s_nop 1
    v_permlane16_swap_b32 v84, v25
    v_add_f32 v84, v84, v25
    v_rcp_f32 v20, v84
    s_nop 0
    v_pk_mul_f32 v[128:129], v[128:129], v[20:21] op_sel_hi:[1,0]
    v_pk_mul_f32 v[130:131], v[130:131], v[20:21] op_sel_hi:[1,0]
    v_pk_mul_f32 v[132:133], v[132:133], v[20:21] op_sel_hi:[1,0]
    v_pk_mul_f32 v[134:135], v[134:135], v[20:21] op_sel_hi:[1,0]
    v_pk_mul_f32 v[136:137], v[136:137], v[20:21] op_sel_hi:[1,0]
    v_pk_mul_f32 v[138:139], v[138:139], v[20:21] op_sel_hi:[1,0]
    v_pk_mul_f32 v[140:141], v[140:141], v[20:21] op_sel_hi:[1,0]
    v_pk_mul_f32 v[142:143], v[142:143], v[20:21] op_sel_hi:[1,0]
    v_pk_mul_f32 v[144:145], v[144:145], v[20:21] op_sel_hi:[1,0]
    v_pk_mul_f32 v[146:147], v[146:147], v[20:21] op_sel_hi:[1,0]
    v_pk_mul_f32 v[148:149], v[148:149], v[20:21] op_sel_hi:[1,0]
    v_pk_mul_f32 v[150:151], v[150:151], v[20:21] op_sel_hi:[1,0]
    v_pk_mul_f32 v[152:153], v[152:153], v[20:21] op_sel_hi:[1,0]
    v_pk_mul_f32 v[154:155], v[154:155], v[20:21] op_sel_hi:[1,0]
    v_pk_mul_f32 v[156:157], v[156:157], v[20:21] op_sel_hi:[1,0]
    v_pk_mul_f32 v[158:159], v[158:159], v[20:21] op_sel_hi:[1,0]
    v_cvt_pk_bf16_f32 v112, v128, v129
    v_cvt_pk_bf16_f32 v113, v130, v131
    v_cvt_pk_bf16_f32 v114, v132, v133
    v_cvt_pk_bf16_f32 v115, v134, v135
    s_nop 1
    v_permlane16_swap_b32 v112, v114
    v_permlane16_swap_b32 v113, v115
    buffer_store_dwordx4 v[112:115], v110, s[24:27], 0 offen offset:0 sc1
    v_cvt_pk_bf16_f32 v116, v136, v137
    v_cvt_pk_bf16_f32 v117, v138, v139
    v_cvt_pk_bf16_f32 v118, v140, v141
    v_cvt_pk_bf16_f32 v119, v142, v143
    s_nop 1
    v_permlane16_swap_b32 v116, v118
    v_permlane16_swap_b32 v117, v119
    buffer_store_dwordx4 v[116:119], v110, s[24:27], 0 offen offset:64 sc1
    v_cvt_pk_bf16_f32 v120, v144, v145
    v_cvt_pk_bf16_f32 v121, v146, v147
    v_cvt_pk_bf16_f32 v122, v148, v149
    v_cvt_pk_bf16_f32 v123, v150, v151
    s_nop 1
    v_permlane16_swap_b32 v120, v122
    v_permlane16_swap_b32 v121, v123
    buffer_store_dwordx4 v[120:123], v110, s[24:27], 0 offen offset:128 sc1
    v_cvt_pk_bf16_f32 v124, v152, v153
    v_cvt_pk_bf16_f32 v125, v154, v155
    v_cvt_pk_bf16_f32 v126, v156, v157
    v_cvt_pk_bf16_f32 v127, v158, v159
    s_nop 1
    v_permlane16_swap_b32 v124, v126
    v_permlane16_swap_b32 v125, v127
    buffer_store_dwordx4 v[124:127], v110, s[24:27], 0 offen offset:192 sc1
    s_nop 1
    v_mov_b32 v25, v85
    s_nop 1
    v_permlane32_swap_b32 v85, v25
    v_add_f32 v85, v85, v25
    v_mov_b32 v25, v85
    s_nop 1
    v_permlane16_swap_b32 v85, v25
    v_add_f32 v85, v85, v25
    v_rcp_f32 v22, v85
    s_nop 0
    v_pk_mul_f32 v[160:161], v[160:161], v[22:23] op_sel_hi:[1,0]
    v_pk_mul_f32 v[162:163], v[162:163], v[22:23] op_sel_hi:[1,0]
    v_pk_mul_f32 v[164:165], v[164:165], v[22:23] op_sel_hi:[1,0]
    v_pk_mul_f32 v[166:167], v[166:167], v[22:23] op_sel_hi:[1,0]
    v_pk_mul_f32 v[168:169], v[168:169], v[22:23] op_sel_hi:[1,0]
    v_pk_mul_f32 v[170:171], v[170:171], v[22:23] op_sel_hi:[1,0]
    v_pk_mul_f32 v[172:173], v[172:173], v[22:23] op_sel_hi:[1,0]
    v_pk_mul_f32 v[174:175], v[174:175], v[22:23] op_sel_hi:[1,0]
    v_pk_mul_f32 v[176:177], v[176:177], v[22:23] op_sel_hi:[1,0]
    v_pk_mul_f32 v[178:179], v[178:179], v[22:23] op_sel_hi:[1,0]
    v_pk_mul_f32 v[180:181], v[180:181], v[22:23] op_sel_hi:[1,0]
    v_pk_mul_f32 v[182:183], v[182:183], v[22:23] op_sel_hi:[1,0]
    v_pk_mul_f32 v[184:185], v[184:185], v[22:23] op_sel_hi:[1,0]
    v_pk_mul_f32 v[186:187], v[186:187], v[22:23] op_sel_hi:[1,0]
    v_pk_mul_f32 v[188:189], v[188:189], v[22:23] op_sel_hi:[1,0]
    v_pk_mul_f32 v[190:191], v[190:191], v[22:23] op_sel_hi:[1,0]
    v_cvt_pk_bf16_f32 v112, v160, v161
    v_cvt_pk_bf16_f32 v113, v162, v163
    v_cvt_pk_bf16_f32 v114, v164, v165
    v_cvt_pk_bf16_f32 v115, v166, v167
    s_nop 1
    v_permlane16_swap_b32 v112, v114
    v_permlane16_swap_b32 v113, v115
    buffer_store_dwordx4 v[112:115], v110, s[24:27], s8 offen offset:0 sc1
    v_cvt_pk_bf16_f32 v116, v168, v169
    v_cvt_pk_bf16_f32 v117, v170, v171
    v_cvt_pk_bf16_f32 v118, v172, v173
    v_cvt_pk_bf16_f32 v119, v174, v175
    s_nop 1
    v_permlane16_swap_b32 v116, v118
    v_permlane16_swap_b32 v117, v119
    buffer_store_dwordx4 v[116:119], v110, s[24:27], s8 offen offset:64 sc1
    v_cvt_pk_bf16_f32 v120, v176, v177
    v_cvt_pk_bf16_f32 v121, v178, v179
    v_cvt_pk_bf16_f32 v122, v180, v181
    v_cvt_pk_bf16_f32 v123, v182, v183
    s_nop 1
    v_permlane16_swap_b32 v120, v122
    v_permlane16_swap_b32 v121, v123
    buffer_store_dwordx4 v[120:123], v110, s[24:27], s8 offen offset:128 sc1
    v_cvt_pk_bf16_f32 v124, v184, v185
    v_cvt_pk_bf16_f32 v125, v186, v187
    v_cvt_pk_bf16_f32 v126, v188, v189
    v_cvt_pk_bf16_f32 v127, v190, v191
    s_nop 1
    v_permlane16_swap_b32 v124, v126
    v_permlane16_swap_b32 v125, v127
    buffer_store_dwordx4 v[124:127], v110, s[24:27], s8 offen offset:192 sc1
    s_nop 1
    v_mov_b32 v25, v86
    s_nop 1
    v_permlane32_swap_b32 v86, v25
    v_add_f32 v86, v86, v25
    v_mov_b32 v25, v86
    s_nop 1
    v_permlane16_swap_b32 v86, v25
    v_add_f32 v86, v86, v25
    v_rcp_f32 v20, v86
    s_nop 0
    v_pk_mul_f32 v[192:193], v[192:193], v[20:21] op_sel_hi:[1,0]
    v_pk_mul_f32 v[194:195], v[194:195], v[20:21] op_sel_hi:[1,0]
    v_pk_mul_f32 v[196:197], v[196:197], v[20:21] op_sel_hi:[1,0]
    v_pk_mul_f32 v[198:199], v[198:199], v[20:21] op_sel_hi:[1,0]
    v_pk_mul_f32 v[200:201], v[200:201], v[20:21] op_sel_hi:[1,0]
    v_pk_mul_f32 v[202:203], v[202:203], v[20:21] op_sel_hi:[1,0]
    v_pk_mul_f32 v[204:205], v[204:205], v[20:21] op_sel_hi:[1,0]
    v_pk_mul_f32 v[206:207], v[206:207], v[20:21] op_sel_hi:[1,0]
    v_pk_mul_f32 v[208:209], v[208:209], v[20:21] op_sel_hi:[1,0]
    v_pk_mul_f32 v[210:211], v[210:211], v[20:21] op_sel_hi:[1,0]
    v_pk_mul_f32 v[212:213], v[212:213], v[20:21] op_sel_hi:[1,0]
    v_pk_mul_f32 v[214:215], v[214:215], v[20:21] op_sel_hi:[1,0]
    v_pk_mul_f32 v[216:217], v[216:217], v[20:21] op_sel_hi:[1,0]
    v_pk_mul_f32 v[218:219], v[218:219], v[20:21] op_sel_hi:[1,0]
    v_pk_mul_f32 v[220:221], v[220:221], v[20:21] op_sel_hi:[1,0]
    v_pk_mul_f32 v[222:223], v[222:223], v[20:21] op_sel_hi:[1,0]
    v_cvt_pk_bf16_f32 v112, v192, v193
    v_cvt_pk_bf16_f32 v113, v194, v195
    v_cvt_pk_bf16_f32 v114, v196, v197
    v_cvt_pk_bf16_f32 v115, v198, v199
    s_nop 1
    v_permlane16_swap_b32 v112, v114
    v_permlane16_swap_b32 v113, v115
    buffer_store_dwordx4 v[112:115], v110, s[24:27], s9 offen offset:0 sc1
    v_cvt_pk_bf16_f32 v116, v200, v201
    v_cvt_pk_bf16_f32 v117, v202, v203
    v_cvt_pk_bf16_f32 v118, v204, v205
    v_cvt_pk_bf16_f32 v119, v206, v207
    s_nop 1
    v_permlane16_swap_b32 v116, v118
    v_permlane16_swap_b32 v117, v119
    buffer_store_dwordx4 v[116:119], v110, s[24:27], s9 offen offset:64 sc1
    v_cvt_pk_bf16_f32 v120, v208, v209
    v_cvt_pk_bf16_f32 v121, v210, v211
    v_cvt_pk_bf16_f32 v122, v212, v213
    v_cvt_pk_bf16_f32 v123, v214, v215
    s_nop 1
    v_permlane16_swap_b32 v120, v122
    v_permlane16_swap_b32 v121, v123
    buffer_store_dwordx4 v[120:123], v110, s[24:27], s9 offen offset:128 sc1
    v_cvt_pk_bf16_f32 v124, v216, v217
    v_cvt_pk_bf16_f32 v125, v218, v219
    v_cvt_pk_bf16_f32 v126, v220, v221
    v_cvt_pk_bf16_f32 v127, v222, v223
    s_nop 1
    v_permlane16_swap_b32 v124, v126
    v_permlane16_swap_b32 v125, v127
    buffer_store_dwordx4 v[124:127], v110, s[24:27], s9 offen offset:192 sc1
    s_nop 1
    v_mov_b32 v25, v87
    s_nop 1
    v_permlane32_swap_b32 v87, v25
    v_add_f32 v87, v87, v25
    v_mov_b32 v25, v87
    s_nop 1
    v_permlane16_swap_b32 v87, v25
    v_add_f32 v87, v87, v25
    v_rcp_f32 v22, v87
    s_nop 0
    v_pk_mul_f32 v[224:225], v[224:225], v[22:23] op_sel_hi:[1,0]
    v_pk_mul_f32 v[226:227], v[226:227], v[22:23] op_sel_hi:[1,0]
    v_pk_mul_f32 v[228:229], v[228:229], v[22:23] op_sel_hi:[1,0]
    v_pk_mul_f32 v[230:231], v[230:231], v[22:23] op_sel_hi:[1,0]
    v_pk_mul_f32 v[232:233], v[232:233], v[22:23] op_sel_hi:[1,0]
    v_pk_mul_f32 v[234:235], v[234:235], v[22:23] op_sel_hi:[1,0]
    v_pk_mul_f32 v[236:237], v[236:237], v[22:23] op_sel_hi:[1,0]
    v_pk_mul_f32 v[238:239], v[238:239], v[22:23] op_sel_hi:[1,0]
    v_pk_mul_f32 v[240:241], v[240:241], v[22:23] op_sel_hi:[1,0]
    v_pk_mul_f32 v[242:243], v[242:243], v[22:23] op_sel_hi:[1,0]
    v_pk_mul_f32 v[244:245], v[244:245], v[22:23] op_sel_hi:[1,0]
    v_pk_mul_f32 v[246:247], v[246:247], v[22:23] op_sel_hi:[1,0]
    v_pk_mul_f32 v[248:249], v[248:249], v[22:23] op_sel_hi:[1,0]
    v_pk_mul_f32 v[250:251], v[250:251], v[22:23] op_sel_hi:[1,0]
    v_pk_mul_f32 v[252:253], v[252:253], v[22:23] op_sel_hi:[1,0]
    v_pk_mul_f32 v[254:255], v[254:255], v[22:23] op_sel_hi:[1,0]
    v_cvt_pk_bf16_f32 v112, v224, v225
    v_cvt_pk_bf16_f32 v113, v226, v227
    v_cvt_pk_bf16_f32 v114, v228, v229
    v_cvt_pk_bf16_f32 v115, v230, v231
    s_nop 1
    v_permlane16_swap_b32 v112, v114
    v_permlane16_swap_b32 v113, v115
    buffer_store_dwordx4 v[112:115], v110, s[24:27], s10 offen offset:0 sc1
    v_cvt_pk_bf16_f32 v116, v232, v233
    v_cvt_pk_bf16_f32 v117, v234, v235
    v_cvt_pk_bf16_f32 v118, v236, v237
    v_cvt_pk_bf16_f32 v119, v238, v239
    s_nop 1
    v_permlane16_swap_b32 v116, v118
    v_permlane16_swap_b32 v117, v119
    buffer_store_dwordx4 v[116:119], v110, s[24:27], s10 offen offset:64 sc1
    v_cvt_pk_bf16_f32 v120, v240, v241
    v_cvt_pk_bf16_f32 v121, v242, v243
    v_cvt_pk_bf16_f32 v122, v244, v245
    v_cvt_pk_bf16_f32 v123, v246, v247
    s_nop 1
    v_permlane16_swap_b32 v120, v122
    v_permlane16_swap_b32 v121, v123
    buffer_store_dwordx4 v[120:123], v110, s[24:27], s10 offen offset:128 sc1
    v_cvt_pk_bf16_f32 v124, v248, v249
    v_cvt_pk_bf16_f32 v125, v250, v251
    v_cvt_pk_bf16_f32 v126, v252, v253
    v_cvt_pk_bf16_f32 v127, v254, v255
    s_nop 1
    v_permlane16_swap_b32 v124, v126
    v_permlane16_swap_b32 v125, v127
    buffer_store_dwordx4 v[124:127], v110, s[24:27], s10 offen offset:192 sc1
    s_nop 1
    s_branch L_fin4
Z_slow4:
.p2align 6
S_slow3:
    s_waitcnt vmcnt(0) lgkmcnt(0)
    s_add_u32 s28, s30, 65536
    v_lshrrev_b32 v22, 2, v18
    v_and_b32 v20, 7, v22
    v_lshlrev_b32 v22, 8, v22
    v_and_b32 v23, 3, v18
    v_lshl_add_u32 v22, v23, 3, v22
    v_add_u32 v22, s28, v22
    v_xor_b32 v24, 0, v20
    v_lshl_add_u32 v4, v24, 5, v22
    v_xor_b32 v24, 1, v20
    v_lshl_add_u32 v5, v24, 5, v22
    v_xor_b32 v24, 2, v20
    v_lshl_add_u32 v6, v24, 5, v22
    v_xor_b32 v24, 3, v20
    v_lshl_add_u32 v7, v24, 5, v22
    v_xor_b32 v24, 4, v20
    v_lshl_add_u32 v8, v24, 5, v22
    v_xor_b32 v24, 5, v20
    v_lshl_add_u32 v9, v24, 5, v22
    v_xor_b32 v24, 6, v20
    v_lshl_add_u32 v10, v24, 5, v22
    v_xor_b32 v24, 7, v20
    v_lshl_add_u32 v11, v24, 5, v22
    s_lshl_b32 s28, s3, 14
    v_and_b32 v21, 15, v18
    v_lshrrev_b32 v20, 5, v18
    v_bfe_u32 v23, v18, 4, 1
    v_lshlrev_b32 v110, 8, v21
    v_lshl_add_u32 v110, v23, 5, v110
    v_lshl_add_u32 v110, v20, 4, v110
    v_add_u32 v110, s28, v110
    v_mfma_f32_32x32x16_bf16 v[128:143], a[212:215], a[212:215], 0
    v_mfma_f32_32x32x16_bf16 v[144:159], a[212:215], a[212:215], 0
    v_mfma_f32_32x32x16_bf16 v[160:175], a[212:215], a[212:215], 0
    v_mfma_f32_32x32x16_bf16 v[176:191], a[212:215], a[212:215], 0
    v_mfma_f32_32x32x16_bf16 v[192:207], a[212:215], a[212:215], 0
    v_mfma_f32_32x32x16_bf16 v[208:223], a[212:215], a[212:215], 0
    v_mfma_f32_32x32x16_bf16 v[224:239], a[212:215], a[212:215], 0
    v_mfma_f32_32x32x16_bf16 v[240:255], a[212:215], a[212:215], 0
    v_mfma_f32_32x32x16_bf16 a[192:207], a[212:215], a[212:215], 0
    v_mov_b32 v80, 0xff7fffff
    v_mov_b32 v84, 0
    v_mov_b32 v81, 0xff7fffff
    v_mov_b32 v85, 0
    v_mov_b32 v82, 0xff7fffff
    v_mov_b32 v86, 0
    v_subrev_u32 v112, s37, v12
    v_subrev_u32 v113, s37, v13
    v_subrev_u32 v114, s37, v14
    v_subrev_u32 v115, s37, v15
    v_subrev_u32 v116, s37, v16
    v_subrev_u32 v117, s37, v17
    s_mov_b32 s32, 0
L_sl3:
    s_add_u32 m0, s30, 0
    s_add_u32 s28, s32, 0
    buffer_load_dwordx4 v112, s[12:15], s28 offen offset:0 lds
    buffer_load_dwordx4 v113, s[12:15], s28 offen offset:1024 lds
    buffer_load_dwordx4 v114, s[12:15], s28 offen offset:2048 lds
    buffer_load_dwordx4 v115, s[12:15], s28 offen offset:3072 lds
    s_add_u32 m0, s30, 65536
    s_nop 0
    buffer_load_dwordx4 v116, s[16:19], s28 offen offset:0 lds
    buffer_load_dwordx4 v117, s[16:19], s28 offen offset:1024 lds
    buffer_load_dwordx4 v116, s[16:19], s28 offen offset:2048 lds
    buffer_load_dwordx4 v117, s[16:19], s28 offen offset:3072 lds
    s_add_u32 m0, s30, 16384
    s_add_u32 s28, s32, 4096
    buffer_load_dwordx4 v112, s[12:15], s28 offen offset:0 lds
    buffer_load_dwordx4 v113, s[12:15], s28 offen offset:1024 lds
    buffer_load_dwordx4 v114, s[12:15], s28 offen offset:2048 lds
    buffer_load_dwordx4 v115, s[12:15], s28 offen offset:3072 lds
    s_add_u32 m0, s30, 81920
    s_nop 0
    buffer_load_dwordx4 v116, s[16:19], s28 offen offset:0 lds
    buffer_load_dwordx4 v117, s[16:19], s28 offen offset:1024 lds
    buffer_load_dwordx4 v116, s[16:19], s28 offen offset:2048 lds
    buffer_load_dwordx4 v117, s[16:19], s28 offen offset:3072 lds
    s_waitcnt vmcnt(0)
    ds_read_b128 a[64:67], v96 offset:0
    ds_read_b128 a[68:71], v97 offset:0
    ds_read_b128 a[72:75], v98 offset:0
    ds_read_b128 a[76:79], v99 offset:0
    ds_read_b128 a[80:83], v96 offset:16384
    ds_read_b128 a[84:87], v97 offset:16384
    ds_read_b128 a[88:91], v98 offset:16384
    ds_read_b128 a[92:95], v99 offset:16384
    s_waitcnt lgkmcnt(0)
    ds_read_b64_tr_b16 a[128:129], v4 offset:0
    ds_read_b64_tr_b16 a[130:131], v4 offset:16384
    ds_read_b64_tr_b16 a[132:133], v5 offset:0
    ds_read_b64_tr_b16 a[134:135], v5 offset:16384
    ds_read_b64_tr_b16 a[136:137], v6 offset:0
    ds_read_b64_tr_b16 a[138:139], v6 offset:16384
    ds_read_b64_tr_b16 a[140:141], v7 offset:0
    ds_read_b64_tr_b16 a[142:143], v7 offset:16384
    ds_read_b64_tr_b16 a[144:145], v8 offset:0
    ds_read_b64_tr_b16 a[146:147], v8 offset:16384
    ds_read_b64_tr_b16 a[148:149], v9 offset:0
    ds_read_b64_tr_b16 a[150:151], v9 offset:16384
    ds_read_b64_tr_b16 a[152:153], v10 offset:0
    ds_read_b64_tr_b16 a[154:155], v10 offset:16384
    ds_read_b64_tr_b16 a[156:157], v11 offset:0
    ds_read_b64_tr_b16 a[158:159], v11 offset:16384
    s_waitcnt lgkmcnt(0)
    v_mfma_f32_16x16x32_bf16 v[32:35], a[64:67], a[0:3], 0
    v_mfma_f32_16x16x32_bf16 v[32:35], a[68:71], a[4:7], v[32:35]
    v_mfma_f32_16x16x32_bf16 v[32:35], a[72:75], a[8:11], v[32:35]
    v_mfma_f32_16x16x32_bf16 v[32:35], a[76:79], a[12:15], v[32:35]
    v_mfma_f32_16x16x32_bf16 v[36:39], a[80:83], a[0:3], 0
    v_mfma_f32_16x16x32_bf16 v[36:39], a[84:87], a[4:7], v[36:39]
    v_mfma_f32_16x16x32_bf16 v[36:39], a[88:91], a[8:11], v[36:39]
    v_mfma_f32_16x16x32_bf16 v[36:39], a[92:95], a[12:15], v[36:39]
    s_nop 7
    v_max3_f32 v24, v32, v33, v34
    v_max3_f32 v25, v35, v36, v37
    v_max3_f32 v24, v24, v38, v39
    v_max3_f32 v24, v24, v25, v80
    v_mov_b32 v25, v24
    s_nop 1
    v_permlane32_swap_b32 v24, v25
    v_max_f32 v24, v24, v25
    v_mov_b32 v25, v24
    s_nop 1
    v_permlane16_swap_b32 v24, v25
    v_max_f32 v24, v24, v25
    v_sub_f32 v22, v80, v24
    v_exp_f32 v22, v22
    v_mov_b32 v80, v24
    v_sub_f32 v32, v32, v24
    v_sub_f32 v33, v33, v24
    v_sub_f32 v34, v34, v24
    v_sub_f32 v35, v35, v24
    v_sub_f32 v36, v36, v24
    v_sub_f32 v37, v37, v24
    v_sub_f32 v38, v38, v24
    v_sub_f32 v39, v39, v24
    v_exp_f32 v32, v32
    v_exp_f32 v33, v33
    v_exp_f32 v34, v34
    v_exp_f32 v35, v35
    v_exp_f32 v36, v36
    v_exp_f32 v37, v37
    v_exp_f32 v38, v38
    v_exp_f32 v39, v39
    v_mul_f32 v84, v84, v22
    v_cvt_pk_bf16_f32 v64, v32, v33
    v_cvt_pk_bf16_f32 v65, v34, v35
    v_cvt_pk_bf16_f32 v66, v36, v37
    v_cvt_pk_bf16_f32 v67, v38, v39
    v_lshlrev_b32 v25, 16, v64
    v_add_f32 v84, v84, v25
    v_and_b32 v25, s31, v64
    v_add_f32 v84, v84, v25
    v_lshlrev_b32 v25, 16, v65
    v_add_f32 v84, v84, v25
    v_and_b32 v25, s31, v65
    v_add_f32 v84, v84, v25
    v_lshlrev_b32 v25, 16, v66
    v_add_f32 v84, v84, v25
    v_and_b32 v25, s31, v66
    v_add_f32 v84, v84, v25
    v_lshlrev_b32 v25, 16, v67
    v_add_f32 v84, v84, v25
    v_and_b32 v25, s31, v67
    v_add_f32 v84, v84, v25
    v_mul_f32 v128, v128, v22
    v_mul_f32 v129, v129, v22
    v_mul_f32 v130, v130, v22
    v_mul_f32 v131, v131, v22
    v_mul_f32 v132, v132, v22
    v_mul_f32 v133, v133, v22
    v_mul_f32 v134, v134, v22
    v_mul_f32 v135, v135, v22
    v_mul_f32 v136, v136, v22
    v_mul_f32 v137, v137, v22
    v_mul_f32 v138, v138, v22
    v_mul_f32 v139, v139, v22
    v_mul_f32 v140, v140, v22
    v_mul_f32 v141, v141, v22
    v_mul_f32 v142, v142, v22
    v_mul_f32 v143, v143, v22
    v_mul_f32 v144, v144, v22
    v_mul_f32 v145, v145, v22
    v_mul_f32 v146, v146, v22
    v_mul_f32 v147, v147, v22
    v_mul_f32 v148, v148, v22
    v_mul_f32 v149, v149, v22
    v_mul_f32 v150, v150, v22
    v_mul_f32 v151, v151, v22
    v_mul_f32 v152, v152, v22
    v_mul_f32 v153, v153, v22
    v_mul_f32 v154, v154, v22
    v_mul_f32 v155, v155, v22
    v_mul_f32 v156, v156, v22
    v_mul_f32 v157, v157, v22
    v_mul_f32 v158, v158, v22
    v_mul_f32 v159, v159, v22
    s_nop 1
    v_mfma_f32_16x16x32_bf16 v[128:131], a[128:131], v[64:67], v[128:131]
    v_mfma_f32_16x16x32_bf16 v[132:135], a[132:135], v[64:67], v[132:135]
    v_mfma_f32_16x16x32_bf16 v[136:139], a[136:139], v[64:67], v[136:139]
    v_mfma_f32_16x16x32_bf16 v[140:143], a[140:143], v[64:67], v[140:143]
    v_mfma_f32_16x16x32_bf16 v[144:147], a[144:147], v[64:67], v[144:147]
    v_mfma_f32_16x16x32_bf16 v[148:151], a[148:151], v[64:67], v[148:151]
    v_mfma_f32_16x16x32_bf16 v[152:155], a[152:155], v[64:67], v[152:155]
    v_mfma_f32_16x16x32_bf16 v[156:159], a[156:159], v[64:67], v[156:159]
    s_nop 7
    v_mfma_f32_16x16x32_bf16 v[32:35], a[64:67], a[16:19], 0
    v_mfma_f32_16x16x32_bf16 v[32:35], a[68:71], a[20:23], v[32:35]
    v_mfma_f32_16x16x32_bf16 v[32:35], a[72:75], a[24:27], v[32:35]
    v_mfma_f32_16x16x32_bf16 v[32:35], a[76:79], a[28:31], v[32:35]
    v_mfma_f32_16x16x32_bf16 v[36:39], a[80:83], a[16:19], 0
    v_mfma_f32_16x16x32_bf16 v[36:39], a[84:87], a[20:23], v[36:39]
    v_mfma_f32_16x16x32_bf16 v[36:39], a[88:91], a[24:27], v[36:39]
    v_mfma_f32_16x16x32_bf16 v[36:39], a[92:95], a[28:31], v[36:39]
    s_nop 7
    v_max3_f32 v24, v32, v33, v34
    v_max3_f32 v25, v35, v36, v37
    v_max3_f32 v24, v24, v38, v39
    v_max3_f32 v24, v24, v25, v81
    v_mov_b32 v25, v24
    s_nop 1
    v_permlane32_swap_b32 v24, v25
    v_max_f32 v24, v24, v25
    v_mov_b32 v25, v24
    s_nop 1
    v_permlane16_swap_b32 v24, v25
    v_max_f32 v24, v24, v25
    v_sub_f32 v22, v81, v24
    v_exp_f32 v22, v22
    v_mov_b32 v81, v24
    v_sub_f32 v32, v32, v24
    v_sub_f32 v33, v33, v24
    v_sub_f32 v34, v34, v24
    v_sub_f32 v35, v35, v24
    v_sub_f32 v36, v36, v24
    v_sub_f32 v37, v37, v24
    v_sub_f32 v38, v38, v24
    v_sub_f32 v39, v39, v24
    v_exp_f32 v32, v32
    v_exp_f32 v33, v33
    v_exp_f32 v34, v34
    v_exp_f32 v35, v35
    v_exp_f32 v36, v36
    v_exp_f32 v37, v37
    v_exp_f32 v38, v38
    v_exp_f32 v39, v39
    v_mul_f32 v85, v85, v22
    v_cvt_pk_bf16_f32 v64, v32, v33
    v_cvt_pk_bf16_f32 v65, v34, v35
    v_cvt_pk_bf16_f32 v66, v36, v37
    v_cvt_pk_bf16_f32 v67, v38, v39
    v_lshlrev_b32 v25, 16, v64
    v_add_f32 v85, v85, v25
    v_and_b32 v25, s31, v64
    v_add_f32 v85, v85, v25
    v_lshlrev_b32 v25, 16, v65
    v_add_f32 v85, v85, v25
    v_and_b32 v25, s31, v65
    v_add_f32 v85, v85, v25
    v_lshlrev_b32 v25, 16, v66
    v_add_f32 v85, v85, v25
    v_and_b32 v25, s31, v66
    v_add_f32 v85, v85, v25
    v_lshlrev_b32 v25, 16, v67
    v_add_f32 v85, v85, v25
    v_and_b32 v25, s31, v67
    v_add_f32 v85, v85, v25
    v_mul_f32 v160, v160, v22
    v_mul_f32 v161, v161, v22
    v_mul_f32 v162, v162, v22
    v_mul_f32 v163, v163, v22
    v_mul_f32 v164, v164, v22
    v_mul_f32 v165, v165, v22
    v_mul_f32 v166, v166, v22
    v_mul_f32 v167, v167, v22
    v_mul_f32 v168, v168, v22
    v_mul_f32 v169, v169, v22
    v_mul_f32 v170, v170, v22
    v_mul_f32 v171, v171, v22
    v_mul_f32 v172, v172, v22
    v_mul_f32 v173, v173, v22
    v_mul_f32 v174, v174, v22
    v_mul_f32 v175, v175, v22
    v_mul_f32 v176, v176, v22
    v_mul_f32 v177, v177, v22
    v_mul_f32 v178, v178, v22
    v_mul_f32 v179, v179, v22
    v_mul_f32 v180, v180, v22
    v_mul_f32 v181, v181, v22
    v_mul_f32 v182, v182, v22
    v_mul_f32 v183, v183, v22
    v_mul_f32 v184, v184, v22
    v_mul_f32 v185, v185, v22
    v_mul_f32 v186, v186, v22
    v_mul_f32 v187, v187, v22
    v_mul_f32 v188, v188, v22
    v_mul_f32 v189, v189, v22
    v_mul_f32 v190, v190, v22
    v_mul_f32 v191, v191, v22
    s_nop 1
    v_mfma_f32_16x16x32_bf16 v[160:163], a[128:131], v[64:67], v[160:163]
    v_mfma_f32_16x16x32_bf16 v[164:167], a[132:135], v[64:67], v[164:167]
    v_mfma_f32_16x16x32_bf16 v[168:171], a[136:139], v[64:67], v[168:171]
    v_mfma_f32_16x16x32_bf16 v[172:175], a[140:143], v[64:67], v[172:175]
    v_mfma_f32_16x16x32_bf16 v[176:179], a[144:147], v[64:67], v[176:179]
    v_mfma_f32_16x16x32_bf16 v[180:183], a[148:151], v[64:67], v[180:183]
    v_mfma_f32_16x16x32_bf16 v[184:187], a[152:155], v[64:67], v[184:187]
    v_mfma_f32_16x16x32_bf16 v[188:191], a[156:159], v[64:67], v[188:191]
    s_nop 7
    v_mfma_f32_16x16x32_bf16 v[32:35], a[64:67], a[32:35], 0
    v_mfma_f32_16x16x32_bf16 v[32:35], a[68:71], a[36:39], v[32:35]
    v_mfma_f32_16x16x32_bf16 v[32:35], a[72:75], a[40:43], v[32:35]
    v_mfma_f32_16x16x32_bf16 v[32:35], a[76:79], a[44:47], v[32:35]
    v_mfma_f32_16x16x32_bf16 v[36:39], a[80:83], a[32:35], 0
    v_mfma_f32_16x16x32_bf16 v[36:39], a[84:87], a[36:39], v[36:39]
    v_mfma_f32_16x16x32_bf16 v[36:39], a[88:91], a[40:43], v[36:39]
    v_mfma_f32_16x16x32_bf16 v[36:39], a[92:95], a[44:47], v[36:39]
    s_nop 7
    v_max3_f32 v24, v32, v33, v34
    v_max3_f32 v25, v35, v36, v37
    v_max3_f32 v24, v24, v38, v39
    v_max3_f32 v24, v24, v25, v82
    v_mov_b32 v25, v24
    s_nop 1
    v_permlane32_swap_b32 v24, v25
    v_max_f32 v24, v24, v25
    v_mov_b32 v25, v24
    s_nop 1
    v_permlane16_swap_b32 v24, v25
    v_max_f32 v24, v24, v25
    v_sub_f32 v22, v82, v24
    v_exp_f32 v22, v22
    v_mov_b32 v82, v24
    v_sub_f32 v32, v32, v24
    v_sub_f32 v33, v33, v24
    v_sub_f32 v34, v34, v24
    v_sub_f32 v35, v35, v24
    v_sub_f32 v36, v36, v24
    v_sub_f32 v37, v37, v24
    v_sub_f32 v38, v38, v24
    v_sub_f32 v39, v39, v24
    v_exp_f32 v32, v32
    v_exp_f32 v33, v33
    v_exp_f32 v34, v34
    v_exp_f32 v35, v35
    v_exp_f32 v36, v36
    v_exp_f32 v37, v37
    v_exp_f32 v38, v38
    v_exp_f32 v39, v39
    v_mul_f32 v86, v86, v22
    v_cvt_pk_bf16_f32 v64, v32, v33
    v_cvt_pk_bf16_f32 v65, v34, v35
    v_cvt_pk_bf16_f32 v66, v36, v37
    v_cvt_pk_bf16_f32 v67, v38, v39
    v_lshlrev_b32 v25, 16, v64
    v_add_f32 v86, v86, v25
    v_and_b32 v25, s31, v64
    v_add_f32 v86, v86, v25
    v_lshlrev_b32 v25, 16, v65
    v_add_f32 v86, v86, v25
    v_and_b32 v25, s31, v65
    v_add_f32 v86, v86, v25
    v_lshlrev_b32 v25, 16, v66
    v_add_f32 v86, v86, v25
    v_and_b32 v25, s31, v66
    v_add_f32 v86, v86, v25
    v_lshlrev_b32 v25, 16, v67
    v_add_f32 v86, v86, v25
    v_and_b32 v25, s31, v67
    v_add_f32 v86, v86, v25
    v_mul_f32 v192, v192, v22
    v_mul_f32 v193, v193, v22
    v_mul_f32 v194, v194, v22
    v_mul_f32 v195, v195, v22
    v_mul_f32 v196, v196, v22
    v_mul_f32 v197, v197, v22
    v_mul_f32 v198, v198, v22
    v_mul_f32 v199, v199, v22
    v_mul_f32 v200, v200, v22
    v_mul_f32 v201, v201, v22
    v_mul_f32 v202, v202, v22
    v_mul_f32 v203, v203, v22
    v_mul_f32 v204, v204, v22
    v_mul_f32 v205, v205, v22
    v_mul_f32 v206, v206, v22
    v_mul_f32 v207, v207, v22
    v_mul_f32 v208, v208, v22
    v_mul_f32 v209, v209, v22
    v_mul_f32 v210, v210, v22
    v_mul_f32 v211, v211, v22
    v_mul_f32 v212, v212, v22
    v_mul_f32 v213, v213, v22
    v_mul_f32 v214, v214, v22
    v_mul_f32 v215, v215, v22
    v_mul_f32 v216, v216, v22
    v_mul_f32 v217, v217, v22
    v_mul_f32 v218, v218, v22
    v_mul_f32 v219, v219, v22
    v_mul_f32 v220, v220, v22
    v_mul_f32 v221, v221, v22
    v_mul_f32 v222, v222, v22
    v_mul_f32 v223, v223, v22
    s_nop 1
    v_mfma_f32_16x16x32_bf16 v[192:195], a[128:131], v[64:67], v[192:195]
    v_mfma_f32_16x16x32_bf16 v[196:199], a[132:135], v[64:67], v[196:199]
    v_mfma_f32_16x16x32_bf16 v[200:203], a[136:139], v[64:67], v[200:203]
    v_mfma_f32_16x16x32_bf16 v[204:207], a[140:143], v[64:67], v[204:207]
    v_mfma_f32_16x16x32_bf16 v[208:211], a[144:147], v[64:67], v[208:211]
    v_mfma_f32_16x16x32_bf16 v[212:215], a[148:151], v[64:67], v[212:215]
    v_mfma_f32_16x16x32_bf16 v[216:219], a[152:155], v[64:67], v[216:219]
    v_mfma_f32_16x16x32_bf16 v[220:223], a[156:159], v[64:67], v[220:223]
    s_nop 7
    s_add_u32 s32, s32, 8192
    s_cmp_lt_u32 s32, 0x80000
    s_cbranch_scc1 L_sl3
    v_mov_b32 v25, v84
    s_nop 1
    v_permlane32_swap_b32 v84, v25
    v_add_f32 v84, v84, v25
    v_mov_b32 v25, v84
    s_nop 1
    v_permlane16_swap_b32 v84, v25
    v_add_f32 v84, v84, v25
    v_rcp_f32 v20, v84
    s_nop 0
    v_pk_mul_f32 v[128:129], v[128:129], v[20:21] op_sel_hi:[1,0]
    v_pk_mul_f32 v[130:131], v[130:131], v[20:21] op_sel_hi:[1,0]
    v_pk_mul_f32 v[132:133], v[132:133], v[20:21] op_sel_hi:[1,0]
    v_pk_mul_f32 v[134:135], v[134:135], v[20:21] op_sel_hi:[1,0]
    v_pk_mul_f32 v[136:137], v[136:137], v[20:21] op_sel_hi:[1,0]
    v_pk_mul_f32 v[138:139], v[138:139], v[20:21] op_sel_hi:[1,0]
    v_pk_mul_f32 v[140:141], v[140:141], v[20:21] op_sel_hi:[1,0]
    v_pk_mul_f32 v[142:143], v[142:143], v[20:21] op_sel_hi:[1,0]
    v_pk_mul_f32 v[144:145], v[144:145], v[20:21] op_sel_hi:[1,0]
    v_pk_mul_f32 v[146:147], v[146:147], v[20:21] op_sel_hi:[1,0]
    v_pk_mul_f32 v[148:149], v[148:149], v[20:21] op_sel_hi:[1,0]
    v_pk_mul_f32 v[150:151], v[150:151], v[20:21] op_sel_hi:[1,0]
    v_pk_mul_f32 v[152:153], v[152:153], v[20:21] op_sel_hi:[1,0]
    v_pk_mul_f32 v[154:155], v[154:155], v[20:21] op_sel_hi:[1,0]
    v_pk_mul_f32 v[156:157], v[156:157], v[20:21] op_sel_hi:[1,0]
    v_pk_mul_f32 v[158:159], v[158:159], v[20:21] op_sel_hi:[1,0]
    v_cvt_pk_bf16_f32 v112, v128, v129
    v_cvt_pk_bf16_f32 v113, v130, v131
    v_cvt_pk_bf16_f32 v114, v132, v133
    v_cvt_pk_bf16_f32 v115, v134, v135
    s_nop 1
    v_permlane16_swap_b32 v112, v114
    v_permlane16_swap_b32 v113, v115
    buffer_store_dwordx4 v[112:115], v110, s[24:27], 0 offen offset:0 sc1
    v_cvt_pk_bf16_f32 v116, v136, v137
    v_cvt_pk_bf16_f32 v117, v138, v139
    v_cvt_pk_bf16_f32 v118, v140, v141
    v_cvt_pk_bf16_f32 v119, v142, v143
    s_nop 1
    v_permlane16_swap_b32 v116, v118
    v_permlane16_swap_b32 v117, v119
    buffer_store_dwordx4 v[116:119], v110, s[24:27], 0 offen offset:64 sc1
    v_cvt_pk_bf16_f32 v120, v144, v145
    v_cvt_pk_bf16_f32 v121, v146, v147
    v_cvt_pk_bf16_f32 v122, v148, v149
    v_cvt_pk_bf16_f32 v123, v150, v151
    s_nop 1
    v_permlane16_swap_b32 v120, v122
    v_permlane16_swap_b32 v121, v123
    buffer_store_dwordx4 v[120:123], v110, s[24:27], 0 offen offset:128 sc1
    v_cvt_pk_bf16_f32 v124, v152, v153
    v_cvt_pk_bf16_f32 v125, v154, v155
    v_cvt_pk_bf16_f32 v126, v156, v157
    v_cvt_pk_bf16_f32 v127, v158, v159
    s_nop 1
    v_permlane16_swap_b32 v124, v126
    v_permlane16_swap_b32 v125, v127
    buffer_store_dwordx4 v[124:127], v110, s[24:27], 0 offen offset:192 sc1
    s_nop 1
    v_mov_b32 v25, v85
    s_nop 1
    v_permlane32_swap_b32 v85, v25
    v_add_f32 v85, v85, v25
    v_mov_b32 v25, v85
    s_nop 1
    v_permlane16_swap_b32 v85, v25
    v_add_f32 v85, v85, v25
    v_rcp_f32 v22, v85
    s_nop 0
    v_pk_mul_f32 v[160:161], v[160:161], v[22:23] op_sel_hi:[1,0]
    v_pk_mul_f32 v[162:163], v[162:163], v[22:23] op_sel_hi:[1,0]
    v_pk_mul_f32 v[164:165], v[164:165], v[22:23] op_sel_hi:[1,0]
    v_pk_mul_f32 v[166:167], v[166:167], v[22:23] op_sel_hi:[1,0]
    v_pk_mul_f32 v[168:169], v[168:169], v[22:23] op_sel_hi:[1,0]
    v_pk_mul_f32 v[170:171], v[170:171], v[22:23] op_sel_hi:[1,0]
    v_pk_mul_f32 v[172:173], v[172:173], v[22:23] op_sel_hi:[1,0]
    v_pk_mul_f32 v[174:175], v[174:175], v[22:23] op_sel_hi:[1,0]
    v_pk_mul_f32 v[176:177], v[176:177], v[22:23] op_sel_hi:[1,0]
    v_pk_mul_f32 v[178:179], v[178:179], v[22:23] op_sel_hi:[1,0]
    v_pk_mul_f32 v[180:181], v[180:181], v[22:23] op_sel_hi:[1,0]
    v_pk_mul_f32 v[182:183], v[182:183], v[22:23] op_sel_hi:[1,0]
    v_pk_mul_f32 v[184:185], v[184:185], v[22:23] op_sel_hi:[1,0]
    v_pk_mul_f32 v[186:187], v[186:187], v[22:23] op_sel_hi:[1,0]
    v_pk_mul_f32 v[188:189], v[188:189], v[22:23] op_sel_hi:[1,0]
    v_pk_mul_f32 v[190:191], v[190:191], v[22:23] op_sel_hi:[1,0]
    v_cvt_pk_bf16_f32 v112, v160, v161
    v_cvt_pk_bf16_f32 v113, v162, v163
    v_cvt_pk_bf16_f32 v114, v164, v165
    v_cvt_pk_bf16_f32 v115, v166, v167
    s_nop 1
    v_permlane16_swap_b32 v112, v114
    v_permlane16_swap_b32 v113, v115
    buffer_store_dwordx4 v[112:115], v110, s[24:27], s8 offen offset:0 sc1
    v_cvt_pk_bf16_f32 v116, v168, v169
    v_cvt_pk_bf16_f32 v117, v170, v171
    v_cvt_pk_bf16_f32 v118, v172, v173
    v_cvt_pk_bf16_f32 v119, v174, v175
    s_nop 1
    v_permlane16_swap_b32 v116, v118
    v_permlane16_swap_b32 v117, v119
    buffer_store_dwordx4 v[116:119], v110, s[24:27], s8 offen offset:64 sc1
    v_cvt_pk_bf16_f32 v120, v176, v177
    v_cvt_pk_bf16_f32 v121, v178, v179
    v_cvt_pk_bf16_f32 v122, v180, v181
    v_cvt_pk_bf16_f32 v123, v182, v183
    s_nop 1
    v_permlane16_swap_b32 v120, v122
    v_permlane16_swap_b32 v121, v123
    buffer_store_dwordx4 v[120:123], v110, s[24:27], s8 offen offset:128 sc1
    v_cvt_pk_bf16_f32 v124, v184, v185
    v_cvt_pk_bf16_f32 v125, v186, v187
    v_cvt_pk_bf16_f32 v126, v188, v189
    v_cvt_pk_bf16_f32 v127, v190, v191
    s_nop 1
    v_permlane16_swap_b32 v124, v126
    v_permlane16_swap_b32 v125, v127
    buffer_store_dwordx4 v[124:127], v110, s[24:27], s8 offen offset:192 sc1
    s_nop 1
    v_mov_b32 v25, v86
    s_nop 1
    v_permlane32_swap_b32 v86, v25
    v_add_f32 v86, v86, v25
    v_mov_b32 v25, v86
    s_nop 1
    v_permlane16_swap_b32 v86, v25
    v_add_f32 v86, v86, v25
    v_rcp_f32 v20, v86
    s_nop 0
    v_pk_mul_f32 v[192:193], v[192:193], v[20:21] op_sel_hi:[1,0]
    v_pk_mul_f32 v[194:195], v[194:195], v[20:21] op_sel_hi:[1,0]
    v_pk_mul_f32 v[196:197], v[196:197], v[20:21] op_sel_hi:[1,0]
    v_pk_mul_f32 v[198:199], v[198:199], v[20:21] op_sel_hi:[1,0]
    v_pk_mul_f32 v[200:201], v[200:201], v[20:21] op_sel_hi:[1,0]
    v_pk_mul_f32 v[202:203], v[202:203], v[20:21] op_sel_hi:[1,0]
    v_pk_mul_f32 v[204:205], v[204:205], v[20:21] op_sel_hi:[1,0]
    v_pk_mul_f32 v[206:207], v[206:207], v[20:21] op_sel_hi:[1,0]
    v_pk_mul_f32 v[208:209], v[208:209], v[20:21] op_sel_hi:[1,0]
    v_pk_mul_f32 v[210:211], v[210:211], v[20:21] op_sel_hi:[1,0]
    v_pk_mul_f32 v[212:213], v[212:213], v[20:21] op_sel_hi:[1,0]
    v_pk_mul_f32 v[214:215], v[214:215], v[20:21] op_sel_hi:[1,0]
    v_pk_mul_f32 v[216:217], v[216:217], v[20:21] op_sel_hi:[1,0]
    v_pk_mul_f32 v[218:219], v[218:219], v[20:21] op_sel_hi:[1,0]
    v_pk_mul_f32 v[220:221], v[220:221], v[20:21] op_sel_hi:[1,0]
    v_pk_mul_f32 v[222:223], v[222:223], v[20:21] op_sel_hi:[1,0]
    v_cvt_pk_bf16_f32 v112, v192, v193
    v_cvt_pk_bf16_f32 v113, v194, v195
    v_cvt_pk_bf16_f32 v114, v196, v197
    v_cvt_pk_bf16_f32 v115, v198, v199
    s_nop 1
    v_permlane16_swap_b32 v112, v114
    v_permlane16_swap_b32 v113, v115
    buffer_store_dwordx4 v[112:115], v110, s[24:27], s9 offen offset:0 sc1
    v_cvt_pk_bf16_f32 v116, v200, v201
    v_cvt_pk_bf16_f32 v117, v202, v203
    v_cvt_pk_bf16_f32 v118, v204, v205
    v_cvt_pk_bf16_f32 v119, v206, v207
    s_nop 1
    v_permlane16_swap_b32 v116, v118
    v_permlane16_swap_b32 v117, v119
    buffer_store_dwordx4 v[116:119], v110, s[24:27], s9 offen offset:64 sc1
    v_cvt_pk_bf16_f32 v120, v208, v209
    v_cvt_pk_bf16_f32 v121, v210, v211
    v_cvt_pk_bf16_f32 v122, v212, v213
    v_cvt_pk_bf16_f32 v123, v214, v215
    s_nop 1
    v_permlane16_swap_b32 v120, v122
    v_permlane16_swap_b32 v121, v123
    buffer_store_dwordx4 v[120:123], v110, s[24:27], s9 offen offset:128 sc1
    v_cvt_pk_bf16_f32 v124, v216, v217
    v_cvt_pk_bf16_f32 v125, v218, v219
    v_cvt_pk_bf16_f32 v126, v220, v221
    v_cvt_pk_bf16_f32 v127, v222, v223
    s_nop 1
    v_permlane16_swap_b32 v124, v126
    v_permlane16_swap_b32 v125, v127
    buffer_store_dwordx4 v[124:127], v110, s[24:27], s9 offen offset:192 sc1
    s_nop 1
    s_branch L_fin3
Z_slow3:
L_end:
    s_endpgm
.section .rodata,"a"
.p2align 6
.amdhsa_kernel standalone__mha_softmax__near_ridge_kernel
  .amdhsa_next_free_vgpr 472
  .amdhsa_next_free_sgpr 40
  .amdhsa_accum_offset 256
  .amdhsa_group_segment_fixed_size 0
  .amdhsa_kernarg_size 48
  .amdhsa_user_sgpr_count 2
  .amdhsa_user_sgpr_kernarg_segment_ptr 1
  .amdhsa_system_sgpr_workgroup_id_x 1
.end_amdhsa_kernel
```
